```python
import torch

def _softmax(x, axis=-1):
    return torch.softmax(x, dim=axis)
def _gelu(x):
    return torch.nn.functional.gelu(x, approximate="tanh")
def _silu(x):
    return torch.nn.functional.silu(x)
def _sigmoid(x):
    return torch.sigmoid(x)
def _layernorm(x, axis=-1, eps=1e-5):
    m = x.mean(dim=axis, keepdim=True)
    v = x.var(dim=axis, keepdim=True, unbiased=False)
    return (x - m) / torch.sqrt(v + eps)
def _scatter_add(tgt, idx, src, axis=0):
    return tgt.clone().index_add_(axis, idx, src)
def _segment_sum(src, seg, n):
    out = torch.zeros((n,) + src.shape[1:], dtype=src.dtype)
    return out.index_add_(0, seg, src)
def _pad(x, pw):
    flat = tuple(v for pair in reversed(pw) for v in pair)
    return torch.nn.functional.pad(x, flat)

kernel_name = 'parallel_sum__linear_attn_block__geglu_ffn__prompt'

def setup_inputs():

    _w = (lambda a: (lambda t: t.to(torch.bfloat16) if t.is_floating_point() else t)(torch.as_tensor(a)))
    def _A_setup():
        B, S, D = 1, 2048, 448
        return {
            "x": _w((lambda *s: torch.randn(*s, dtype=torch.bfloat16) * 0.05)(B, S, D)),
            "wqkv": _w((lambda *s: torch.randn(*s, dtype=torch.bfloat16) * 0.4)(D, 3 * D)),
            "wo": _w((lambda *s: torch.randn(*s, dtype=torch.bfloat16) * 0.2)(D, D)),
        }
    _A_in = _A_setup()

    def _B_setup():
        B, S, D, F = 1, 2048, 448, 1792
        return {
            "x": _w((lambda *s: torch.randn(*s, dtype=torch.bfloat16) * 0.05)(B, S, D)),
            "w_gate": _w((lambda *s: torch.randn(*s, dtype=torch.bfloat16) * 0.05)(D, F)),
            "w_up": _w((lambda *s: torch.randn(*s, dtype=torch.bfloat16) * 0.05)(D, F)),
            "w_down": _w((lambda *s: torch.randn(*s, dtype=torch.bfloat16) * 0.05)(F, D)),
        }
    _B_in = _B_setup()

    return {
        "A_x": _A_in["x"],
        "A_wqkv": _A_in["wqkv"],
        "A_wo": _A_in["wo"],
        "B_x": _B_in["x"],
        "B_w_gate": _B_in["w_gate"],
        "B_w_up": _B_in["w_up"],
        "B_w_down": _B_in["w_down"],
    }

def reference(A_x, A_wqkv, A_wo, B_x, B_w_gate, B_w_up, B_w_down):
    def _A_ref(x, wqkv, wo):
        B, S, D = x.shape
        H = 16; Dh = D // H
        qkv = (lambda x, *d: x.permute(*d))((x @ wqkv).reshape(B, S, 3, H, Dh), 2, 0, 3, 1, 4)
        q, k, v = qkv[0], qkv[1], qkv[2]
        phi = lambda t: torch.where(t > 0, t + 1, torch.exp(t)) + 1e-6
        pq, pk = phi(q), phi(k)
        kv = torch.einsum("bhsd,bhse->bhde", pk, v)
        z = torch.einsum("bhsd->bhd", pk)
        num = torch.einsum("bhqd,bhde->bhqe", pq, kv)
        den = torch.einsum("bhqd,bhd->bhq", pq, z)[..., None] + 1e-6
        o = num / den
        return (lambda x, *d: x.permute(*d))(o, 0, 2, 1, 3).reshape(B, S, D) @ wo

    def _B_ref(x, w_gate, w_up, w_down):
        return (_gelu(x @ w_gate) * (x @ w_up)) @ w_down

    x = A_x
    xn = _layernorm(x, axis=-1)
    return x + _A_ref(xn, A_wqkv, A_wo) + _B_ref(xn, B_w_gate, B_w_up, B_w_down)
```

```asm
; @launch grid=(256,1,1) block=(512,1,1) lds=163840
.amdgcn_target "amdgcn-amd-amdhsa--gfx950"
.text
.globl parallel_sum__linear_attn_block__geglu_ffn__prompt_kernel
.p2align 8
.type parallel_sum__linear_attn_block__geglu_ffn__prompt_kernel,@function
parallel_sum__linear_attn_block__geglu_ffn__prompt_kernel:
s_cmp_ge_u32 s2, 256
s_cbranch_scc1 L_end
s_load_dwordx16 s[60:75], s[0:1], 0
s_load_dwordx4 s[40:43], s[0:1], 64
s_memrealtime s[96:97]
v_lshrrev_b32 v1, 6, v0
v_and_b32 v0, 63, v0
v_readfirstlane_b32 s44, v1
s_nop 1
s_cmp_eq_u32 s44, 3
s_cbranch_scc0 L_npf
s_getpc_b64 s[8:9]
L_pc:
s_sub_u32 s8, s8, L_pc-parallel_sum__linear_attn_block__geglu_ffn__prompt_kernel
s_subb_u32 s9, s9, 0
s_mov_b32 s10, L_end-parallel_sum__linear_attn_block__geglu_ffn__prompt_kernel
s_mov_b32 s11, 0x20000
v_lshlrev_b32 v9, 7, v0
s_lshr_b32 s54, s2, 3
s_lshl_b32 s54, s54, 11
s_mov_b64 exec, 0xffff
buffer_load_dword v7, v9, s[8:11], s54 offen
s_mov_b64 exec, -1
L_npf:
s_mov_b32 s6, 1835008
s_mov_b32 s7, 0x20000
s_and_b32 s54, s2, 7
s_lshr_b32 s55, s2, 3
s_lshr_b32 s48, s55, 3
s_and_b32 s46, s55, 7
s_and_b32 s47, s54, 1
s_lshr_b32 s54, s54, 1
s_lshl_b32 s54, s54, 2
s_add_u32 s45, s54, s48
s_lshl_b32 s54, s48, 1
s_add_u32 s54, s54, s46
s_sub_u32 s55, s54, 7
s_cmp_ge_u32 s54, 7
s_cselect_b32 s49, s55, s54
s_mul_i32 s52, s47, 7
s_add_u32 s52, s52, s46
s_lshl_b32 s51, s47, 3
s_add_u32 s51, s51, s46
s_cmp_eq_u32 s46, 7
s_cselect_b32 s50, 1, 0
s_and_b32 s3, s48, 0
s_waitcnt lgkmcnt(0)
s_mov_b64 s[4:5], s[60:61]
s_cmp_lt_u32 s44, 4
s_cbranch_scc1 L_C
L_H:
s_sub_u32 s100, s44, 4
v_lshrrev_b32 v8, 4, v0
v_and_b32 v9, 7, v0
v_xor_b32 v9, v9, v8
v_lshrrev_b32 v8, 3, v0
v_mul_u32_u24 v8, 896, v8
v_lshl_add_u32 v16, v9, 4, v8
v_xor_b32 v17, 64, v16
s_lshl_b32 s84, s45, 2
s_add_u32 s84, s84, s100
s_mul_i32 s84, s84, 28672
s_lshl_b32 s85, s100, 12
s_mov_b32 s86, s49
s_lshl_b32 s87, s86, 7
s_add_u32 s87, s87, s84
s_add_u32 m0, s85, 98304
s_add_u32 s86, s86, 1
buffer_load_dwordx4 v16, s[4:7], s87 offen  lds
s_add_u32 m0, s85, 99328
s_add_u32 s87, s87, 7168
buffer_load_dwordx4 v16, s[4:7], s87 offen  lds
s_add_u32 m0, s85, 100352
s_add_u32 s87, s87, 7168
buffer_load_dwordx4 v17, s[4:7], s87 offen  lds
s_add_u32 m0, s85, 101376
s_add_u32 s87, s87, 7168
buffer_load_dwordx4 v17, s[4:7], s87 offen  lds
s_cmp_eq_u32 s86, 7
s_cselect_b32 s86, 0, s86
s_mov_b64 s[8:9], s[62:63]
s_mov_b64 s[12:13], s[64:65]
s_mov_b64 s[16:17], s[68:69]
s_mov_b64 s[20:21], s[70:71]
s_mov_b64 s[24:25], s[72:73]
s_mov_b64 s[28:29], s[74:75]
s_mov_b64 s[32:33], s[40:41]
s_mov_b64 s[36:37], s[42:43]
s_mov_b32 s10, 1204224
s_mov_b32 s11, 0x20000
s_mov_b32 s14, 401408
s_mov_b32 s15, 0x20000
s_mov_b32 s18, 1605632
s_mov_b32 s19, 0x20000
s_mov_b32 s22, 1605632
s_mov_b32 s23, 0x20000
s_mov_b32 s26, 1605632
s_mov_b32 s27, 0x20000
s_mov_b32 s30, 1835008
s_mov_b32 s31, 0x20000
s_mov_b32 s34, 256
s_mov_b32 s35, 0x20000
s_mov_b32 s38, 16777216
s_mov_b32 s39, 0x20000
s_cmp_eq_u32 s50, 1
s_cselect_b32 s57, 21, 28
s_cselect_b32 s16, s8, s16
s_cselect_b32 s17, s9, s17
s_cselect_b32 s18, s10, s18
s_cselect_b32 s20, s8, s20
s_cselect_b32 s21, s9, s21
s_cselect_b32 s22, s10, s22
s_lshl_b32 s57, s57, 7
v_and_b32 v8, 7, v0
v_lshrrev_b32 v9, 2, v0
v_and_b32 v9, 4, v9
v_xor_b32 v8, v8, v9
v_lshrrev_b32 v9, 3, v0
v_mul_lo_u32 v9, v9, s57
v_lshl_add_u32 v2, v8, 4, v9
s_lshl_b32 s53, s100, 11
s_mov_b32 s94, s49
s_lshl_b32 s92, s57, 3
s_lshl_b32 s93, s57, 6
s_lshl_b32 s57, s57, 4
s_mul_i32 s57, s57, s100
s_lshl_b32 s54, s52, 8
s_mul_i32 s55, s47, 448
s_add_u32 s95, s54, s57
s_add_u32 s101, s55, s57
s_lshl_b32 s54, s3, 7
s_add_u32 s95, s95, s54
s_xor_b32 s56, s95, 0
s_add_u32 s58, s101, 0
s_cmp_eq_u32 s50, 1
s_cselect_b32 s75, s58, s56
s_lshl_b32 s87, s86, 7
s_add_u32 s87, s87, s84
s_add_u32 m0, s85, 114688
s_add_u32 s86, s86, 1
buffer_load_dwordx4 v16, s[4:7], s87 offen  lds
s_add_u32 m0, s85, 115712
s_add_u32 s87, s87, 7168
buffer_load_dwordx4 v16, s[4:7], s87 offen  lds
s_add_u32 m0, s85, 116736
s_add_u32 s87, s87, 7168
buffer_load_dwordx4 v17, s[4:7], s87 offen  lds
s_add_u32 m0, s85, 117760
s_add_u32 s87, s87, 7168
buffer_load_dwordx4 v17, s[4:7], s87 offen  lds
s_cmp_eq_u32 s86, 7
s_cselect_b32 s86, 0, s86
s_mul_i32 s55, s45, 28
v_add_u32 v8, s55, v0
v_mul_u32_u24 v8, 3584, v8
s_mul_i32 s56, s100, 57344
s_sub_u32 s56, s75, s56
s_cmp_eq_u32 s100, 0
s_cselect_b32 s55, 28, 0
s_cmp_eq_u32 s50, 1
s_cselect_b32 s55, 0, s55
v_mov_b32 v9, 0x40000000
v_cmp_gt_u32 vcc, s55, v0
s_nop 1
v_cndmask_b32 v8, v9, v8, vcc
buffer_load_dword v54, v8, s[16:19], s56 offen
s_xor_b32 s56, s95, 0
s_add_u32 s58, s101, 112
s_cmp_eq_u32 s50, 1
s_cselect_b32 s41, s58, s56
s_xor_b32 s56, s95, 128
s_add_u32 s58, s101, 224
s_cmp_eq_u32 s50, 1
s_cselect_b32 s42, s58, s56
s_xor_b32 s56, s95, 128
s_add_u32 s58, s101, 336
s_cmp_eq_u32 s50, 1
s_cselect_b32 s43, s58, s56
v_and_b32 v8, 7, v0
v_lshrrev_b32 v9, 2, v0
v_and_b32 v9, 4, v9
v_xor_b32 v8, v8, v9
v_lshrrev_b32 v9, 3, v0
v_mul_u32_u24 v9, 2688, v9
v_lshl_add_u32 v1, v8, 4, v9
v_cmp_lt_u32 vcc, 3, v8
v_mov_b32 v9, 896
v_mov_b32 v10, 1728
v_cndmask_b32 v9, v9, v10, vcc
v_add_u32 v1, v1, v9
s_mul_i32 s40, s51, 56
s_mul_i32 s54, s100, 43008
s_add_u32 s40, s40, s54
v_lshlrev_b32 v4, 4, v0
v_mov_b32 v9, 0x40000000
v_cmp_eq_u32 vcc, 0, v0
s_nop 1
v_cndmask_b32 v190, v9, v0, vcc
s_lshl_b32 s54, s51, 4
s_add_u32 s54, s54, s45
s_lshl_b32 s54, s54, 2
s_add_u32 s101, s54, s100
v_and_b32 v8, 7, v0
v_lshrrev_b32 v9, 2, v0
v_and_b32 v9, 4, v9
v_xor_b32 v8, v8, v9
v_lshrrev_b32 v9, 3, v0
v_mul_u32_u24 v9, 896, v9
v_lshl_add_u32 v3, v8, 4, v9
s_lshl_b32 s87, s86, 7
s_add_u32 s87, s87, s84
s_add_u32 m0, s85, 131072
s_add_u32 s86, s86, 1
buffer_load_dwordx4 v16, s[4:7], s87 offen  lds
s_add_u32 m0, s85, 132096
s_add_u32 s87, s87, 7168
buffer_load_dwordx4 v16, s[4:7], s87 offen  lds
s_add_u32 m0, s85, 133120
s_add_u32 s87, s87, 7168
buffer_load_dwordx4 v17, s[4:7], s87 offen  lds
s_add_u32 m0, s85, 134144
s_add_u32 s87, s87, 7168
buffer_load_dwordx4 v17, s[4:7], s87 offen  lds
s_cmp_eq_u32 s86, 7
s_cselect_b32 s86, 0, s86
s_lshl_b32 s87, s86, 7
s_add_u32 s87, s87, s84
s_add_u32 m0, s85, 147456
s_add_u32 s86, s86, 1
buffer_load_dwordx4 v16, s[4:7], s87 offen  lds
s_add_u32 m0, s85, 148480
s_add_u32 s87, s87, 7168
buffer_load_dwordx4 v16, s[4:7], s87 offen  lds
s_add_u32 m0, s85, 149504
s_add_u32 s87, s87, 7168
buffer_load_dwordx4 v17, s[4:7], s87 offen  lds
s_add_u32 m0, s85, 150528
s_add_u32 s87, s87, 7168
buffer_load_dwordx4 v17, s[4:7], s87 offen  lds
s_cmp_eq_u32 s86, 7
s_cselect_b32 s86, 0, s86
s_waitcnt vmcnt(9)
s_barrier
s_lshl_b32 s87, s86, 7
s_add_u32 s87, s87, s84
s_add_u32 m0, s85, 0
s_add_u32 s86, s86, 1
buffer_load_dwordx4 v16, s[4:7], s87 offen  lds
s_add_u32 m0, s85, 1024
s_add_u32 s87, s87, 7168
buffer_load_dwordx4 v16, s[4:7], s87 offen  lds
s_add_u32 m0, s85, 2048
s_add_u32 s87, s87, 7168
buffer_load_dwordx4 v17, s[4:7], s87 offen  lds
s_add_u32 m0, s85, 3072
s_add_u32 s87, s87, 7168
buffer_load_dwordx4 v17, s[4:7], s87 offen  lds
s_cmp_eq_u32 s86, 7
s_cselect_b32 s86, 0, s86
s_lshl_b32 s87, s86, 7
s_add_u32 s87, s87, s84
s_add_u32 m0, s85, 16384
s_add_u32 s86, s86, 1
buffer_load_dwordx4 v16, s[4:7], s87 offen  lds
s_add_u32 m0, s85, 17408
s_add_u32 s87, s87, 7168
buffer_load_dwordx4 v16, s[4:7], s87 offen  lds
s_add_u32 m0, s85, 18432
s_add_u32 s87, s87, 7168
buffer_load_dwordx4 v17, s[4:7], s87 offen  lds
s_add_u32 m0, s85, 19456
s_add_u32 s87, s87, 7168
buffer_load_dwordx4 v17, s[4:7], s87 offen  lds
s_cmp_eq_u32 s86, 7
s_cselect_b32 s86, 0, s86
s_waitcnt vmcnt(8)
s_barrier
s_lshl_b32 s87, s86, 7
s_add_u32 s87, s87, s84
s_add_u32 m0, s85, 32768
s_add_u32 s86, s86, 1
buffer_load_dwordx4 v16, s[4:7], s87 offen  lds
s_add_u32 m0, s85, 33792
s_add_u32 s87, s87, 7168
buffer_load_dwordx4 v16, s[4:7], s87 offen  lds
s_add_u32 m0, s85, 34816
s_add_u32 s87, s87, 7168
buffer_load_dwordx4 v17, s[4:7], s87 offen  lds
s_add_u32 m0, s85, 35840
s_add_u32 s87, s87, 7168
buffer_load_dwordx4 v17, s[4:7], s87 offen  lds
s_cmp_eq_u32 s86, 7
s_cselect_b32 s86, 0, s86
s_add_u32 s94, s49, 0
s_sub_u32 s54, s94, 7
s_cmp_ge_u32 s94, 7
s_cselect_b32 s94, s54, s94
s_mul_i32 s54, s94, s93
s_add_u32 s54, s54, s75
s_add_u32 m0, s53, 49152
s_nop 0
buffer_load_dwordx4 v2, s[16:19], s54 offen  lds
s_add_u32 m0, s53, 50176
s_add_u32 s54, s54, s92
buffer_load_dwordx4 v2, s[16:19], s54 offen  lds
s_add_u32 s94, s49, 1
s_sub_u32 s54, s94, 7
s_cmp_ge_u32 s94, 7
s_cselect_b32 s94, s54, s94
s_mul_i32 s54, s94, s93
s_add_u32 s54, s54, s75
s_add_u32 m0, s53, 57344
s_nop 0
buffer_load_dwordx4 v2, s[16:19], s54 offen  lds
s_add_u32 m0, s53, 58368
s_add_u32 s54, s54, s92
buffer_load_dwordx4 v2, s[16:19], s54 offen  lds
s_add_u32 s94, s49, 2
s_sub_u32 s54, s94, 7
s_cmp_ge_u32 s94, 7
s_cselect_b32 s94, s54, s94
s_mul_i32 s54, s94, s93
s_add_u32 s54, s54, s75
s_add_u32 m0, s53, 65536
s_nop 0
buffer_load_dwordx4 v2, s[16:19], s54 offen  lds
s_add_u32 m0, s53, 66560
s_add_u32 s54, s54, s92
buffer_load_dwordx4 v2, s[16:19], s54 offen  lds
s_waitcnt vmcnt(10)
s_barrier
v_mov_b32 v8, 0x40000000
s_or_b32 s96, s96, 1
v_mov_b32 v12, s96
s_or_b32 s54, s2, s100
s_cmp_eq_u32 s54, 0
s_cselect_b32 s54, 1, 0
v_cmp_gt_u32 vcc, s54, v0
v_lshlrev_b32 v15, 2, v0
s_nop 0
v_cndmask_b32 v15, v8, v15, vcc
buffer_store_dword v12, v15, s[32:35], 0 offen sc1
s_waitcnt vmcnt(7)
s_barrier
s_add_u32 s94, s49, 3
s_sub_u32 s54, s94, 7
s_cmp_ge_u32 s94, 7
s_cselect_b32 s94, s54, s94
s_mul_i32 s54, s94, s93
s_add_u32 s54, s54, s75
s_add_u32 m0, s53, 73728
s_nop 0
buffer_load_dwordx4 v2, s[16:19], s54 offen  lds
s_add_u32 m0, s53, 74752
s_add_u32 s54, s54, s92
buffer_load_dwordx4 v2, s[16:19], s54 offen  lds
s_add_u32 s94, s49, 4
s_sub_u32 s54, s94, 7
s_cmp_ge_u32 s94, 7
s_cselect_b32 s94, s54, s94
s_mul_i32 s54, s94, s93
s_add_u32 s54, s54, s75
s_add_u32 m0, s53, 81920
s_nop 0
buffer_load_dwordx4 v2, s[16:19], s54 offen  lds
s_add_u32 m0, s53, 82944
s_add_u32 s54, s54, s92
buffer_load_dwordx4 v2, s[16:19], s54 offen  lds
s_add_u32 s94, s49, 5
s_sub_u32 s54, s94, 7
s_cmp_ge_u32 s94, 7
s_cselect_b32 s94, s54, s94
s_mul_i32 s54, s94, s93
s_add_u32 s54, s54, s75
s_add_u32 m0, s53, 90112
s_nop 0
buffer_load_dwordx4 v2, s[16:19], s54 offen  lds
s_add_u32 m0, s53, 91136
s_add_u32 s54, s54, s92
buffer_load_dwordx4 v2, s[16:19], s54 offen  lds
s_lshr_b32 s54, s46, 3
s_mul_i32 s54, s54, 0
s_mul_i32 s55, s48, 3
s_add_u32 s54, s54, s55
s_sub_u32 s55, s54, 7
s_cmp_ge_u32 s54, 7
s_cselect_b32 s54, s55, s54
s_sub_u32 s55, s54, 7
s_cmp_ge_u32 s54, 7
s_cselect_b32 s54, s55, s54
s_mov_b32 s99, s54
s_lshl_b32 s74, s100, 12
s_lshl_b32 s71, s46, 7
s_mul_i32 s54, s3, 57344
s_add_u32 s72, s71, s54
s_sub_u32 s73, 57344, s54
s_add_u32 s73, s73, s71
s_waitcnt vmcnt(7)
s_barrier
s_add_u32 s94, s49, 6
s_sub_u32 s54, s94, 7
s_cmp_ge_u32 s94, 7
s_cselect_b32 s94, s54, s94
s_mul_i32 s54, s94, s93
s_add_u32 s54, s54, s75
s_add_u32 m0, s53, 98304
s_nop 0
buffer_load_dwordx4 v2, s[16:19], s54 offen  lds
s_add_u32 m0, s53, 99328
s_add_u32 s54, s54, s92
buffer_load_dwordx4 v2, s[16:19], s54 offen  lds
s_add_u32 s94, s49, 0
s_sub_u32 s54, s94, 7
s_cmp_ge_u32 s94, 7
s_cselect_b32 s94, s54, s94
s_mul_i32 s54, s94, 172032
s_add_u32 s54, s54, s40
s_add_u32 m0, s53, 106496
s_nop 0
buffer_load_dwordx4 v1, s[8:11], s54 offen  lds
s_add_u32 m0, s53, 107520
s_add_u32 s54, s54, 21504
buffer_load_dwordx4 v1, s[8:11], s54 offen  lds
s_add_u32 s94, s49, 1
s_sub_u32 s54, s94, 7
s_cmp_ge_u32 s94, 7
s_cselect_b32 s94, s54, s94
s_mul_i32 s54, s94, 172032
s_add_u32 s54, s54, s40
s_add_u32 m0, s53, 114688
s_nop 0
buffer_load_dwordx4 v1, s[8:11], s54 offen  lds
s_add_u32 m0, s53, 115712
s_add_u32 s54, s54, 21504
buffer_load_dwordx4 v1, s[8:11], s54 offen  lds
v_mov_b32 v8, 0x40000000
v_mov_b32 v20, 0
v_mov_b32 v21, 0
v_mov_b32 v22, 0
v_mov_b32 v23, 0
v_lshrrev_b32 v9, 3, v0
v_and_b32 v10, 7, v0
v_lshlrev_b32 v10, 4, v10
v_lshl_add_u32 v11, v9, 12, v10
v_and_b32 v13, 3, v9
v_lshl_add_u32 v13, v13, 12, v10
v_lshrrev_b32 v9, 2, v9
v_lshl_add_u32 v13, v9, 7, v13
s_cmp_eq_u32 s50, 1
s_cselect_b64 vcc, -1, 0
s_lshl_b32 s54, s52, 7
s_lshl_b32 s55, s47, 8
s_add_u32 s55, s55, 18432
v_cndmask_b32 v11, v11, v13, vcc
s_cmp_eq_u32 s50, 1
s_cselect_b32 s54, s55, s54
s_lshl_b32 s55, s45, 15
s_add_u32 s54, s54, s55
s_add_u32 s54, s54, 10551296
s_cmp_eq_u32 s100, 1
s_cselect_b64 vcc, -1, 0
v_cndmask_b32 v11, v8, v11, vcc
buffer_store_dwordx4 v[20:23], v11, s[36:39], s54 offen sc1
v_and_b32 v9, 7, v0
v_lshlrev_b32 v9, 4, v9
v_cmp_gt_u32 vcc, 8, v0
s_lshl_b32 s54, s101, 11
s_add_u32 s54, s54, 11536256
v_cndmask_b32 v9, v8, v9, vcc
buffer_store_dwordx4 v[20:23], v9, s[36:39], s54 offen sc1
v_lshrrev_b32 v9, 4, v0
v_lshlrev_b32 v9, 10, v9
v_and_b32 v10, 15, v0
v_lshl_add_u32 v9, v10, 4, v9
s_lshl_b32 s54, s50, 5
v_cmp_gt_u32 vcc, s54, v0
s_lshl_b32 s54, s45, 1
s_add_u32 s54, s54, s47
v_cndmask_b32 v9, v8, v9, vcc
s_lshl_b32 s54, s54, 11
s_lshl_b32 s55, s100, 8
s_add_u32 s54, s54, s55
s_add_u32 s54, s54, 10485760
buffer_store_dwordx4 v[20:23], v9, s[36:39], s54 offen sc1
v_mov_b32 v12, 0
buffer_load_dword v191, v12, s[32:35], 0 offen sc1
s_cmp_eq_u32 s50, 1
s_cbranch_scc1 L_HrA
s_waitcnt vmcnt(10)
s_barrier
s_lshr_b32 s54, s46, 3
s_mul_i32 s54, s54, 0
s_mul_i32 s55, s48, 3
s_add_u32 s54, s54, s55
s_sub_u32 s55, s54, 7
s_cmp_ge_u32 s54, 7
s_cselect_b32 s54, s55, s54
s_sub_u32 s55, s54, 7
s_cmp_ge_u32 s54, 7
s_cselect_b32 s54, s55, s54
s_mov_b32 s99, s54
s_lshl_b32 s74, s100, 12
s_lshl_b32 s71, s46, 7
s_mul_i32 s54, s3, 57344
s_add_u32 s72, s71, s54
s_sub_u32 s73, 57344, s54
s_add_u32 s73, s73, s71
v_and_b32 v8, 15, v0
v_lshrrev_b32 v9, 2, v8
v_lshrrev_b32 v184, 5, v0
v_mul_u32_u24 v184, 4, v184
v_add_u32 v184, v184, v9
v_lshlrev_b32 v184, 7, v184
v_and_b32 v8, 3, v0
v_lshrrev_b32 v9, 2, v0
v_and_b32 v9, 4, v9
v_add_u32 v8, v8, v9
v_lshlrev_b32 v8, 3, v8
v_lshlrev_b32 v9, 3, v0
v_and_b32 v9, 64, v9
v_xor_b32 v8, v8, v9
v_add_u32 v184, v184, v8
v_add_u32 v184, s74, v184
v_xor_b32 v185, 64, v184
s_add_u32 s94, s49, 2
s_sub_u32 s54, s94, 7
s_cmp_ge_u32 s94, 7
s_cselect_b32 s94, s54, s94
s_mul_i32 s54, s94, 172032
s_add_u32 s54, s54, s40
s_add_u32 m0, s53, 122880
s_nop 0
buffer_load_dwordx4 v1, s[8:11], s54 offen  lds
s_add_u32 m0, s53, 123904
s_add_u32 s54, s54, 21504
buffer_load_dwordx4 v1, s[8:11], s54 offen  lds
s_add_u32 s94, s49, 3
s_sub_u32 s54, s94, 7
s_cmp_ge_u32 s94, 7
s_cselect_b32 s94, s54, s94
s_mul_i32 s54, s94, 172032
s_add_u32 s54, s54, s40
s_add_u32 m0, s53, 131072
s_nop 0
buffer_load_dwordx4 v1, s[8:11], s54 offen  lds
s_add_u32 m0, s53, 132096
s_add_u32 s54, s54, 21504
buffer_load_dwordx4 v1, s[8:11], s54 offen  lds
s_add_u32 s94, s49, 4
s_sub_u32 s54, s94, 7
s_cmp_ge_u32 s94, 7
s_cselect_b32 s94, s54, s94
s_mul_i32 s54, s94, 172032
s_add_u32 s54, s54, s40
s_add_u32 m0, s53, 139264
s_nop 0
buffer_load_dwordx4 v1, s[8:11], s54 offen  lds
s_add_u32 m0, s53, 140288
s_add_u32 s54, s54, 21504
buffer_load_dwordx4 v1, s[8:11], s54 offen  lds
s_lshl_b32 s57, s45, 1
s_add_u32 s57, s57, s47
s_mul_i32 s57, s57, 294912
s_mul_i32 s54, s100, 7
s_add_u32 s54, s54, s99
s_sub_u32 s55, s54, 28
s_cmp_ge_u32 s54, 28
s_cselect_b32 s54, s55, s54
s_lshr_b32 s55, s54, 1
s_lshl_b32 s55, s55, 13
s_and_b32 s56, s54, 1
s_lshl_b32 s56, s56, 11
s_add_u32 s55, s55, s56
s_add_u32 s60, s55, s57
s_mul_i32 s54, s100, 7
s_add_u32 s54, s54, s99
s_add_u32 s54, s54, 1
s_sub_u32 s55, s54, 28
s_cmp_ge_u32 s54, 28
s_cselect_b32 s54, s55, s54
s_lshr_b32 s55, s54, 1
s_lshl_b32 s55, s55, 13
s_and_b32 s56, s54, 1
s_lshl_b32 s56, s56, 11
s_add_u32 s55, s55, s56
s_add_u32 s61, s55, s57
s_mul_i32 s54, s100, 7
s_add_u32 s54, s54, s99
s_add_u32 s54, s54, 2
s_sub_u32 s55, s54, 28
s_cmp_ge_u32 s54, 28
s_cselect_b32 s54, s55, s54
s_lshr_b32 s55, s54, 1
s_lshl_b32 s55, s55, 13
s_and_b32 s56, s54, 1
s_lshl_b32 s56, s56, 11
s_add_u32 s55, s55, s56
s_add_u32 s62, s55, s57
s_mul_i32 s54, s100, 7
s_add_u32 s54, s54, s99
s_add_u32 s54, s54, 3
s_sub_u32 s55, s54, 28
s_cmp_ge_u32 s54, 28
s_cselect_b32 s54, s55, s54
s_lshr_b32 s55, s54, 1
s_lshl_b32 s55, s55, 13
s_and_b32 s56, s54, 1
s_lshl_b32 s56, s56, 11
s_add_u32 s55, s55, s56
s_add_u32 s63, s55, s57
s_mul_i32 s54, s100, 7
s_add_u32 s54, s54, s99
s_add_u32 s54, s54, 4
s_sub_u32 s55, s54, 28
s_cmp_ge_u32 s54, 28
s_cselect_b32 s54, s55, s54
s_lshr_b32 s55, s54, 1
s_lshl_b32 s55, s55, 13
s_and_b32 s56, s54, 1
s_lshl_b32 s56, s56, 11
s_add_u32 s55, s55, s56
s_add_u32 s64, s55, s57
s_mul_i32 s54, s100, 7
s_add_u32 s54, s54, s99
s_add_u32 s54, s54, 5
s_sub_u32 s55, s54, 28
s_cmp_ge_u32 s54, 28
s_cselect_b32 s54, s55, s54
s_lshr_b32 s55, s54, 1
s_lshl_b32 s55, s55, 13
s_and_b32 s56, s54, 1
s_lshl_b32 s56, s56, 11
s_add_u32 s55, s55, s56
s_add_u32 s65, s55, s57
s_mul_i32 s54, s100, 7
s_add_u32 s54, s54, s99
s_add_u32 s54, s54, 6
s_sub_u32 s55, s54, 28
s_cmp_ge_u32 s54, 28
s_cselect_b32 s54, s55, s54
s_lshr_b32 s55, s54, 1
s_lshl_b32 s55, s55, 13
s_and_b32 s56, s54, 1
s_lshl_b32 s56, s56, 11
s_add_u32 s55, s55, s56
s_add_u32 s66, s55, s57
s_mul_i32 s54, s100, 4
s_add_u32 s54, s54, s99
s_and_b32 s54, s54, 15
s_lshl_b32 s55, s54, 11
s_add_u32 s55, s55, s57
s_add_u32 s67, s55, 114688
s_mul_i32 s54, s100, 4
s_add_u32 s54, s54, s99
s_add_u32 s54, s54, 1
s_and_b32 s54, s54, 15
s_lshl_b32 s55, s54, 11
s_add_u32 s55, s55, s57
s_add_u32 s68, s55, 114688
s_mul_i32 s54, s100, 4
s_add_u32 s54, s54, s99
s_add_u32 s54, s54, 2
s_and_b32 s54, s54, 15
s_lshl_b32 s55, s54, 11
s_add_u32 s55, s55, s57
s_add_u32 s69, s55, 114688
s_mul_i32 s54, s100, 4
s_add_u32 s54, s54, s99
s_add_u32 s54, s54, 3
s_and_b32 s54, s54, 15
s_lshl_b32 s55, s54, 11
s_add_u32 s55, s55, s57
s_add_u32 s70, s55, 114688
s_waitcnt vmcnt(4)
s_barrier
v_cmp_eq_u32 vcc, 0, v191
s_nop 1
s_cbranch_vccz L_tagG_x
s_mov_b32 s58, 0
v_mov_b32 v12, 0
L_tagG:
buffer_load_dword v191, v12, s[32:35], 0 offen sc1
s_add_u32 s58, s58, 1
s_waitcnt vmcnt(0)
v_cmp_eq_u32 vcc, 0, v191
s_cmp_gt_u32 s58, 0x40000
s_cbranch_scc1 L_tagG_x
s_cbranch_vccnz L_tagG
L_tagG_x:
s_add_u32 s94, s49, 5
s_sub_u32 s54, s94, 7
s_cmp_ge_u32 s94, 7
s_cselect_b32 s94, s54, s94
s_mul_i32 s54, s94, 172032
s_add_u32 s54, s54, s40
s_add_u32 m0, s53, 147456
s_nop 0
buffer_load_dwordx4 v1, s[8:11], s54 offen  lds
s_add_u32 m0, s53, 148480
s_add_u32 s54, s54, 21504
buffer_load_dwordx4 v1, s[8:11], s54 offen  lds
s_add_u32 s94, s49, 6
s_sub_u32 s54, s94, 7
s_cmp_ge_u32 s94, 7
s_cselect_b32 s94, s54, s94
s_mul_i32 s54, s94, 172032
s_add_u32 s54, s54, s40
s_add_u32 m0, s53, 155648
s_nop 0
buffer_load_dwordx4 v1, s[8:11], s54 offen  lds
s_add_u32 m0, s53, 156672
s_add_u32 s54, s54, 21504
buffer_load_dwordx4 v1, s[8:11], s54 offen  lds
s_add_u32 s94, s49, 0
s_sub_u32 s54, s94, 7
s_cmp_ge_u32 s94, 7
s_cselect_b32 s94, s54, s94
s_mul_i32 s54, s94, s93
s_add_u32 s54, s54, s41
s_add_u32 m0, s53, 49152
s_nop 0
buffer_load_dwordx4 v2, s[20:23], s54 offen  lds
s_add_u32 m0, s53, 50176
s_add_u32 s54, s54, s92
buffer_load_dwordx4 v2, s[20:23], s54 offen  lds
s_add_u32 s94, s49, 1
s_sub_u32 s54, s94, 7
s_cmp_ge_u32 s94, 7
s_cselect_b32 s94, s54, s94
s_mul_i32 s54, s94, s93
s_add_u32 s54, s54, s41
s_add_u32 m0, s53, 57344
s_nop 0
buffer_load_dwordx4 v2, s[20:23], s54 offen  lds
s_add_u32 m0, s53, 58368
s_add_u32 s54, s54, s92
buffer_load_dwordx4 v2, s[20:23], s54 offen  lds
s_add_u32 s94, s49, 2
s_sub_u32 s54, s94, 7
s_cmp_ge_u32 s94, 7
s_cselect_b32 s94, s54, s94
s_mul_i32 s54, s94, s93
s_add_u32 s54, s54, s41
s_add_u32 m0, s53, 65536
s_nop 0
buffer_load_dwordx4 v2, s[20:23], s54 offen  lds
s_add_u32 m0, s53, 66560
s_add_u32 s54, s54, s92
buffer_load_dwordx4 v2, s[20:23], s54 offen  lds
s_mul_i32 s55, s45, 28
v_add_u32 v8, s55, v0
v_mul_u32_u24 v8, 3584, v8
s_mul_i32 s56, s100, 57344
s_sub_u32 s56, s42, s56
s_cmp_eq_u32 s100, 3
s_cselect_b32 s55, 28, 0
s_cmp_eq_u32 s50, 1
s_cselect_b32 s55, 0, s55
v_mov_b32 v9, 0x40000000
v_cmp_gt_u32 vcc, s55, v0
s_nop 1
v_cndmask_b32 v8, v9, v8, vcc
buffer_load_dword v54, v8, s[16:19], s56 offen
s_mul_i32 s54, s100, 7
s_add_u32 s54, s54, s99
s_sub_u32 s55, s54, 28
s_cmp_ge_u32 s54, 28
s_cselect_b32 s54, s55, s54
s_lshr_b32 s55, s54, 1
s_mul_i32 s55, s55, 114688
s_and_b32 s56, s54, 1
s_mul_i32 s56, s56, 28672
s_add_u32 s55, s55, s56
s_add_u32 s55, s55, s72
s_add_u32 m0, s74, 0
s_nop 0
buffer_load_dwordx4 v3, s[24:27], s55 offen  lds
s_add_u32 m0, s74, 1024
s_add_u32 s55, s55, 7168
buffer_load_dwordx4 v3, s[24:27], s55 offen  lds
s_add_u32 m0, s74, 2048
s_add_u32 s55, s55, 7168
buffer_load_dwordx4 v3, s[24:27], s55 offen  lds
s_add_u32 m0, s74, 3072
s_add_u32 s55, s55, 7168
buffer_load_dwordx4 v3, s[24:27], s55 offen  lds
s_waitcnt vmcnt(13)
s_barrier
s_add_u32 s94, s49, 3
s_sub_u32 s54, s94, 7
s_cmp_ge_u32 s94, 7
s_cselect_b32 s94, s54, s94
s_mul_i32 s54, s94, s93
s_add_u32 s54, s54, s41
s_add_u32 m0, s53, 73728
s_nop 0
buffer_load_dwordx4 v2, s[20:23], s54 offen  lds
s_add_u32 m0, s53, 74752
s_add_u32 s54, s54, s92
buffer_load_dwordx4 v2, s[20:23], s54 offen  lds
s_add_u32 s94, s49, 4
s_sub_u32 s54, s94, 7
s_cmp_ge_u32 s94, 7
s_cselect_b32 s94, s54, s94
s_mul_i32 s54, s94, s93
s_add_u32 s54, s54, s41
s_add_u32 m0, s53, 81920
s_nop 0
buffer_load_dwordx4 v2, s[20:23], s54 offen  lds
s_add_u32 m0, s53, 82944
s_add_u32 s54, s54, s92
buffer_load_dwordx4 v2, s[20:23], s54 offen  lds
s_add_u32 s94, s49, 5
s_sub_u32 s54, s94, 7
s_cmp_ge_u32 s94, 7
s_cselect_b32 s94, s54, s94
s_mul_i32 s54, s94, s93
s_add_u32 s54, s54, s41
s_add_u32 m0, s53, 90112
s_nop 0
buffer_load_dwordx4 v2, s[20:23], s54 offen  lds
s_add_u32 m0, s53, 91136
s_add_u32 s54, s54, s92
buffer_load_dwordx4 v2, s[20:23], s54 offen  lds
s_add_u32 s94, s49, 6
s_sub_u32 s54, s94, 7
s_cmp_ge_u32 s94, 7
s_cselect_b32 s94, s54, s94
s_mul_i32 s54, s94, s93
s_add_u32 s54, s54, s41
s_add_u32 m0, s53, 98304
s_nop 0
buffer_load_dwordx4 v2, s[20:23], s54 offen  lds
s_add_u32 m0, s53, 99328
s_add_u32 s54, s54, s92
buffer_load_dwordx4 v2, s[20:23], s54 offen  lds
s_waitcnt vmcnt(13)
s_barrier
s_waitcnt vmcnt(8)
ds_read_b64_tr_b16 v[56:57], v184 offset:0
ds_read_b64_tr_b16 v[58:59], v184 offset:1024
ds_read_b64_tr_b16 v[60:61], v185 offset:0
ds_read_b64_tr_b16 v[62:63], v185 offset:1024
ds_read_b64_tr_b16 v[64:65], v184 offset:2048
ds_read_b64_tr_b16 v[66:67], v184 offset:3072
ds_read_b64_tr_b16 v[68:69], v185 offset:2048
ds_read_b64_tr_b16 v[70:71], v185 offset:3072
s_add_u32 s94, s49, 0
s_sub_u32 s54, s94, 7
s_cmp_ge_u32 s94, 7
s_cselect_b32 s94, s54, s94
s_mul_i32 s54, s94, s93
s_add_u32 s54, s54, s42
s_add_u32 m0, s53, 106496
s_nop 0
buffer_load_dwordx4 v2, s[16:19], s54 offen  lds
s_add_u32 m0, s53, 107520
s_add_u32 s54, s54, s92
buffer_load_dwordx4 v2, s[16:19], s54 offen  lds
s_add_u32 s94, s49, 1
s_sub_u32 s54, s94, 7
s_cmp_ge_u32 s94, 7
s_cselect_b32 s94, s54, s94
s_mul_i32 s54, s94, s93
s_add_u32 s54, s54, s42
s_add_u32 m0, s53, 114688
s_nop 0
buffer_load_dwordx4 v2, s[16:19], s54 offen  lds
s_add_u32 m0, s53, 115712
s_add_u32 s54, s54, s92
buffer_load_dwordx4 v2, s[16:19], s54 offen  lds
s_add_u32 s94, s49, 2
s_sub_u32 s54, s94, 7
s_cmp_ge_u32 s94, 7
s_cselect_b32 s94, s54, s94
s_mul_i32 s54, s94, s93
s_add_u32 s54, s54, s42
s_add_u32 m0, s53, 122880
s_nop 0
buffer_load_dwordx4 v2, s[16:19], s54 offen  lds
s_add_u32 m0, s53, 123904
s_add_u32 s54, s54, s92
buffer_load_dwordx4 v2, s[16:19], s54 offen  lds
s_lshl_b32 s54, s45, 1
s_add_u32 s54, s54, s47
s_mul_i32 s55, s54, 28
v_add_u32 v8, s55, v0
v_lshrrev_b32 v9, 6, v8
v_lshlrev_b32 v9, 6, v9
v_add_u32 v8, v8, v9
v_mul_u32_u24 v8, 896, v8
s_cmp_eq_u32 s100, 1
s_cselect_b32 s55, 28, 0
s_cmp_eq_u32 s50, 1
s_cselect_b32 s55, 0, s55
v_mov_b32 v9, 0x40000000
v_cmp_gt_u32 vcc, s55, v0
s_nop 1
v_cndmask_b32 v8, v9, v8, vcc
buffer_load_dword v54, v8, s[24:27], s73 offen
s_lshl_b32 s54, s45, 1
s_add_u32 s54, s54, s47
s_mul_i32 s55, s54, 14
v_add_u32 v8, s55, v0
v_mul_u32_u24 v8, 896, v8
s_cmp_eq_u32 s100, 2
s_cselect_b32 s55, 14, 0
s_cmp_eq_u32 s50, 1
s_cselect_b32 s55, 0, s55
v_mov_b32 v9, 0x40000000
v_cmp_gt_u32 vcc, s55, v0
s_nop 1
v_cndmask_b32 v8, v9, v8, vcc
buffer_load_dword v54, v8, s[12:15], s71 offen
s_mul_i32 s55, s45, 28
v_add_u32 v8, s55, v0
v_mul_u32_u24 v8, 3584, v8
s_mul_i32 s56, s100, 57344
s_sub_u32 s56, s43, s56
s_cmp_eq_u32 s100, 0
s_cselect_b32 s55, 28, 0
s_cmp_eq_u32 s50, 1
s_cselect_b32 s55, 0, s55
v_mov_b32 v9, 0x40000000
v_cmp_gt_u32 vcc, s55, v0
s_nop 1
v_cndmask_b32 v8, v9, v8, vcc
buffer_load_dword v54, v8, s[20:23], s56 offen
s_waitcnt lgkmcnt(0)
s_mul_i32 s54, s100, 7
s_add_u32 s54, s54, s99
s_add_u32 s54, s54, 1
s_sub_u32 s55, s54, 28
s_cmp_ge_u32 s54, 28
s_cselect_b32 s54, s55, s54
s_lshr_b32 s55, s54, 1
s_mul_i32 s55, s55, 114688
s_and_b32 s56, s54, 1
s_mul_i32 s56, s56, 28672
s_add_u32 s55, s55, s56
s_add_u32 s55, s55, s72
s_add_u32 m0, s74, 0
s_nop 0
buffer_load_dwordx4 v3, s[24:27], s55 offen  lds
s_add_u32 m0, s74, 1024
s_add_u32 s55, s55, 7168
buffer_load_dwordx4 v3, s[24:27], s55 offen  lds
s_add_u32 m0, s74, 2048
s_add_u32 s55, s55, 7168
buffer_load_dwordx4 v3, s[24:27], s55 offen  lds
s_add_u32 m0, s74, 3072
s_add_u32 s55, s55, 7168
buffer_load_dwordx4 v3, s[24:27], s55 offen  lds
s_mul_i32 s54, s100, 7
s_add_u32 s54, s54, s99
s_add_u32 s54, s54, 2
s_sub_u32 s55, s54, 28
s_cmp_ge_u32 s54, 28
s_cselect_b32 s54, s55, s54
s_lshr_b32 s55, s54, 1
s_mul_i32 s55, s55, 114688
s_and_b32 s56, s54, 1
s_mul_i32 s56, s56, 28672
s_add_u32 s55, s55, s56
s_add_u32 s55, s55, s72
s_add_u32 m0, s74, 16384
s_nop 0
buffer_load_dwordx4 v3, s[24:27], s55 offen  lds
s_add_u32 m0, s74, 17408
s_add_u32 s55, s55, 7168
buffer_load_dwordx4 v3, s[24:27], s55 offen  lds
s_add_u32 m0, s74, 18432
s_add_u32 s55, s55, 7168
buffer_load_dwordx4 v3, s[24:27], s55 offen  lds
s_add_u32 m0, s74, 19456
s_add_u32 s55, s55, 7168
buffer_load_dwordx4 v3, s[24:27], s55 offen  lds
s_waitcnt vmcnt(19)
s_barrier
s_waitcnt vmcnt(4)
ds_read_b64_tr_b16 v[72:73], v184 offset:0
ds_read_b64_tr_b16 v[74:75], v184 offset:1024
ds_read_b64_tr_b16 v[76:77], v185 offset:0
ds_read_b64_tr_b16 v[78:79], v185 offset:1024
ds_read_b64_tr_b16 v[80:81], v184 offset:2048
ds_read_b64_tr_b16 v[82:83], v184 offset:3072
ds_read_b64_tr_b16 v[84:85], v185 offset:2048
ds_read_b64_tr_b16 v[86:87], v185 offset:3072
s_waitcnt vmcnt(0)
ds_read_b64_tr_b16 v[88:89], v184 offset:16384
ds_read_b64_tr_b16 v[90:91], v184 offset:17408
ds_read_b64_tr_b16 v[92:93], v185 offset:16384
ds_read_b64_tr_b16 v[94:95], v185 offset:17408
ds_read_b64_tr_b16 v[96:97], v184 offset:18432
ds_read_b64_tr_b16 v[98:99], v184 offset:19456
ds_read_b64_tr_b16 v[100:101], v185 offset:18432
ds_read_b64_tr_b16 v[102:103], v185 offset:19456
s_add_u32 s94, s49, 3
s_sub_u32 s54, s94, 7
s_cmp_ge_u32 s94, 7
s_cselect_b32 s94, s54, s94
s_mul_i32 s54, s94, s93
s_add_u32 s54, s54, s42
s_add_u32 m0, s53, 131072
s_nop 0
buffer_load_dwordx4 v2, s[16:19], s54 offen  lds
s_add_u32 m0, s53, 132096
s_add_u32 s54, s54, s92
buffer_load_dwordx4 v2, s[16:19], s54 offen  lds
s_add_u32 s94, s49, 4
s_sub_u32 s54, s94, 7
s_cmp_ge_u32 s94, 7
s_cselect_b32 s94, s54, s94
s_mul_i32 s54, s94, s93
s_add_u32 s54, s54, s42
s_add_u32 m0, s53, 139264
s_nop 0
buffer_load_dwordx4 v2, s[16:19], s54 offen  lds
s_add_u32 m0, s53, 140288
s_add_u32 s54, s54, s92
buffer_load_dwordx4 v2, s[16:19], s54 offen  lds
s_add_u32 s94, s49, 5
s_sub_u32 s54, s94, 7
s_cmp_ge_u32 s94, 7
s_cselect_b32 s94, s54, s94
s_mul_i32 s54, s94, s93
s_add_u32 s54, s54, s42
s_add_u32 m0, s53, 147456
s_nop 0
buffer_load_dwordx4 v2, s[16:19], s54 offen  lds
s_add_u32 m0, s53, 148480
s_add_u32 s54, s54, s92
buffer_load_dwordx4 v2, s[16:19], s54 offen  lds
s_add_u32 s94, s49, 6
s_sub_u32 s54, s94, 7
s_cmp_ge_u32 s94, 7
s_cselect_b32 s94, s54, s94
s_mul_i32 s54, s94, s93
s_add_u32 s54, s54, s42
s_add_u32 m0, s53, 155648
s_nop 0
buffer_load_dwordx4 v2, s[16:19], s54 offen  lds
s_add_u32 m0, s53, 156672
s_add_u32 s54, s54, s92
buffer_load_dwordx4 v2, s[16:19], s54 offen  lds
s_waitcnt lgkmcnt(0)
s_barrier
s_lshl_b32 s54, s100, 12
s_add_u32 s55, s54, 32768
v_add_u32 v11, s55, v4
ds_read_b128 v[16:19], v11 offset:0
ds_read_b128 v[20:23], v11 offset:1024
ds_read_b128 v[24:27], v11 offset:2048
ds_read_b128 v[28:31], v11 offset:3072
s_lshl_b32 s54, s101, 11
s_add_u32 s54, s54, 11534336
s_waitcnt lgkmcnt(2)
v_add_f32 v16, v16, v20
v_add_f32 v17, v17, v21
v_add_f32 v18, v18, v22
v_add_f32 v19, v19, v23
s_waitcnt lgkmcnt(0)
v_add_f32 v24, v24, v28
v_add_f32 v25, v25, v29
v_add_f32 v26, v26, v30
v_add_f32 v27, v27, v31
v_add_f32 v32, v16, v24
v_mov_b32 v33, v191
v_add_f32 v34, v17, v25
v_mov_b32 v35, v191
v_add_f32 v36, v18, v26
v_mov_b32 v37, v191
v_add_f32 v38, v19, v27
v_mov_b32 v39, v191
buffer_store_dwordx4 v[32:35], v4, s[36:39], s54 offen offset:0 sc1
buffer_store_dwordx4 v[36:39], v4, s[36:39], s54 offen offset:1024 sc1
s_add_u32 s94, s49, 0
s_sub_u32 s54, s94, 7
s_cmp_ge_u32 s94, 7
s_cselect_b32 s94, s54, s94
s_mul_i32 s54, s94, s93
s_add_u32 s54, s54, s43
s_add_u32 m0, s53, 49152
s_nop 0
buffer_load_dwordx4 v2, s[20:23], s54 offen  lds
s_add_u32 m0, s53, 50176
s_add_u32 s54, s54, s92
buffer_load_dwordx4 v2, s[20:23], s54 offen  lds
s_add_u32 s94, s49, 1
s_sub_u32 s54, s94, 7
s_cmp_ge_u32 s94, 7
s_cselect_b32 s94, s54, s94
s_mul_i32 s54, s94, s93
s_add_u32 s54, s54, s43
s_add_u32 m0, s53, 57344
s_nop 0
buffer_load_dwordx4 v2, s[20:23], s54 offen  lds
s_add_u32 m0, s53, 58368
s_add_u32 s54, s54, s92
buffer_load_dwordx4 v2, s[20:23], s54 offen  lds
s_add_u32 s94, s49, 2
s_sub_u32 s54, s94, 7
s_cmp_ge_u32 s94, 7
s_cselect_b32 s94, s54, s94
s_mul_i32 s54, s94, s93
s_add_u32 s54, s54, s43
s_add_u32 m0, s53, 65536
s_nop 0
buffer_load_dwordx4 v2, s[20:23], s54 offen  lds
s_add_u32 m0, s53, 66560
s_add_u32 s54, s54, s92
buffer_load_dwordx4 v2, s[20:23], s54 offen  lds
s_add_u32 s94, s49, 3
s_sub_u32 s54, s94, 7
s_cmp_ge_u32 s94, 7
s_cselect_b32 s94, s54, s94
s_mul_i32 s54, s94, s93
s_add_u32 s54, s54, s43
s_add_u32 m0, s53, 73728
s_nop 0
buffer_load_dwordx4 v2, s[20:23], s54 offen  lds
s_add_u32 m0, s53, 74752
s_add_u32 s54, s54, s92
buffer_load_dwordx4 v2, s[20:23], s54 offen  lds
s_add_u32 s94, s49, 4
s_sub_u32 s54, s94, 7
s_cmp_ge_u32 s94, 7
s_cselect_b32 s94, s54, s94
s_mul_i32 s54, s94, s93
s_add_u32 s54, s54, s43
s_add_u32 m0, s53, 81920
s_nop 0
buffer_load_dwordx4 v2, s[20:23], s54 offen  lds
s_add_u32 m0, s53, 82944
s_add_u32 s54, s54, s92
buffer_load_dwordx4 v2, s[20:23], s54 offen  lds
s_waitcnt vmcnt(14)
s_barrier
s_add_u32 s94, s49, 5
s_sub_u32 s54, s94, 7
s_cmp_ge_u32 s94, 7
s_cselect_b32 s94, s54, s94
s_mul_i32 s54, s94, s93
s_add_u32 s54, s54, s43
s_add_u32 m0, s53, 90112
s_nop 0
buffer_load_dwordx4 v2, s[20:23], s54 offen  lds
s_add_u32 m0, s53, 91136
s_add_u32 s54, s54, s92
buffer_load_dwordx4 v2, s[20:23], s54 offen  lds
s_add_u32 s94, s49, 6
s_sub_u32 s54, s94, 7
s_cmp_ge_u32 s94, 7
s_cselect_b32 s94, s54, s94
s_mul_i32 s54, s94, s93
s_add_u32 s54, s54, s43
s_add_u32 m0, s53, 98304
s_nop 0
buffer_load_dwordx4 v2, s[20:23], s54 offen  lds
s_add_u32 m0, s53, 99328
s_add_u32 s54, s54, s92
buffer_load_dwordx4 v2, s[20:23], s54 offen  lds
s_mul_i32 s54, s100, 7
s_add_u32 s54, s54, s99
s_add_u32 s54, s54, 3
s_sub_u32 s55, s54, 28
s_cmp_ge_u32 s54, 28
s_cselect_b32 s54, s55, s54
s_lshr_b32 s55, s54, 1
s_mul_i32 s55, s55, 114688
s_and_b32 s56, s54, 1
s_mul_i32 s56, s56, 28672
s_add_u32 s55, s55, s56
s_add_u32 s55, s55, s72
s_add_u32 m0, s74, 0
s_nop 0
buffer_load_dwordx4 v3, s[24:27], s55 offen  lds
s_add_u32 m0, s74, 1024
s_add_u32 s55, s55, 7168
buffer_load_dwordx4 v3, s[24:27], s55 offen  lds
s_add_u32 m0, s74, 2048
s_add_u32 s55, s55, 7168
buffer_load_dwordx4 v3, s[24:27], s55 offen  lds
s_add_u32 m0, s74, 3072
s_add_u32 s55, s55, 7168
buffer_load_dwordx4 v3, s[24:27], s55 offen  lds
v_lshlrev_b32 v186, 4, v0
v_add_u32 v187, 147456, v186
s_lshl_b32 s54, s3, 12
v_add_u32 v1, s54, v186
v_xor_b32 v5, 4096, v1
v_add_u32 v2, 147456, v1
v_add_u32 v6, 147456, v5
s_mul_i32 s54, s100, 7
s_add_u32 s54, s54, s99
s_sub_u32 s55, s54, 28
s_cmp_ge_u32 s54, 28
s_cselect_b32 s54, s55, s54
s_lshr_b32 s54, s54, 1
v_lshlrev_b32 v8, 7, v0
v_and_b32 v9, 31, v0
v_subrev_u32 v10, s54, v9
v_add_u32 v11, 14, v10
v_min_u32 v10, v10, v11
v_cmp_gt_u32 s[40:41], 4, v10
v_cmp_gt_u32 vcc, 14, v9
v_mov_b32 v11, 0x40000000
s_nop 0
s_and_b64 s[40:41], s[40:41], vcc
v_cndmask_b32 v188, v11, v8, s[40:41]
s_mul_i32 s54, s100, 4
s_add_u32 s54, s54, s99
s_and_b32 s54, s54, 15
s_and_b32 s55, s54, 3
s_cmp_eq_u32 s55, 0
s_cselect_b32 s55, 1, 2
s_lshr_b32 s54, s54, 2
v_subrev_u32 v10, s54, v9
v_and_b32 v10, 3, v10
v_cmp_gt_u32 s[42:43], s55, v10
v_lshrrev_b32 v9, 2, v9
v_cmp_eq_u32 vcc, 4, v9
s_nop 1
s_and_b64 s[42:43], s[42:43], vcc
v_cndmask_b32 v189, v11, v8, s[42:43]
s_lshl_b32 s75, s45, 15
s_lshl_b32 s54, s47, 13
s_add_u32 s75, s75, s54
s_add_u32 s75, s75, 10551296
v_lshrrev_b32 v8, 3, v0
v_mul_u32_u24 v8, 896, v8
v_and_b32 v9, 7, v0
v_lshl_add_u32 v7, v9, 4, v8
s_lshl_b32 s54, s45, 7
s_lshl_b32 s55, s47, 6
s_add_u32 s54, s54, s55
s_lshl_b32 s55, s44, 3
s_add_u32 s54, s54, s55
s_mul_i32 s54, s54, 896
s_lshl_b32 s55, s46, 7
s_add_u32 s59, s54, s55
buffer_load_dwordx4 v[12:15], v7, s[4:7], s59 offen
s_waitcnt vmcnt(5)
s_barrier
s_waitcnt vmcnt(1)
ds_read_b64_tr_b16 v[104:105], v184 offset:0
ds_read_b64_tr_b16 v[106:107], v184 offset:1024
ds_read_b64_tr_b16 v[108:109], v185 offset:0
ds_read_b64_tr_b16 v[110:111], v185 offset:1024
ds_read_b64_tr_b16 v[112:113], v184 offset:2048
ds_read_b64_tr_b16 v[114:115], v184 offset:3072
ds_read_b64_tr_b16 v[116:117], v185 offset:2048
ds_read_b64_tr_b16 v[118:119], v185 offset:3072
s_waitcnt lgkmcnt(0)
s_mul_i32 s54, s100, 7
s_add_u32 s54, s54, s99
s_add_u32 s54, s54, 4
s_sub_u32 s55, s54, 28
s_cmp_ge_u32 s54, 28
s_cselect_b32 s54, s55, s54
s_lshr_b32 s55, s54, 1
s_mul_i32 s55, s55, 114688
s_and_b32 s56, s54, 1
s_mul_i32 s56, s56, 28672
s_add_u32 s55, s55, s56
s_add_u32 s55, s55, s72
s_add_u32 m0, s74, 32768
s_nop 0
buffer_load_dwordx4 v3, s[24:27], s55 offen  lds
s_add_u32 m0, s74, 33792
s_add_u32 s55, s55, 7168
buffer_load_dwordx4 v3, s[24:27], s55 offen  lds
s_add_u32 m0, s74, 34816
s_add_u32 s55, s55, 7168
buffer_load_dwordx4 v3, s[24:27], s55 offen  lds
s_add_u32 m0, s74, 35840
s_add_u32 s55, s55, 7168
buffer_load_dwordx4 v3, s[24:27], s55 offen  lds
s_mul_i32 s54, s100, 7
s_add_u32 s54, s54, s99
s_add_u32 s54, s54, 5
s_sub_u32 s55, s54, 28
s_cmp_ge_u32 s54, 28
s_cselect_b32 s54, s55, s54
s_lshr_b32 s55, s54, 1
s_mul_i32 s55, s55, 114688
s_and_b32 s56, s54, 1
s_mul_i32 s56, s56, 28672
s_add_u32 s55, s55, s56
s_add_u32 s55, s55, s72
s_add_u32 m0, s74, 0
s_nop 0
buffer_load_dwordx4 v3, s[24:27], s55 offen  lds
s_add_u32 m0, s74, 1024
s_add_u32 s55, s55, 7168
buffer_load_dwordx4 v3, s[24:27], s55 offen  lds
s_add_u32 m0, s74, 2048
s_add_u32 s55, s55, 7168
buffer_load_dwordx4 v3, s[24:27], s55 offen  lds
s_add_u32 m0, s74, 3072
s_add_u32 s55, s55, 7168
buffer_load_dwordx4 v3, s[24:27], s55 offen  lds
s_mul_i32 s54, s100, 7
s_add_u32 s54, s54, s99
s_add_u32 s54, s54, 6
s_sub_u32 s55, s54, 28
s_cmp_ge_u32 s54, 28
s_cselect_b32 s54, s55, s54
s_lshr_b32 s55, s54, 1
s_mul_i32 s55, s55, 114688
s_and_b32 s56, s54, 1
s_mul_i32 s56, s56, 28672
s_add_u32 s55, s55, s56
s_add_u32 s55, s55, s72
s_add_u32 m0, s74, 16384
s_nop 0
buffer_load_dwordx4 v3, s[24:27], s55 offen  lds
s_add_u32 m0, s74, 17408
s_add_u32 s55, s55, 7168
buffer_load_dwordx4 v3, s[24:27], s55 offen  lds
s_add_u32 m0, s74, 18432
s_add_u32 s55, s55, 7168
buffer_load_dwordx4 v3, s[24:27], s55 offen  lds
s_add_u32 m0, s74, 19456
s_add_u32 s55, s55, 7168
buffer_load_dwordx4 v3, s[24:27], s55 offen  lds
s_mul_i32 s54, s100, 7
s_add_u32 s54, s54, s99
s_add_u32 s54, s54, 4
s_sub_u32 s55, s54, 28
s_cmp_ge_u32 s54, 28
s_cselect_b32 s54, s55, s54
s_lshr_b32 s55, s54, 1
s_mul_i32 s55, s55, 114688
s_and_b32 s56, s54, 1
s_mul_i32 s56, s56, 28672
s_add_u32 s55, s55, s56
s_add_u32 s55, s55, s73
s_add_u32 m0, s74, 114688
s_nop 0
buffer_load_dwordx4 v3, s[24:27], s55 offen  lds
s_add_u32 m0, s74, 115712
s_add_u32 s55, s55, 7168
buffer_load_dwordx4 v3, s[24:27], s55 offen  lds
s_add_u32 m0, s74, 116736
s_add_u32 s55, s55, 7168
buffer_load_dwordx4 v3, s[24:27], s55 offen  lds
s_add_u32 m0, s74, 117760
s_add_u32 s55, s55, 7168
buffer_load_dwordx4 v3, s[24:27], s55 offen  lds
s_mul_i32 s54, s100, 7
s_add_u32 s54, s54, s99
s_add_u32 s54, s54, 5
s_sub_u32 s55, s54, 28
s_cmp_ge_u32 s54, 28
s_cselect_b32 s54, s55, s54
s_lshr_b32 s55, s54, 1
s_mul_i32 s55, s55, 114688
s_and_b32 s56, s54, 1
s_mul_i32 s56, s56, 28672
s_add_u32 s55, s55, s56
s_add_u32 s55, s55, s73
s_add_u32 m0, s74, 131072
s_nop 0
buffer_load_dwordx4 v3, s[24:27], s55 offen  lds
s_add_u32 m0, s74, 132096
s_add_u32 s55, s55, 7168
buffer_load_dwordx4 v3, s[24:27], s55 offen  lds
s_add_u32 m0, s74, 133120
s_add_u32 s55, s55, 7168
buffer_load_dwordx4 v3, s[24:27], s55 offen  lds
s_add_u32 m0, s74, 134144
s_add_u32 s55, s55, 7168
buffer_load_dwordx4 v3, s[24:27], s55 offen  lds
s_waitcnt vmcnt(16)
ds_read_b64_tr_b16 v[120:121], v184 offset:32768
ds_read_b64_tr_b16 v[122:123], v184 offset:33792
ds_read_b64_tr_b16 v[124:125], v185 offset:32768
ds_read_b64_tr_b16 v[126:127], v185 offset:33792
ds_read_b64_tr_b16 v[128:129], v184 offset:34816
ds_read_b64_tr_b16 v[130:131], v184 offset:35840
ds_read_b64_tr_b16 v[132:133], v185 offset:34816
ds_read_b64_tr_b16 v[134:135], v185 offset:35840
s_waitcnt lgkmcnt(0)
s_mul_i32 s54, s100, 7
s_add_u32 s54, s54, s99
s_sub_u32 s55, s54, 28
s_cmp_ge_u32 s54, 28
s_cselect_b32 s54, s55, s54
s_lshr_b32 s55, s54, 1
s_mul_i32 s55, s55, 114688
s_and_b32 s56, s54, 1
s_mul_i32 s56, s56, 28672
s_add_u32 s55, s55, s56
s_add_u32 s55, s55, s73
s_add_u32 m0, s74, 32768
s_nop 0
buffer_load_dwordx4 v3, s[24:27], s55 offen  lds
s_add_u32 m0, s74, 33792
s_add_u32 s55, s55, 7168
buffer_load_dwordx4 v3, s[24:27], s55 offen  lds
s_add_u32 m0, s74, 34816
s_add_u32 s55, s55, 7168
buffer_load_dwordx4 v3, s[24:27], s55 offen  lds
s_add_u32 m0, s74, 35840
s_add_u32 s55, s55, 7168
buffer_load_dwordx4 v3, s[24:27], s55 offen  lds
s_waitcnt vmcnt(16)
ds_read_b64_tr_b16 v[136:137], v184 offset:0
ds_read_b64_tr_b16 v[138:139], v184 offset:1024
ds_read_b64_tr_b16 v[140:141], v185 offset:0
ds_read_b64_tr_b16 v[142:143], v185 offset:1024
ds_read_b64_tr_b16 v[144:145], v184 offset:2048
ds_read_b64_tr_b16 v[146:147], v184 offset:3072
ds_read_b64_tr_b16 v[148:149], v185 offset:2048
ds_read_b64_tr_b16 v[150:151], v185 offset:3072
s_waitcnt vmcnt(12)
ds_read_b64_tr_b16 v[152:153], v184 offset:16384
ds_read_b64_tr_b16 v[154:155], v184 offset:17408
ds_read_b64_tr_b16 v[156:157], v185 offset:16384
ds_read_b64_tr_b16 v[158:159], v185 offset:17408
ds_read_b64_tr_b16 v[160:161], v184 offset:18432
ds_read_b64_tr_b16 v[162:163], v184 offset:19456
ds_read_b64_tr_b16 v[164:165], v185 offset:18432
ds_read_b64_tr_b16 v[166:167], v185 offset:19456
s_waitcnt vmcnt(0)
ds_read_b64_tr_b16 v[168:169], v184 offset:32768
ds_read_b64_tr_b16 v[170:171], v184 offset:33792
ds_read_b64_tr_b16 v[172:173], v185 offset:32768
ds_read_b64_tr_b16 v[174:175], v185 offset:33792
ds_read_b64_tr_b16 v[176:177], v184 offset:34816
ds_read_b64_tr_b16 v[178:179], v184 offset:35840
ds_read_b64_tr_b16 v[180:181], v185 offset:34816
ds_read_b64_tr_b16 v[182:183], v185 offset:35840
s_waitcnt lgkmcnt(0)
s_mul_i32 s54, s100, 7
s_add_u32 s54, s54, s99
s_add_u32 s54, s54, 1
s_sub_u32 s55, s54, 28
s_cmp_ge_u32 s54, 28
s_cselect_b32 s54, s55, s54
s_lshr_b32 s55, s54, 1
s_mul_i32 s55, s55, 114688
s_and_b32 s56, s54, 1
s_mul_i32 s56, s56, 28672
s_add_u32 s55, s55, s56
s_add_u32 s55, s55, s73
s_add_u32 m0, s74, 0
s_nop 0
buffer_load_dwordx4 v3, s[24:27], s55 offen  lds
s_add_u32 m0, s74, 1024
s_add_u32 s55, s55, 7168
buffer_load_dwordx4 v3, s[24:27], s55 offen  lds
s_add_u32 m0, s74, 2048
s_add_u32 s55, s55, 7168
buffer_load_dwordx4 v3, s[24:27], s55 offen  lds
s_add_u32 m0, s74, 3072
s_add_u32 s55, s55, 7168
buffer_load_dwordx4 v3, s[24:27], s55 offen  lds
s_mul_i32 s54, s100, 7
s_add_u32 s54, s54, s99
s_add_u32 s54, s54, 2
s_sub_u32 s55, s54, 28
s_cmp_ge_u32 s54, 28
s_cselect_b32 s54, s55, s54
s_lshr_b32 s55, s54, 1
s_mul_i32 s55, s55, 114688
s_and_b32 s56, s54, 1
s_mul_i32 s56, s56, 28672
s_add_u32 s55, s55, s56
s_add_u32 s55, s55, s73
s_add_u32 m0, s74, 16384
s_nop 0
buffer_load_dwordx4 v3, s[24:27], s55 offen  lds
s_add_u32 m0, s74, 17408
s_add_u32 s55, s55, 7168
buffer_load_dwordx4 v3, s[24:27], s55 offen  lds
s_add_u32 m0, s74, 18432
s_add_u32 s55, s55, 7168
buffer_load_dwordx4 v3, s[24:27], s55 offen  lds
s_add_u32 m0, s74, 19456
s_add_u32 s55, s55, 7168
buffer_load_dwordx4 v3, s[24:27], s55 offen  lds
buffer_load_dword v10, v188, s[36:39], s75 offen sc1
s_mul_i32 s54, s100, 7
s_add_u32 s54, s54, s99
s_add_u32 s54, s54, 3
s_sub_u32 s55, s54, 28
s_cmp_ge_u32 s54, 28
s_cselect_b32 s54, s55, s54
s_lshr_b32 s55, s54, 1
s_mul_i32 s55, s55, 114688
s_and_b32 s56, s54, 1
s_mul_i32 s56, s56, 28672
s_add_u32 s55, s55, s56
s_add_u32 s55, s55, s73
s_add_u32 m0, s74, 32768
s_nop 0
buffer_load_dwordx4 v3, s[24:27], s55 offen  lds
s_add_u32 m0, s74, 33792
s_add_u32 s55, s55, 7168
buffer_load_dwordx4 v3, s[24:27], s55 offen  lds
s_add_u32 m0, s74, 34816
s_add_u32 s55, s55, 7168
buffer_load_dwordx4 v3, s[24:27], s55 offen  lds
s_add_u32 m0, s74, 35840
s_add_u32 s55, s55, 7168
buffer_load_dwordx4 v3, s[24:27], s55 offen  lds
s_waitcnt vmcnt(4)
v_cmp_ne_u32 vcc, v191, v10
s_nop 1
s_and_b64 s[56:57], vcc, s[40:41]
s_cbranch_scc0 L_pe_x
s_mov_b32 s58, 0
L_pe:
buffer_load_dword v10, v188, s[36:39], s75 offen sc1
s_add_u32 s58, s58, 1
s_waitcnt vmcnt(0)
v_cmp_ne_u32 vcc, v191, v10
s_cmp_gt_u32 s58, 0x40000
s_cbranch_scc1 L_pe_x
s_and_b64 s[56:57], vcc, s[40:41]
s_cbranch_scc1 L_pe
L_pe_x:
s_branch L_P2

.p2align 3
L_P2:
buffer_load_dwordx4 v[16:19], v1, s[36:39], s60 offen offset:0 sc1
buffer_load_dwordx4 v[20:23], v2, s[36:39], s60 offen offset:0 sc1
buffer_load_dwordx4 v[24:27], v1, s[36:39], s60 offen offset:1024 sc1
buffer_load_dwordx4 v[28:31], v2, s[36:39], s60 offen offset:1024 sc1
buffer_load_dwordx4 v[32:35], v1, s[36:39], s61 offen offset:0 sc1
buffer_load_dwordx4 v[36:39], v2, s[36:39], s61 offen offset:0 sc1
buffer_load_dwordx4 v[40:43], v1, s[36:39], s61 offen offset:1024 sc1
buffer_load_dwordx4 v[44:47], v2, s[36:39], s61 offen offset:1024 sc1
buffer_load_dwordx4 v[48:51], v1, s[36:39], s62 offen offset:0 sc1
buffer_load_dwordx4 v[52:55], v2, s[36:39], s62 offen offset:0 sc1
s_setprio 1
s_waitcnt vmcnt(9)
v_mfma_f32_32x32x16_bf16 v[192:207], v[56:59], v[16:19], 0
v_mfma_f32_32x32x16_bf16 v[208:223], v[60:63], v[16:19], 0
buffer_load_dwordx4 v[16:19], v1, s[36:39], s62 offen offset:1024 sc1
s_waitcnt vmcnt(9)
v_mfma_f32_32x32x16_bf16 v[224:239], v[56:59], v[20:23], 0
v_mfma_f32_32x32x16_bf16 v[240:255], v[60:63], v[20:23], 0
buffer_load_dwordx4 v[20:23], v2, s[36:39], s62 offen offset:1024 sc1
s_waitcnt vmcnt(9)
v_mfma_f32_32x32x16_bf16 v[192:207], v[64:67], v[24:27], v[192:207]
v_mfma_f32_32x32x16_bf16 v[208:223], v[68:71], v[24:27], v[208:223]
buffer_load_dwordx4 v[24:27], v1, s[36:39], s63 offen offset:0 sc1
s_waitcnt vmcnt(9)
v_mfma_f32_32x32x16_bf16 v[224:239], v[64:67], v[28:31], v[224:239]
v_mfma_f32_32x32x16_bf16 v[240:255], v[68:71], v[28:31], v[240:255]
buffer_load_dwordx4 v[28:31], v2, s[36:39], s63 offen offset:0 sc1
s_waitcnt vmcnt(9)
v_mfma_f32_32x32x16_bf16 v[192:207], v[72:75], v[32:35], v[192:207]
v_mfma_f32_32x32x16_bf16 v[208:223], v[76:79], v[32:35], v[208:223]
buffer_load_dwordx4 v[32:35], v1, s[36:39], s63 offen offset:1024 sc1
s_waitcnt vmcnt(9)
v_mfma_f32_32x32x16_bf16 v[224:239], v[72:75], v[36:39], v[224:239]
v_mfma_f32_32x32x16_bf16 v[240:255], v[76:79], v[36:39], v[240:255]
buffer_load_dwordx4 v[36:39], v2, s[36:39], s63 offen offset:1024 sc1
s_waitcnt vmcnt(9)
v_mfma_f32_32x32x16_bf16 v[192:207], v[80:83], v[40:43], v[192:207]
buffer_load_dwordx4 v[72:75], v1, s[36:39], s64 offen offset:0 sc1
v_mfma_f32_32x32x16_bf16 v[208:223], v[84:87], v[40:43], v[208:223]
buffer_load_dwordx4 v[76:79], v2, s[36:39], s64 offen offset:0 sc1
s_waitcnt vmcnt(10)
v_mfma_f32_32x32x16_bf16 v[224:239], v[80:83], v[44:47], v[224:239]
buffer_load_dwordx4 v[40:43], v1, s[36:39], s64 offen offset:1024 sc1
v_mfma_f32_32x32x16_bf16 v[240:255], v[84:87], v[44:47], v[240:255]
buffer_load_dwordx4 v[44:47], v2, s[36:39], s64 offen offset:1024 sc1
s_waitcnt vmcnt(11)
v_mfma_f32_32x32x16_bf16 v[192:207], v[88:91], v[48:51], v[192:207]
buffer_load_dwordx4 v[80:83], v1, s[36:39], s65 offen offset:0 sc1
v_mfma_f32_32x32x16_bf16 v[208:223], v[92:95], v[48:51], v[208:223]
buffer_load_dwordx4 v[84:87], v2, s[36:39], s65 offen offset:0 sc1
s_waitcnt vmcnt(12)
v_mfma_f32_32x32x16_bf16 v[224:239], v[88:91], v[52:55], v[224:239]
buffer_load_dwordx4 v[48:51], v1, s[36:39], s65 offen offset:1024 sc1
v_mfma_f32_32x32x16_bf16 v[240:255], v[92:95], v[52:55], v[240:255]
buffer_load_dwordx4 v[52:55], v2, s[36:39], s65 offen offset:1024 sc1
s_waitcnt vmcnt(13)
v_mfma_f32_32x32x16_bf16 v[192:207], v[96:99], v[16:19], v[192:207]
buffer_load_dwordx4 v[88:91], v1, s[36:39], s66 offen offset:0 sc1
v_mfma_f32_32x32x16_bf16 v[208:223], v[100:103], v[16:19], v[208:223]
buffer_load_dwordx4 v[92:95], v2, s[36:39], s66 offen offset:0 sc1
s_waitcnt vmcnt(14)
v_mfma_f32_32x32x16_bf16 v[224:239], v[96:99], v[20:23], v[224:239]
buffer_load_dwordx4 v[16:19], v1, s[36:39], s66 offen offset:1024 sc1
v_mfma_f32_32x32x16_bf16 v[240:255], v[100:103], v[20:23], v[240:255]
buffer_load_dwordx4 v[20:23], v2, s[36:39], s66 offen offset:1024 sc1
s_barrier
s_waitcnt vmcnt(15)
v_mfma_f32_32x32x16_bf16 v[192:207], v[104:107], v[24:27], v[192:207]
v_mfma_f32_32x32x16_bf16 v[208:223], v[108:111], v[24:27], v[208:223]
s_waitcnt vmcnt(14)
v_mfma_f32_32x32x16_bf16 v[224:239], v[104:107], v[28:31], v[224:239]
v_mfma_f32_32x32x16_bf16 v[240:255], v[108:111], v[28:31], v[240:255]
s_add_u32 s75, s75, 16384
buffer_load_dword v9, v188, s[36:39], s75 offen sc1
s_waitcnt vmcnt(14)
v_mfma_f32_32x32x16_bf16 v[192:207], v[112:115], v[32:35], v[192:207]
v_mfma_f32_32x32x16_bf16 v[208:223], v[116:119], v[32:35], v[208:223]
s_waitcnt vmcnt(13)
v_mfma_f32_32x32x16_bf16 v[224:239], v[112:115], v[36:39], v[224:239]
v_mfma_f32_32x32x16_bf16 v[240:255], v[116:119], v[36:39], v[240:255]
s_waitcnt vmcnt(12)
v_mfma_f32_32x32x16_bf16 v[192:207], v[120:123], v[72:75], v[192:207]
v_mfma_f32_32x32x16_bf16 v[208:223], v[124:127], v[72:75], v[208:223]
s_waitcnt vmcnt(11)
v_mfma_f32_32x32x16_bf16 v[224:239], v[120:123], v[76:79], v[224:239]
v_mfma_f32_32x32x16_bf16 v[240:255], v[124:127], v[76:79], v[240:255]
s_waitcnt vmcnt(10)
v_mfma_f32_32x32x16_bf16 v[192:207], v[128:131], v[40:43], v[192:207]
s_waitcnt vmcnt(0)
v_cmp_ne_u32 vcc, v191, v9
s_nop 1
s_and_b64 s[56:57], vcc, s[40:41]
s_cbranch_scc0 L_pl_x
s_mov_b32 s58, 0
L_pl:
buffer_load_dword v9, v188, s[36:39], s75 offen sc1
s_add_u32 s58, s58, 1
s_waitcnt vmcnt(0)
v_cmp_ne_u32 vcc, v191, v9
s_cmp_gt_u32 s58, 0x40000
s_cbranch_scc1 L_pl_x
s_and_b64 s[56:57], vcc, s[40:41]
s_cbranch_scc1 L_pl
L_pl_x:
buffer_load_dwordx4 v[96:99], v5, s[36:39], s60 offen offset:0 sc1
v_mfma_f32_32x32x16_bf16 v[208:223], v[132:135], v[40:43], v[208:223]
buffer_load_dwordx4 v[100:103], v6, s[36:39], s60 offen offset:0 sc1
v_mfma_f32_32x32x16_bf16 v[224:239], v[128:131], v[44:47], v[224:239]
buffer_load_dwordx4 v[24:27], v5, s[36:39], s60 offen offset:1024 sc1
v_mfma_f32_32x32x16_bf16 v[240:255], v[132:135], v[44:47], v[240:255]
buffer_load_dwordx4 v[28:31], v6, s[36:39], s60 offen offset:1024 sc1
v_mfma_f32_32x32x16_bf16 v[192:207], v[136:139], v[80:83], v[192:207]
buffer_load_dwordx4 v[104:107], v5, s[36:39], s61 offen offset:0 sc1
v_mfma_f32_32x32x16_bf16 v[208:223], v[140:143], v[80:83], v[208:223]
buffer_load_dwordx4 v[108:111], v6, s[36:39], s61 offen offset:0 sc1
v_mfma_f32_32x32x16_bf16 v[224:239], v[136:139], v[84:87], v[224:239]
buffer_load_dwordx4 v[32:35], v5, s[36:39], s61 offen offset:1024 sc1
v_mfma_f32_32x32x16_bf16 v[240:255], v[140:143], v[84:87], v[240:255]
buffer_load_dwordx4 v[36:39], v6, s[36:39], s61 offen offset:1024 sc1
v_mfma_f32_32x32x16_bf16 v[192:207], v[144:147], v[48:51], v[192:207]
buffer_load_dwordx4 v[112:115], v5, s[36:39], s62 offen offset:0 sc1
v_mfma_f32_32x32x16_bf16 v[208:223], v[148:151], v[48:51], v[208:223]
buffer_load_dwordx4 v[116:119], v6, s[36:39], s62 offen offset:0 sc1
v_mfma_f32_32x32x16_bf16 v[224:239], v[144:147], v[52:55], v[224:239]
buffer_load_dwordx4 v[72:75], v5, s[36:39], s62 offen offset:1024 sc1
v_mfma_f32_32x32x16_bf16 v[240:255], v[148:151], v[52:55], v[240:255]
buffer_load_dwordx4 v[76:79], v6, s[36:39], s62 offen offset:1024 sc1
v_mfma_f32_32x32x16_bf16 v[192:207], v[152:155], v[88:91], v[192:207]
v_mfma_f32_32x32x16_bf16 v[208:223], v[156:159], v[88:91], v[208:223]
buffer_load_dwordx4 v[120:123], v5, s[36:39], s63 offen offset:0 sc1
v_mfma_f32_32x32x16_bf16 v[224:239], v[152:155], v[92:95], v[224:239]
v_mfma_f32_32x32x16_bf16 v[240:255], v[156:159], v[92:95], v[240:255]
buffer_load_dwordx4 v[124:127], v6, s[36:39], s63 offen offset:0 sc1
v_mfma_f32_32x32x16_bf16 v[192:207], v[160:163], v[16:19], v[192:207]
v_mfma_f32_32x32x16_bf16 v[208:223], v[164:167], v[16:19], v[208:223]
buffer_load_dwordx4 v[40:43], v5, s[36:39], s63 offen offset:1024 sc1
v_mfma_f32_32x32x16_bf16 v[224:239], v[160:163], v[20:23], v[224:239]
v_mfma_f32_32x32x16_bf16 v[240:255], v[164:167], v[20:23], v[240:255]
buffer_load_dwordx4 v[44:47], v6, s[36:39], s63 offen offset:1024 sc1
s_waitcnt vmcnt(15)
v_mfma_f32_32x32x16_bf16 v[192:207], v[168:171], v[96:99], v[192:207]
v_mfma_f32_32x32x16_bf16 v[208:223], v[172:175], v[96:99], v[208:223]
buffer_load_dwordx4 v[128:131], v5, s[36:39], s64 offen offset:0 sc1
s_waitcnt vmcnt(15)
v_mfma_f32_32x32x16_bf16 v[224:239], v[168:171], v[100:103], v[224:239]
v_mfma_f32_32x32x16_bf16 v[240:255], v[172:175], v[100:103], v[240:255]
buffer_load_dwordx4 v[132:135], v6, s[36:39], s64 offen offset:0 sc1
s_waitcnt vmcnt(15)
v_mfma_f32_32x32x16_bf16 v[192:207], v[176:179], v[24:27], v[192:207]
ds_read_b64_tr_b16 v[56:57], v184 offset:0
ds_read_b64_tr_b16 v[58:59], v184 offset:1024
ds_read_b64_tr_b16 v[60:61], v185 offset:0
ds_read_b64_tr_b16 v[62:63], v185 offset:1024
v_mfma_f32_32x32x16_bf16 v[208:223], v[180:183], v[24:27], v[208:223]
buffer_load_dwordx4 v[80:83], v5, s[36:39], s64 offen offset:1024 sc1
s_waitcnt vmcnt(15)
v_mfma_f32_32x32x16_bf16 v[224:239], v[176:179], v[28:31], v[224:239]
v_mfma_f32_32x32x16_bf16 v[240:255], v[180:183], v[28:31], v[240:255]
buffer_load_dwordx4 v[84:87], v6, s[36:39], s64 offen offset:1024 sc1
s_waitcnt vmcnt(15) lgkmcnt(0)
v_mfma_f32_32x32x16_bf16 v[192:207], v[56:59], v[104:107], v[192:207]
ds_read_b64_tr_b16 v[64:65], v184 offset:2048
ds_read_b64_tr_b16 v[66:67], v184 offset:3072
ds_read_b64_tr_b16 v[68:69], v185 offset:2048
ds_read_b64_tr_b16 v[70:71], v185 offset:3072
v_mfma_f32_32x32x16_bf16 v[208:223], v[60:63], v[104:107], v[208:223]
buffer_load_dwordx4 v[136:139], v5, s[36:39], s65 offen offset:0 sc1
s_waitcnt vmcnt(15)
v_mfma_f32_32x32x16_bf16 v[224:239], v[56:59], v[108:111], v[224:239]
v_mfma_f32_32x32x16_bf16 v[240:255], v[60:63], v[108:111], v[240:255]
buffer_load_dwordx4 v[140:143], v6, s[36:39], s65 offen offset:0 sc1
s_waitcnt vmcnt(15) lgkmcnt(0)
v_mfma_f32_32x32x16_bf16 v[192:207], v[64:67], v[32:35], v[192:207]
ds_read_b64_tr_b16 v[56:57], v184 offset:16384
ds_read_b64_tr_b16 v[58:59], v184 offset:17408
ds_read_b64_tr_b16 v[60:61], v185 offset:16384
ds_read_b64_tr_b16 v[62:63], v185 offset:17408
v_mfma_f32_32x32x16_bf16 v[208:223], v[68:71], v[32:35], v[208:223]
buffer_load_dwordx4 v[48:51], v5, s[36:39], s65 offen offset:1024 sc1
s_waitcnt vmcnt(15)
v_mfma_f32_32x32x16_bf16 v[224:239], v[64:67], v[36:39], v[224:239]
v_mfma_f32_32x32x16_bf16 v[240:255], v[68:71], v[36:39], v[240:255]
buffer_load_dwordx4 v[52:55], v6, s[36:39], s65 offen offset:1024 sc1
s_waitcnt vmcnt(15) lgkmcnt(0)
v_mfma_f32_32x32x16_bf16 v[192:207], v[56:59], v[112:115], v[192:207]
ds_read_b64_tr_b16 v[64:65], v184 offset:18432
ds_read_b64_tr_b16 v[66:67], v184 offset:19456
ds_read_b64_tr_b16 v[68:69], v185 offset:18432
ds_read_b64_tr_b16 v[70:71], v185 offset:19456
v_mfma_f32_32x32x16_bf16 v[208:223], v[60:63], v[112:115], v[208:223]
buffer_load_dwordx4 v[144:147], v5, s[36:39], s66 offen offset:0 sc1
s_waitcnt vmcnt(15)
v_mfma_f32_32x32x16_bf16 v[224:239], v[56:59], v[116:119], v[224:239]
v_mfma_f32_32x32x16_bf16 v[240:255], v[60:63], v[116:119], v[240:255]
buffer_load_dwordx4 v[148:151], v6, s[36:39], s66 offen offset:0 sc1
buffer_load_dword v8, v189, s[36:39], s75 offen sc1
s_waitcnt vmcnt(16) lgkmcnt(0)
v_mfma_f32_32x32x16_bf16 v[192:207], v[64:67], v[72:75], v[192:207]
ds_read_b64_tr_b16 v[56:57], v184 offset:32768
ds_read_b64_tr_b16 v[58:59], v184 offset:33792
ds_read_b64_tr_b16 v[60:61], v185 offset:32768
ds_read_b64_tr_b16 v[62:63], v185 offset:33792
v_mfma_f32_32x32x16_bf16 v[208:223], v[68:71], v[72:75], v[208:223]
buffer_load_dwordx4 v[88:91], v5, s[36:39], s66 offen offset:1024 sc1
s_waitcnt vmcnt(16)
v_mfma_f32_32x32x16_bf16 v[224:239], v[64:67], v[76:79], v[224:239]
v_mfma_f32_32x32x16_bf16 v[240:255], v[68:71], v[76:79], v[240:255]
buffer_load_dwordx4 v[92:95], v6, s[36:39], s66 offen offset:1024 sc1
s_waitcnt vmcnt(16) lgkmcnt(0)
v_mfma_f32_32x32x16_bf16 v[192:207], v[56:59], v[120:123], v[192:207]
ds_read_b64_tr_b16 v[64:65], v184 offset:34816
ds_read_b64_tr_b16 v[66:67], v184 offset:35840
ds_read_b64_tr_b16 v[68:69], v185 offset:34816
ds_read_b64_tr_b16 v[70:71], v185 offset:35840
v_mfma_f32_32x32x16_bf16 v[208:223], v[60:63], v[120:123], v[208:223]
s_waitcnt vmcnt(15)
v_mfma_f32_32x32x16_bf16 v[224:239], v[56:59], v[124:127], v[224:239]
v_mfma_f32_32x32x16_bf16 v[240:255], v[60:63], v[124:127], v[240:255]
s_waitcnt vmcnt(14) lgkmcnt(0)
v_mfma_f32_32x32x16_bf16 v[192:207], v[64:67], v[40:43], v[192:207]
v_add_u32 v184, 0x00010000, v184
v_add_u32 v185, 0x00010000, v185
ds_read_b64_tr_b16 v[56:57], v184 offset:49152
ds_read_b64_tr_b16 v[58:59], v184 offset:50176
ds_read_b64_tr_b16 v[60:61], v185 offset:49152
ds_read_b64_tr_b16 v[62:63], v185 offset:50176
s_waitcnt vmcnt(2)
v_cmp_ne_u32 vcc, v191, v8
s_nop 1
s_and_b64 s[56:57], vcc, s[42:43]
s_cbranch_scc0 L_po_x
s_mov_b32 s58, 0
L_po:
buffer_load_dword v8, v189, s[36:39], s75 offen sc1
s_add_u32 s58, s58, 1
s_waitcnt vmcnt(0)
v_cmp_ne_u32 vcc, v191, v8
s_cmp_gt_u32 s58, 0x40000
s_cbranch_scc1 L_po_x
s_and_b64 s[56:57], vcc, s[42:43]
s_cbranch_scc1 L_po
L_po_x:
buffer_load_dwordx4 v[152:155], v186, s[36:39], s67 offen offset:0 sc1
v_mfma_f32_32x32x16_bf16 v[208:223], v[68:71], v[40:43], v[208:223]
buffer_load_dwordx4 v[156:159], v187, s[36:39], s67 offen offset:0 sc1
v_mfma_f32_32x32x16_bf16 v[224:239], v[64:67], v[44:47], v[224:239]
buffer_load_dwordx4 v[16:19], v186, s[36:39], s67 offen offset:1024 sc1
v_mfma_f32_32x32x16_bf16 v[240:255], v[68:71], v[44:47], v[240:255]
buffer_load_dwordx4 v[20:23], v187, s[36:39], s67 offen offset:1024 sc1
s_waitcnt lgkmcnt(0)
v_mfma_f32_32x32x16_bf16 v[192:207], v[56:59], v[128:131], v[192:207]
ds_read_b64_tr_b16 v[64:65], v184 offset:51200
ds_read_b64_tr_b16 v[66:67], v184 offset:52224
ds_read_b64_tr_b16 v[68:69], v185 offset:51200
ds_read_b64_tr_b16 v[70:71], v185 offset:52224
v_mfma_f32_32x32x16_bf16 v[208:223], v[60:63], v[128:131], v[208:223]
buffer_load_dwordx4 v[160:163], v186, s[36:39], s68 offen offset:0 sc1
v_mfma_f32_32x32x16_bf16 v[224:239], v[56:59], v[132:135], v[224:239]
v_mfma_f32_32x32x16_bf16 v[240:255], v[60:63], v[132:135], v[240:255]
buffer_load_dwordx4 v[164:167], v187, s[36:39], s68 offen offset:0 sc1
s_waitcnt lgkmcnt(0)
v_mfma_f32_32x32x16_bf16 v[192:207], v[64:67], v[80:83], v[192:207]
v_add_u32 v184, 0x00010000, v184
v_add_u32 v185, 0x00010000, v185
ds_read_b64_tr_b16 v[56:57], v184 offset:0
ds_read_b64_tr_b16 v[58:59], v184 offset:1024
ds_read_b64_tr_b16 v[60:61], v185 offset:0
ds_read_b64_tr_b16 v[62:63], v185 offset:1024
v_mfma_f32_32x32x16_bf16 v[208:223], v[68:71], v[80:83], v[208:223]
buffer_load_dwordx4 v[96:99], v186, s[36:39], s68 offen offset:1024 sc1
v_mfma_f32_32x32x16_bf16 v[224:239], v[64:67], v[84:87], v[224:239]
v_mfma_f32_32x32x16_bf16 v[240:255], v[68:71], v[84:87], v[240:255]
buffer_load_dwordx4 v[100:103], v187, s[36:39], s68 offen offset:1024 sc1
s_waitcnt lgkmcnt(0)
v_mfma_f32_32x32x16_bf16 v[192:207], v[56:59], v[136:139], v[192:207]
ds_read_b64_tr_b16 v[64:65], v184 offset:2048
ds_read_b64_tr_b16 v[66:67], v184 offset:3072
ds_read_b64_tr_b16 v[68:69], v185 offset:2048
ds_read_b64_tr_b16 v[70:71], v185 offset:3072
v_mfma_f32_32x32x16_bf16 v[208:223], v[60:63], v[136:139], v[208:223]
buffer_load_dwordx4 v[24:27], v186, s[36:39], s69 offen offset:0 sc1
v_mfma_f32_32x32x16_bf16 v[224:239], v[56:59], v[140:143], v[224:239]
v_mfma_f32_32x32x16_bf16 v[240:255], v[60:63], v[140:143], v[240:255]
buffer_load_dwordx4 v[28:31], v187, s[36:39], s69 offen offset:0 sc1
s_barrier
s_waitcnt lgkmcnt(0)
v_mfma_f32_32x32x16_bf16 v[192:207], v[64:67], v[48:51], v[192:207]
ds_read_b64_tr_b16 v[56:57], v184 offset:16384
ds_read_b64_tr_b16 v[58:59], v184 offset:17408
ds_read_b64_tr_b16 v[60:61], v185 offset:16384
ds_read_b64_tr_b16 v[62:63], v185 offset:17408
v_mfma_f32_32x32x16_bf16 v[208:223], v[68:71], v[48:51], v[208:223]
buffer_load_dwordx4 v[104:107], v186, s[36:39], s69 offen offset:1024 sc1
v_mfma_f32_32x32x16_bf16 v[224:239], v[64:67], v[52:55], v[224:239]
v_mfma_f32_32x32x16_bf16 v[240:255], v[68:71], v[52:55], v[240:255]
buffer_load_dwordx4 v[108:111], v187, s[36:39], s69 offen offset:1024 sc1
s_waitcnt lgkmcnt(0)
v_mfma_f32_32x32x16_bf16 v[192:207], v[56:59], v[144:147], v[192:207]
ds_read_b64_tr_b16 v[64:65], v184 offset:18432
ds_read_b64_tr_b16 v[66:67], v184 offset:19456
ds_read_b64_tr_b16 v[68:69], v185 offset:18432
ds_read_b64_tr_b16 v[70:71], v185 offset:19456
v_mfma_f32_32x32x16_bf16 v[208:223], v[60:63], v[144:147], v[208:223]
buffer_load_dwordx4 v[32:35], v186, s[36:39], s70 offen offset:0 sc1
v_mfma_f32_32x32x16_bf16 v[224:239], v[56:59], v[148:151], v[224:239]
v_mfma_f32_32x32x16_bf16 v[240:255], v[60:63], v[148:151], v[240:255]
buffer_load_dwordx4 v[36:39], v187, s[36:39], s70 offen offset:0 sc1
s_waitcnt vmcnt(15) lgkmcnt(0)
v_mfma_f32_32x32x16_bf16 v[192:207], v[64:67], v[88:91], v[192:207]
v_add_u32 v184, 0xfffe0000, v184
v_add_u32 v185, 0xfffe0000, v185
ds_read_b64_tr_b16 v[56:57], v184 offset:49152
ds_read_b64_tr_b16 v[58:59], v184 offset:50176
ds_read_b64_tr_b16 v[60:61], v185 offset:49152
ds_read_b64_tr_b16 v[62:63], v185 offset:50176
v_mfma_f32_32x32x16_bf16 v[208:223], v[68:71], v[88:91], v[208:223]
buffer_load_dwordx4 v[112:115], v186, s[36:39], s70 offen offset:1024 sc1
s_waitcnt vmcnt(15)
v_mfma_f32_32x32x16_bf16 v[224:239], v[64:67], v[92:95], v[224:239]
v_mfma_f32_32x32x16_bf16 v[240:255], v[68:71], v[92:95], v[240:255]
buffer_load_dwordx4 v[116:119], v187, s[36:39], s70 offen offset:1024 sc1
s_waitcnt vmcnt(15) lgkmcnt(0)
v_mfma_f32_32x32x16_bf16 v[192:207], v[56:59], v[152:155], v[192:207]
ds_read_b64_tr_b16 v[64:65], v184 offset:51200
ds_read_b64_tr_b16 v[66:67], v184 offset:52224
ds_read_b64_tr_b16 v[68:69], v185 offset:51200
ds_read_b64_tr_b16 v[70:71], v185 offset:52224
v_mfma_f32_32x32x16_bf16 v[208:223], v[60:63], v[152:155], v[208:223]
s_waitcnt vmcnt(14)
v_mfma_f32_32x32x16_bf16 v[224:239], v[56:59], v[156:159], v[224:239]
v_mfma_f32_32x32x16_bf16 v[240:255], v[60:63], v[156:159], v[240:255]
s_waitcnt vmcnt(13) lgkmcnt(0)
v_mfma_f32_32x32x16_bf16 v[192:207], v[64:67], v[16:19], v[192:207]
v_add_u32 v184, 0x00010000, v184
v_add_u32 v185, 0x00010000, v185
ds_read_b64_tr_b16 v[56:57], v184 offset:0
ds_read_b64_tr_b16 v[58:59], v184 offset:1024
ds_read_b64_tr_b16 v[60:61], v185 offset:0
ds_read_b64_tr_b16 v[62:63], v185 offset:1024
v_mfma_f32_32x32x16_bf16 v[208:223], v[68:71], v[16:19], v[208:223]
s_waitcnt vmcnt(12)
v_mfma_f32_32x32x16_bf16 v[224:239], v[64:67], v[20:23], v[224:239]
v_mfma_f32_32x32x16_bf16 v[240:255], v[68:71], v[20:23], v[240:255]
s_waitcnt vmcnt(11) lgkmcnt(0)
v_mfma_f32_32x32x16_bf16 v[192:207], v[56:59], v[160:163], v[192:207]
ds_read_b64_tr_b16 v[64:65], v184 offset:2048
ds_read_b64_tr_b16 v[66:67], v184 offset:3072
ds_read_b64_tr_b16 v[68:69], v185 offset:2048
ds_read_b64_tr_b16 v[70:71], v185 offset:3072
ds_read_b64_tr_b16 v[168:169], v184 offset:16384
ds_read_b64_tr_b16 v[170:171], v184 offset:17408
ds_read_b64_tr_b16 v[172:173], v185 offset:16384
ds_read_b64_tr_b16 v[174:175], v185 offset:17408
v_mfma_f32_32x32x16_bf16 v[208:223], v[60:63], v[160:163], v[208:223]
s_waitcnt vmcnt(10)
v_mfma_f32_32x32x16_bf16 v[224:239], v[56:59], v[164:167], v[224:239]
v_mfma_f32_32x32x16_bf16 v[240:255], v[60:63], v[164:167], v[240:255]
s_waitcnt vmcnt(9) lgkmcnt(4)
v_mfma_f32_32x32x16_bf16 v[192:207], v[64:67], v[96:99], v[192:207]
ds_read_b64_tr_b16 v[176:177], v184 offset:18432
ds_read_b64_tr_b16 v[178:179], v184 offset:19456
ds_read_b64_tr_b16 v[180:181], v185 offset:18432
ds_read_b64_tr_b16 v[182:183], v185 offset:19456
ds_read_b64_tr_b16 v[56:57], v184 offset:32768
ds_read_b64_tr_b16 v[58:59], v184 offset:33792
ds_read_b64_tr_b16 v[60:61], v185 offset:32768
ds_read_b64_tr_b16 v[62:63], v185 offset:33792
v_mfma_f32_32x32x16_bf16 v[208:223], v[68:71], v[96:99], v[208:223]
s_waitcnt vmcnt(8)
v_mfma_f32_32x32x16_bf16 v[224:239], v[64:67], v[100:103], v[224:239]
v_mfma_f32_32x32x16_bf16 v[240:255], v[68:71], v[100:103], v[240:255]
s_waitcnt vmcnt(7) lgkmcnt(8)
v_mfma_f32_32x32x16_bf16 v[192:207], v[168:171], v[24:27], v[192:207]
ds_read_b64_tr_b16 v[64:65], v184 offset:34816
ds_read_b64_tr_b16 v[66:67], v184 offset:35840
ds_read_b64_tr_b16 v[68:69], v185 offset:34816
ds_read_b64_tr_b16 v[70:71], v185 offset:35840
v_mfma_f32_32x32x16_bf16 v[208:223], v[172:175], v[24:27], v[208:223]
s_waitcnt vmcnt(5) lgkmcnt(8)
v_mfma_f32_32x32x16_bf16 v[192:207], v[176:179], v[104:107], v[192:207]
v_mfma_f32_32x32x16_bf16 v[208:223], v[180:183], v[104:107], v[208:223]
s_waitcnt vmcnt(3) lgkmcnt(4)
v_mfma_f32_32x32x16_bf16 v[192:207], v[56:59], v[32:35], v[192:207]
v_mfma_f32_32x32x16_bf16 v[208:223], v[60:63], v[32:35], v[208:223]
s_waitcnt vmcnt(1) lgkmcnt(0)
v_mfma_f32_32x32x16_bf16 v[192:207], v[64:67], v[112:115], v[192:207]
v_mfma_f32_32x32x16_bf16 v[208:223], v[68:71], v[112:115], v[208:223]
v_mfma_f32_32x32x16_bf16 v[224:239], v[168:171], v[28:31], v[224:239]
v_and_b32 v8, 15, v0
v_lshrrev_b32 v9, 5, v0
v_and_b32 v10, 7, v0
v_xor_b32 v9, v9, v10
v_lshlrev_b32 v9, 4, v9
v_lshl_add_u32 v9, v8, 8, v9
v_and_b32 v8, 16, v0
v_lshl_add_u32 v9, v8, 10, v9
v_add_u32 v8, s74, v9
v_xor_b32 v9, 32, v8
v_xor_b32 v10, 64, v8
v_xor_b32 v11, 96, v8
v_mfma_f32_32x32x16_bf16 v[240:255], v[172:175], v[28:31], v[240:255]
ds_write_b128 v8, v[192:195] offset:0
v_mfma_f32_32x32x16_bf16 v[224:239], v[176:179], v[108:111], v[224:239]
ds_write_b128 v9, v[196:199] offset:0
v_mfma_f32_32x32x16_bf16 v[240:255], v[180:183], v[108:111], v[240:255]
ds_write_b128 v10, v[200:203] offset:0
v_mfma_f32_32x32x16_bf16 v[224:239], v[56:59], v[36:39], v[224:239]
ds_write_b128 v11, v[204:207] offset:0
v_mfma_f32_32x32x16_bf16 v[240:255], v[60:63], v[36:39], v[240:255]
ds_write_b128 v8, v[208:211] offset:128
s_waitcnt vmcnt(0)
v_mfma_f32_32x32x16_bf16 v[224:239], v[64:67], v[116:119], v[224:239]
ds_write_b128 v9, v[212:215] offset:128
v_mfma_f32_32x32x16_bf16 v[240:255], v[68:71], v[116:119], v[240:255]
ds_write_b128 v10, v[216:219] offset:128
ds_write_b128 v11, v[220:223] offset:128
s_nop 7
ds_write_b128 v8, v[224:227] offset:32768
ds_write_b128 v9, v[228:231] offset:32768
ds_write_b128 v10, v[232:235] offset:32768
ds_write_b128 v11, v[236:239] offset:32768
ds_write_b128 v8, v[240:243] offset:32896
ds_write_b128 v9, v[244:247] offset:32896
ds_write_b128 v10, v[248:251] offset:32896
ds_write_b128 v11, v[252:255] offset:32896
v_mov_b32 v56, v12
v_mov_b32 v57, v13
v_mov_b32 v58, v14
v_mov_b32 v59, v15
s_waitcnt lgkmcnt(0)
v_lshrrev_b32 v3, 3, v0
v_and_b32 v4, 7, v0
v_lshlrev_b32 v4, 1, v4
v_xor_b32 v4, v4, v3
v_lshlrev_b32 v4, 4, v4
v_lshl_add_u32 v4, v3, 8, v4
s_lshr_b32 s54, s44, 1
s_lshl_b32 s54, s54, 14
s_and_b32 s55, s44, 1
s_lshl_b32 s55, s55, 11
s_add_u32 s54, s54, s55
v_add_u32 v1, s54, v4
v_xor_b32 v2, 16, v1
s_barrier
ds_read_b128 v[8:11], v1 offset:0
ds_read_b128 v[12:15], v2 offset:0
ds_read_b128 v[16:19], v1 offset:4096
ds_read_b128 v[20:23], v2 offset:4096
ds_read_b128 v[24:27], v1 offset:8192
ds_read_b128 v[28:31], v2 offset:8192
ds_read_b128 v[32:35], v1 offset:12288
ds_read_b128 v[36:39], v2 offset:12288
v_lshlrev_b32 v40, 16, v56
v_and_b32 v41, 0xffff0000, v56
v_lshlrev_b32 v42, 16, v57
v_and_b32 v43, 0xffff0000, v57
v_lshlrev_b32 v44, 16, v58
v_and_b32 v45, 0xffff0000, v58
v_lshlrev_b32 v46, 16, v59
v_and_b32 v47, 0xffff0000, v59
s_waitcnt lgkmcnt(6)
v_add_f32 v40, v40, v8
v_add_f32 v41, v41, v9
v_add_f32 v42, v42, v10
v_add_f32 v43, v43, v11
v_add_f32 v44, v44, v12
v_add_f32 v45, v45, v13
v_add_f32 v46, v46, v14
v_add_f32 v47, v47, v15
s_waitcnt lgkmcnt(4)
v_add_f32 v40, v40, v16
v_add_f32 v41, v41, v17
v_add_f32 v42, v42, v18
v_add_f32 v43, v43, v19
v_add_f32 v44, v44, v20
v_add_f32 v45, v45, v21
v_add_f32 v46, v46, v22
v_add_f32 v47, v47, v23
s_waitcnt lgkmcnt(2)
v_add_f32 v40, v40, v24
v_add_f32 v41, v41, v25
v_add_f32 v42, v42, v26
v_add_f32 v43, v43, v27
v_add_f32 v44, v44, v28
v_add_f32 v45, v45, v29
v_add_f32 v46, v46, v30
v_add_f32 v47, v47, v31
s_waitcnt lgkmcnt(0)
v_add_f32 v40, v40, v32
v_add_f32 v41, v41, v33
v_add_f32 v42, v42, v34
v_add_f32 v43, v43, v35
v_add_f32 v44, v44, v36
v_add_f32 v45, v45, v37
v_add_f32 v46, v46, v38
v_add_f32 v47, v47, v39
v_cvt_pk_bf16_f32 v48, v40, v41
v_cvt_pk_bf16_f32 v49, v42, v43
v_cvt_pk_bf16_f32 v50, v44, v45
v_cvt_pk_bf16_f32 v51, v46, v47
buffer_store_dwordx4 v[48:51], v7, s[28:31], s59 offen
s_endpgm
.p2align 3
L_C:
s_setprio 3
s_lshl_b32 s54, s45, 2
s_add_u32 s54, s54, s44
s_lshl_b32 s56, s44, 12
v_and_b32 v12, 31, v0
v_lshrrev_b32 v13, 1, v12
v_and_b32 v13, 3, v13
v_lshrrev_b32 v14, 4, v12
v_lshl_add_u32 v13, v14, 2, v13
v_lshrrev_b32 v14, 5, v0
v_xor_b32 v13, v13, v14
v_lshlrev_b32 v13, 4, v13
v_lshl_add_u32 v13, v12, 7, v13
v_add_u32 v16, s56, v13
v_add_u32 v16, 98304, v16
v_xor_b32 v17, 32, v16
v_xor_b32 v18, 64, v16
v_xor_b32 v19, 96, v16
v_mov_b32 v243, 0x3f803f80
v_mov_b32 v20, 0
v_mov_b32 v21, 0
v_mov_b32 v22, 0
v_mov_b32 v23, 0
v_mov_b32 v24, 0
v_mov_b32 v25, 0
v_mov_b32 v26, 0
v_mov_b32 v27, 0
s_barrier
ds_read_b128 v[128:131], v16 offset:0
ds_read_b128 v[132:135], v17 offset:0
ds_read_b128 v[136:139], v18 offset:0
ds_read_b128 v[140:143], v19 offset:0
ds_read_b128 v[144:147], v16 offset:16384
ds_read_b128 v[148:151], v17 offset:16384
ds_read_b128 v[152:155], v18 offset:16384
ds_read_b128 v[156:159], v19 offset:16384
s_waitcnt lgkmcnt(7)
v_dot2c_f32_bf16 v20, v243, v128
v_dot2c_f32_bf16 v24, v128, v128
v_dot2c_f32_bf16 v21, v243, v129
v_dot2c_f32_bf16 v25, v129, v129
v_dot2c_f32_bf16 v22, v243, v130
v_dot2c_f32_bf16 v26, v130, v130
v_dot2c_f32_bf16 v23, v243, v131
v_dot2c_f32_bf16 v27, v131, v131
s_waitcnt lgkmcnt(6)
v_dot2c_f32_bf16 v20, v243, v132
v_dot2c_f32_bf16 v24, v132, v132
v_dot2c_f32_bf16 v21, v243, v133
v_dot2c_f32_bf16 v25, v133, v133
v_dot2c_f32_bf16 v22, v243, v134
v_dot2c_f32_bf16 v26, v134, v134
v_dot2c_f32_bf16 v23, v243, v135
v_dot2c_f32_bf16 v27, v135, v135
s_waitcnt lgkmcnt(5)
v_dot2c_f32_bf16 v20, v243, v136
v_dot2c_f32_bf16 v24, v136, v136
v_dot2c_f32_bf16 v21, v243, v137
v_dot2c_f32_bf16 v25, v137, v137
v_dot2c_f32_bf16 v22, v243, v138
v_dot2c_f32_bf16 v26, v138, v138
v_dot2c_f32_bf16 v23, v243, v139
v_dot2c_f32_bf16 v27, v139, v139
s_waitcnt lgkmcnt(4)
v_dot2c_f32_bf16 v20, v243, v140
v_dot2c_f32_bf16 v24, v140, v140
v_dot2c_f32_bf16 v21, v243, v141
v_dot2c_f32_bf16 v25, v141, v141
v_dot2c_f32_bf16 v22, v243, v142
v_dot2c_f32_bf16 v26, v142, v142
v_dot2c_f32_bf16 v23, v243, v143
v_dot2c_f32_bf16 v27, v143, v143
s_waitcnt lgkmcnt(3)
v_dot2c_f32_bf16 v20, v243, v144
v_dot2c_f32_bf16 v24, v144, v144
v_dot2c_f32_bf16 v21, v243, v145
v_dot2c_f32_bf16 v25, v145, v145
v_dot2c_f32_bf16 v22, v243, v146
v_dot2c_f32_bf16 v26, v146, v146
v_dot2c_f32_bf16 v23, v243, v147
v_dot2c_f32_bf16 v27, v147, v147
s_waitcnt lgkmcnt(2)
v_dot2c_f32_bf16 v20, v243, v148
v_dot2c_f32_bf16 v24, v148, v148
v_dot2c_f32_bf16 v21, v243, v149
v_dot2c_f32_bf16 v25, v149, v149
v_dot2c_f32_bf16 v22, v243, v150
v_dot2c_f32_bf16 v26, v150, v150
v_dot2c_f32_bf16 v23, v243, v151
v_dot2c_f32_bf16 v27, v151, v151
s_waitcnt lgkmcnt(1)
v_dot2c_f32_bf16 v20, v243, v152
v_dot2c_f32_bf16 v24, v152, v152
v_dot2c_f32_bf16 v21, v243, v153
v_dot2c_f32_bf16 v25, v153, v153
v_dot2c_f32_bf16 v22, v243, v154
v_dot2c_f32_bf16 v26, v154, v154
v_dot2c_f32_bf16 v23, v243, v155
v_dot2c_f32_bf16 v27, v155, v155
s_waitcnt lgkmcnt(0)
v_dot2c_f32_bf16 v20, v243, v156
v_dot2c_f32_bf16 v24, v156, v156
v_dot2c_f32_bf16 v21, v243, v157
v_dot2c_f32_bf16 v25, v157, v157
v_dot2c_f32_bf16 v22, v243, v158
v_dot2c_f32_bf16 v26, v158, v158
v_dot2c_f32_bf16 v23, v243, v159
v_dot2c_f32_bf16 v27, v159, v159
s_mov_b64 s[8:9], s[62:63]
s_mov_b64 s[12:13], s[64:65]
s_mov_b64 s[16:17], s[68:69]
s_mov_b64 s[20:21], s[70:71]
s_mov_b64 s[24:25], s[72:73]
s_mov_b64 s[28:29], s[74:75]
s_mov_b64 s[32:33], s[40:41]
s_mov_b64 s[36:37], s[42:43]
s_mov_b32 s10, 1204224
s_mov_b32 s11, 0x20000
s_mov_b32 s14, 401408
s_mov_b32 s15, 0x20000
s_mov_b32 s18, 1605632
s_mov_b32 s19, 0x20000
s_mov_b32 s22, 1605632
s_mov_b32 s23, 0x20000
s_mov_b32 s26, 1605632
s_mov_b32 s27, 0x20000
s_mov_b32 s30, 1835008
s_mov_b32 s31, 0x20000
s_mov_b32 s34, 256
s_mov_b32 s35, 0x20000
s_mov_b32 s38, 16777216
s_mov_b32 s39, 0x20000
v_and_b32 v12, 15, v0
v_lshrrev_b32 v13, 2, v12
v_lshrrev_b32 v1, 5, v0
v_mul_u32_u24 v1, 8, v1
v_add_u32 v1, v1, v13
v_lshlrev_b32 v1, 7, v1
v_and_b32 v12, 3, v0
v_lshrrev_b32 v13, 2, v0
v_and_b32 v13, 4, v13
v_add_u32 v12, v12, v13
v_lshlrev_b32 v12, 3, v12
v_lshlrev_b32 v13, 3, v0
v_and_b32 v13, 64, v13
v_xor_b32 v12, v12, v13
v_add_u32 v1, v1, v12
v_xor_b32 v2, 64, v1
s_barrier
ds_read_b128 v[160:163], v16 offset:32768
ds_read_b128 v[164:167], v17 offset:32768
ds_read_b128 v[168:171], v18 offset:32768
ds_read_b128 v[172:175], v19 offset:32768
ds_read_b128 v[176:179], v16 offset:49152
ds_read_b128 v[180:183], v17 offset:49152
ds_read_b128 v[184:187], v18 offset:49152
ds_read_b128 v[188:191], v19 offset:49152
s_waitcnt lgkmcnt(7)
v_dot2c_f32_bf16 v20, v243, v160
v_dot2c_f32_bf16 v24, v160, v160
v_dot2c_f32_bf16 v21, v243, v161
v_dot2c_f32_bf16 v25, v161, v161
v_dot2c_f32_bf16 v22, v243, v162
v_dot2c_f32_bf16 v26, v162, v162
v_dot2c_f32_bf16 v23, v243, v163
v_dot2c_f32_bf16 v27, v163, v163
s_waitcnt lgkmcnt(6)
v_dot2c_f32_bf16 v20, v243, v164
v_dot2c_f32_bf16 v24, v164, v164
v_dot2c_f32_bf16 v21, v243, v165
v_dot2c_f32_bf16 v25, v165, v165
v_dot2c_f32_bf16 v22, v243, v166
v_dot2c_f32_bf16 v26, v166, v166
v_dot2c_f32_bf16 v23, v243, v167
v_dot2c_f32_bf16 v27, v167, v167
s_waitcnt lgkmcnt(5)
v_dot2c_f32_bf16 v20, v243, v168
v_dot2c_f32_bf16 v24, v168, v168
v_dot2c_f32_bf16 v21, v243, v169
v_dot2c_f32_bf16 v25, v169, v169
v_dot2c_f32_bf16 v22, v243, v170
v_dot2c_f32_bf16 v26, v170, v170
v_dot2c_f32_bf16 v23, v243, v171
v_dot2c_f32_bf16 v27, v171, v171
s_waitcnt lgkmcnt(4)
v_dot2c_f32_bf16 v20, v243, v172
v_dot2c_f32_bf16 v24, v172, v172
v_dot2c_f32_bf16 v21, v243, v173
v_dot2c_f32_bf16 v25, v173, v173
v_dot2c_f32_bf16 v22, v243, v174
v_dot2c_f32_bf16 v26, v174, v174
v_dot2c_f32_bf16 v23, v243, v175
v_dot2c_f32_bf16 v27, v175, v175
s_waitcnt lgkmcnt(3)
v_dot2c_f32_bf16 v20, v243, v176
v_dot2c_f32_bf16 v24, v176, v176
v_dot2c_f32_bf16 v21, v243, v177
v_dot2c_f32_bf16 v25, v177, v177
v_dot2c_f32_bf16 v22, v243, v178
v_dot2c_f32_bf16 v26, v178, v178
v_dot2c_f32_bf16 v23, v243, v179
v_dot2c_f32_bf16 v27, v179, v179
s_waitcnt lgkmcnt(2)
v_dot2c_f32_bf16 v20, v243, v180
v_dot2c_f32_bf16 v24, v180, v180
v_dot2c_f32_bf16 v21, v243, v181
v_dot2c_f32_bf16 v25, v181, v181
v_dot2c_f32_bf16 v22, v243, v182
v_dot2c_f32_bf16 v26, v182, v182
v_dot2c_f32_bf16 v23, v243, v183
v_dot2c_f32_bf16 v27, v183, v183
s_waitcnt lgkmcnt(1)
v_dot2c_f32_bf16 v20, v243, v184
v_dot2c_f32_bf16 v24, v184, v184
v_dot2c_f32_bf16 v21, v243, v185
v_dot2c_f32_bf16 v25, v185, v185
v_dot2c_f32_bf16 v22, v243, v186
v_dot2c_f32_bf16 v26, v186, v186
v_dot2c_f32_bf16 v23, v243, v187
v_dot2c_f32_bf16 v27, v187, v187
s_waitcnt lgkmcnt(0)
v_dot2c_f32_bf16 v20, v243, v188
v_dot2c_f32_bf16 v24, v188, v188
v_dot2c_f32_bf16 v21, v243, v189
v_dot2c_f32_bf16 v25, v189, v189
v_dot2c_f32_bf16 v22, v243, v190
v_dot2c_f32_bf16 v26, v190, v190
v_dot2c_f32_bf16 v23, v243, v191
v_dot2c_f32_bf16 v27, v191, v191
v_and_b32 v12, 15, v0
v_lshrrev_b32 v13, 2, v12
v_lshrrev_b32 v6, 5, v0
v_mul_u32_u24 v6, 8, v6
v_add_u32 v6, v6, v13
v_lshlrev_b32 v6, 7, v6
v_and_b32 v12, 3, v0
v_lshrrev_b32 v13, 2, v0
v_and_b32 v13, 4, v13
v_add_u32 v12, v12, v13
v_lshlrev_b32 v12, 3, v12
v_add_u32 v12, 56, v12
v_lshlrev_b32 v13, 3, v0
v_and_b32 v13, 64, v13
v_xor_b32 v12, v12, v13
v_add_u32 v6, v6, v12
s_cmp_eq_u32 s50, 1
s_cselect_b64 vcc, -1, 0
v_cndmask_b32 v6, v2, v6, vcc
s_barrier
v_add_u32 v16, 0xfffe8000, v16
v_add_u32 v17, 0xfffe8000, v17
v_add_u32 v18, 0xfffe8000, v18
v_add_u32 v19, 0xfffe8000, v19
ds_read_b128 v[192:195], v16 offset:0
ds_read_b128 v[196:199], v17 offset:0
ds_read_b128 v[200:203], v18 offset:0
ds_read_b128 v[204:207], v19 offset:0
ds_read_b128 v[208:211], v16 offset:16384
ds_read_b128 v[212:215], v17 offset:16384
ds_read_b128 v[216:219], v18 offset:16384
ds_read_b128 v[220:223], v19 offset:16384
s_waitcnt lgkmcnt(7)
v_dot2c_f32_bf16 v20, v243, v192
v_dot2c_f32_bf16 v24, v192, v192
v_dot2c_f32_bf16 v21, v243, v193
v_dot2c_f32_bf16 v25, v193, v193
v_dot2c_f32_bf16 v22, v243, v194
v_dot2c_f32_bf16 v26, v194, v194
v_dot2c_f32_bf16 v23, v243, v195
v_dot2c_f32_bf16 v27, v195, v195
s_waitcnt lgkmcnt(6)
v_dot2c_f32_bf16 v20, v243, v196
v_dot2c_f32_bf16 v24, v196, v196
v_dot2c_f32_bf16 v21, v243, v197
v_dot2c_f32_bf16 v25, v197, v197
v_dot2c_f32_bf16 v22, v243, v198
v_dot2c_f32_bf16 v26, v198, v198
v_dot2c_f32_bf16 v23, v243, v199
v_dot2c_f32_bf16 v27, v199, v199
s_waitcnt lgkmcnt(5)
v_dot2c_f32_bf16 v20, v243, v200
v_dot2c_f32_bf16 v24, v200, v200
v_dot2c_f32_bf16 v21, v243, v201
v_dot2c_f32_bf16 v25, v201, v201
v_dot2c_f32_bf16 v22, v243, v202
v_dot2c_f32_bf16 v26, v202, v202
v_dot2c_f32_bf16 v23, v243, v203
v_dot2c_f32_bf16 v27, v203, v203
s_waitcnt lgkmcnt(4)
v_dot2c_f32_bf16 v20, v243, v204
v_dot2c_f32_bf16 v24, v204, v204
v_dot2c_f32_bf16 v21, v243, v205
v_dot2c_f32_bf16 v25, v205, v205
v_dot2c_f32_bf16 v22, v243, v206
v_dot2c_f32_bf16 v26, v206, v206
v_dot2c_f32_bf16 v23, v243, v207
v_dot2c_f32_bf16 v27, v207, v207
s_waitcnt lgkmcnt(3)
v_dot2c_f32_bf16 v20, v243, v208
v_dot2c_f32_bf16 v24, v208, v208
v_dot2c_f32_bf16 v21, v243, v209
v_dot2c_f32_bf16 v25, v209, v209
v_dot2c_f32_bf16 v22, v243, v210
v_dot2c_f32_bf16 v26, v210, v210
v_dot2c_f32_bf16 v23, v243, v211
v_dot2c_f32_bf16 v27, v211, v211
s_waitcnt lgkmcnt(2)
v_dot2c_f32_bf16 v20, v243, v212
v_dot2c_f32_bf16 v24, v212, v212
v_dot2c_f32_bf16 v21, v243, v213
v_dot2c_f32_bf16 v25, v213, v213
v_dot2c_f32_bf16 v22, v243, v214
v_dot2c_f32_bf16 v26, v214, v214
v_dot2c_f32_bf16 v23, v243, v215
v_dot2c_f32_bf16 v27, v215, v215
s_waitcnt lgkmcnt(1)
v_dot2c_f32_bf16 v20, v243, v216
v_dot2c_f32_bf16 v24, v216, v216
v_dot2c_f32_bf16 v21, v243, v217
v_dot2c_f32_bf16 v25, v217, v217
v_dot2c_f32_bf16 v22, v243, v218
v_dot2c_f32_bf16 v26, v218, v218
v_dot2c_f32_bf16 v23, v243, v219
v_dot2c_f32_bf16 v27, v219, v219
s_waitcnt lgkmcnt(0)
v_dot2c_f32_bf16 v20, v243, v220
v_dot2c_f32_bf16 v24, v220, v220
v_dot2c_f32_bf16 v21, v243, v221
v_dot2c_f32_bf16 v25, v221, v221
v_dot2c_f32_bf16 v22, v243, v222
v_dot2c_f32_bf16 v26, v222, v222
v_dot2c_f32_bf16 v23, v243, v223
v_dot2c_f32_bf16 v27, v223, v223
v_and_b32 v12, 31, v0
v_cmp_eq_u32 s[62:63], 28, v12
v_cmp_lt_u32 s[64:65], 31, v0
v_lshlrev_b32 v3, 4, v0
s_lshl_b32 s58, s44, 13
v_add_u32 v5, s58, v3
v_cmp_eq_u32 vcc, 0, v0
v_mov_b32 v12, 0x40000000
s_nop 0
v_cndmask_b32 v4, v12, v0, vcc
v_mov_b32 v242, 0xbdd2d3e8
s_mov_b32 s60, 0xffff0000
s_mov_b32 s68, 0x3fb8aa3b
s_mul_i32 s66, s54, 144
s_lshl_b32 s58, s52, 3
s_add_u32 s66, s66, s58
s_lshl_b32 s66, s66, 10
s_lshl_b32 s58, s3, 12
s_add_u32 s66, s66, s58
s_lshl_b32 s67, s45, 15
s_lshl_b32 s58, s44, 12
s_add_u32 s67, s67, s58
s_lshl_b32 s58, s52, 7
s_add_u32 s67, s67, s58
s_add_u32 s67, s67, 10551296
s_barrier
ds_read_b128 v[224:227], v16 offset:32768
ds_read_b128 v[228:231], v17 offset:32768
ds_read_b128 v[232:235], v18 offset:32768
ds_read_b128 v[236:239], v19 offset:32768
s_waitcnt lgkmcnt(3)
v_dot2c_f32_bf16 v20, v243, v224
v_dot2c_f32_bf16 v24, v224, v224
v_dot2c_f32_bf16 v21, v243, v225
v_dot2c_f32_bf16 v25, v225, v225
v_dot2c_f32_bf16 v22, v243, v226
v_dot2c_f32_bf16 v26, v226, v226
v_dot2c_f32_bf16 v23, v243, v227
v_dot2c_f32_bf16 v27, v227, v227
s_waitcnt lgkmcnt(2)
v_dot2c_f32_bf16 v20, v243, v228
v_dot2c_f32_bf16 v24, v228, v228
v_dot2c_f32_bf16 v21, v243, v229
v_dot2c_f32_bf16 v25, v229, v229
v_dot2c_f32_bf16 v22, v243, v230
v_dot2c_f32_bf16 v26, v230, v230
v_dot2c_f32_bf16 v23, v243, v231
v_dot2c_f32_bf16 v27, v231, v231
s_waitcnt lgkmcnt(1)
v_dot2c_f32_bf16 v20, v243, v232
v_dot2c_f32_bf16 v24, v232, v232
v_dot2c_f32_bf16 v21, v243, v233
v_dot2c_f32_bf16 v25, v233, v233
v_dot2c_f32_bf16 v22, v243, v234
v_dot2c_f32_bf16 v26, v234, v234
v_dot2c_f32_bf16 v23, v243, v235
v_dot2c_f32_bf16 v27, v235, v235
s_waitcnt lgkmcnt(0)
v_dot2c_f32_bf16 v20, v243, v236
v_dot2c_f32_bf16 v24, v236, v236
v_dot2c_f32_bf16 v21, v243, v237
v_dot2c_f32_bf16 v25, v237, v237
v_dot2c_f32_bf16 v22, v243, v238
v_dot2c_f32_bf16 v26, v238, v238
v_dot2c_f32_bf16 v23, v243, v239
v_dot2c_f32_bf16 v27, v239, v239
v_add_f32 v20, v20, v21
s_nop 0
v_add_f32 v22, v22, v23
v_add_f32 v24, v24, v25
v_add_f32 v26, v26, v27
v_add_f32 v20, v20, v22
v_add_f32 v22, v24, v26
v_mov_b32 v21, v20
v_mov_b32 v23, v22
s_nop 0
v_permlane32_swap_b32 v20, v21
v_permlane32_swap_b32 v22, v23
v_add_f32 v20, v20, v21
v_add_f32 v22, v22, v23
v_mul_f32 v20, 0x3b124925, v20
v_mul_f32 v22, 0x3b124925, v22
v_fma_f32 v22, -v20, v20, v22
v_max_f32 v22, 0, v22
v_cvt_pk_bf16_f32 v21, v20, v22
v_lshlrev_b32 v20, 16, v21
v_and_b32 v22, 0xffff0000, v21
v_add_f32 v22, 0x3727c5ac, v22
v_cvt_pk_bf16_f32 v22, v22, v22
v_lshlrev_b32 v22, 16, v22
v_sqrt_f32 v22, v22
s_nop 0
v_cvt_pk_bf16_f32 v22, v22, v22
v_lshlrev_b32 v22, 16, v22
v_rcp_f32 v240, v22
s_nop 0
v_mul_f32 v241, v20, v240
v_sub_f32 v241, 0, v241
s_barrier
ds_read_b64_tr_b16 v[8:9], v1 offset:49152
ds_read_b64_tr_b16 v[10:11], v1 offset:49664
ds_read_b64_tr_b16 v[12:13], v6 offset:49152
ds_read_b64_tr_b16 v[14:15], v6 offset:49664
ds_read_b64_tr_b16 v[16:17], v1 offset:51200
ds_read_b64_tr_b16 v[18:19], v1 offset:51712
ds_read_b64_tr_b16 v[20:21], v6 offset:51200
ds_read_b64_tr_b16 v[22:23], v6 offset:51712
v_lshlrev_b32 v244, 16, v128
v_and_b32 v245, s60, v128
v_fma_f32 v244, v244, v240, v241
v_fma_f32 v245, v245, v240, v241
v_cvt_pk_bf16_f32 v128, v244, v245
v_lshlrev_b32 v246, 16, v129
v_and_b32 v247, s60, v129
v_fma_f32 v246, v246, v240, v241
v_fma_f32 v247, v247, v240, v241
v_cvt_pk_bf16_f32 v129, v246, v247
v_lshlrev_b32 v244, 16, v130
v_and_b32 v245, s60, v130
v_fma_f32 v244, v244, v240, v241
v_fma_f32 v245, v245, v240, v241
v_cvt_pk_bf16_f32 v130, v244, v245
v_lshlrev_b32 v246, 16, v131
v_and_b32 v247, s60, v131
v_fma_f32 v246, v246, v240, v241
v_fma_f32 v247, v247, v240, v241
v_cvt_pk_bf16_f32 v131, v246, v247
v_lshlrev_b32 v244, 16, v132
v_and_b32 v245, s60, v132
v_fma_f32 v244, v244, v240, v241
v_fma_f32 v245, v245, v240, v241
v_cvt_pk_bf16_f32 v132, v244, v245
v_lshlrev_b32 v246, 16, v133
v_and_b32 v247, s60, v133
v_fma_f32 v246, v246, v240, v241
v_fma_f32 v247, v247, v240, v241
v_cvt_pk_bf16_f32 v133, v246, v247
v_lshlrev_b32 v244, 16, v134
v_and_b32 v245, s60, v134
v_fma_f32 v244, v244, v240, v241
v_fma_f32 v245, v245, v240, v241
v_cvt_pk_bf16_f32 v134, v244, v245
v_lshlrev_b32 v246, 16, v135
v_and_b32 v247, s60, v135
v_fma_f32 v246, v246, v240, v241
v_fma_f32 v247, v247, v240, v241
v_cvt_pk_bf16_f32 v135, v246, v247
s_waitcnt lgkmcnt(4)
v_mfma_f32_32x32x16_bf16 v[64:79], v[8:11], v[128:131], 0
ds_read_b64_tr_b16 v[24:25], v1 offset:53248
ds_read_b64_tr_b16 v[26:27], v1 offset:53760
v_lshlrev_b32 v244, 16, v136
v_and_b32 v245, s60, v136
v_fma_f32 v244, v244, v240, v241
v_fma_f32 v245, v245, v240, v241
v_cvt_pk_bf16_f32 v136, v244, v245
v_lshlrev_b32 v246, 16, v137
v_and_b32 v247, s60, v137
v_fma_f32 v246, v246, v240, v241
v_fma_f32 v247, v247, v240, v241
v_cvt_pk_bf16_f32 v137, v246, v247
v_lshlrev_b32 v244, 16, v138
v_mfma_f32_32x32x16_bf16 v[80:95], v[12:15], v[128:131], 0
ds_read_b64_tr_b16 v[28:29], v6 offset:53248
ds_read_b64_tr_b16 v[30:31], v6 offset:53760
v_and_b32 v245, s60, v138
v_fma_f32 v244, v244, v240, v241
v_fma_f32 v245, v245, v240, v241
v_cvt_pk_bf16_f32 v138, v244, v245
v_lshlrev_b32 v246, 16, v139
v_and_b32 v247, s60, v139
v_fma_f32 v246, v246, v240, v241
v_fma_f32 v247, v247, v240, v241
v_cvt_pk_bf16_f32 v139, v246, v247
s_waitcnt lgkmcnt(4)
v_mfma_f32_32x32x16_bf16 v[64:79], v[16:19], v[132:135], v[64:79]
ds_read_b64_tr_b16 v[8:9], v1 offset:55296
ds_read_b64_tr_b16 v[10:11], v1 offset:55808
v_lshlrev_b32 v244, 16, v140
v_and_b32 v245, s60, v140
v_fma_f32 v244, v244, v240, v241
v_fma_f32 v245, v245, v240, v241
v_cvt_pk_bf16_f32 v140, v244, v245
v_lshlrev_b32 v246, 16, v141
v_and_b32 v247, s60, v141
v_fma_f32 v246, v246, v240, v241
v_fma_f32 v247, v247, v240, v241
v_cvt_pk_bf16_f32 v141, v246, v247
v_lshlrev_b32 v244, 16, v142
v_mfma_f32_32x32x16_bf16 v[80:95], v[20:23], v[132:135], v[80:95]
ds_read_b64_tr_b16 v[12:13], v6 offset:55296
ds_read_b64_tr_b16 v[14:15], v6 offset:55808
v_and_b32 v245, s60, v142
v_fma_f32 v244, v244, v240, v241
v_fma_f32 v245, v245, v240, v241
v_cvt_pk_bf16_f32 v142, v244, v245
v_lshlrev_b32 v246, 16, v143
v_and_b32 v247, s60, v143
v_fma_f32 v246, v246, v240, v241
v_fma_f32 v247, v247, v240, v241
v_cvt_pk_bf16_f32 v143, v246, v247
v_mov_b32 v252, 0
buffer_load_dword v7, v252, s[32:35], 0 offen sc1
s_waitcnt lgkmcnt(4)
v_mfma_f32_32x32x16_bf16 v[64:79], v[24:27], v[136:139], v[64:79]
ds_read_b64_tr_b16 v[16:17], v1 offset:57344
ds_read_b64_tr_b16 v[18:19], v1 offset:57856
v_lshlrev_b32 v244, 16, v144
v_and_b32 v245, s60, v144
v_fma_f32 v244, v244, v240, v241
v_fma_f32 v245, v245, v240, v241
v_cvt_pk_bf16_f32 v144, v244, v245
v_lshlrev_b32 v246, 16, v145
v_and_b32 v247, s60, v145
v_fma_f32 v246, v246, v240, v241
v_fma_f32 v247, v247, v240, v241
v_cvt_pk_bf16_f32 v145, v246, v247
v_lshlrev_b32 v244, 16, v146
v_mfma_f32_32x32x16_bf16 v[80:95], v[28:31], v[136:139], v[80:95]
ds_read_b64_tr_b16 v[20:21], v6 offset:57344
ds_read_b64_tr_b16 v[22:23], v6 offset:57856
v_and_b32 v245, s60, v146
v_fma_f32 v244, v244, v240, v241
v_fma_f32 v245, v245, v240, v241
v_cvt_pk_bf16_f32 v146, v244, v245
v_lshlrev_b32 v246, 16, v147
v_and_b32 v247, s60, v147
v_fma_f32 v246, v246, v240, v241
v_fma_f32 v247, v247, v240, v241
v_cvt_pk_bf16_f32 v147, v246, v247
s_waitcnt lgkmcnt(4)
v_mfma_f32_32x32x16_bf16 v[64:79], v[8:11], v[140:143], v[64:79]
ds_read_b64_tr_b16 v[24:25], v1 offset:59392
ds_read_b64_tr_b16 v[26:27], v1 offset:59904
v_lshlrev_b32 v244, 16, v148
v_and_b32 v245, s60, v148
v_fma_f32 v244, v244, v240, v241
v_fma_f32 v245, v245, v240, v241
v_cvt_pk_bf16_f32 v148, v244, v245
v_lshlrev_b32 v246, 16, v149
v_and_b32 v247, s60, v149
v_fma_f32 v246, v246, v240, v241
v_fma_f32 v247, v247, v240, v241
v_cvt_pk_bf16_f32 v149, v246, v247
v_lshlrev_b32 v244, 16, v150
v_mfma_f32_32x32x16_bf16 v[80:95], v[12:15], v[140:143], v[80:95]
ds_read_b64_tr_b16 v[28:29], v6 offset:59392
ds_read_b64_tr_b16 v[30:31], v6 offset:59904
v_and_b32 v245, s60, v150
v_fma_f32 v244, v244, v240, v241
v_fma_f32 v245, v245, v240, v241
v_cvt_pk_bf16_f32 v150, v244, v245
v_lshlrev_b32 v246, 16, v151
v_and_b32 v247, s60, v151
v_fma_f32 v246, v246, v240, v241
v_fma_f32 v247, v247, v240, v241
v_cvt_pk_bf16_f32 v151, v246, v247
s_waitcnt lgkmcnt(4)
v_mfma_f32_32x32x16_bf16 v[64:79], v[16:19], v[144:147], v[64:79]
ds_read_b64_tr_b16 v[8:9], v1 offset:61440
ds_read_b64_tr_b16 v[10:11], v1 offset:61952
v_lshlrev_b32 v244, 16, v152
v_and_b32 v245, s60, v152
v_fma_f32 v244, v244, v240, v241
v_fma_f32 v245, v245, v240, v241
v_cvt_pk_bf16_f32 v152, v244, v245
v_lshlrev_b32 v246, 16, v153
v_and_b32 v247, s60, v153
v_fma_f32 v246, v246, v240, v241
v_fma_f32 v247, v247, v240, v241
v_cvt_pk_bf16_f32 v153, v246, v247
v_lshlrev_b32 v244, 16, v154
v_mfma_f32_32x32x16_bf16 v[80:95], v[20:23], v[144:147], v[80:95]
ds_read_b64_tr_b16 v[12:13], v6 offset:61440
ds_read_b64_tr_b16 v[14:15], v6 offset:61952
v_and_b32 v245, s60, v154
v_fma_f32 v244, v244, v240, v241
v_fma_f32 v245, v245, v240, v241
v_cvt_pk_bf16_f32 v154, v244, v245
v_lshlrev_b32 v246, 16, v155
v_and_b32 v247, s60, v155
v_fma_f32 v246, v246, v240, v241
v_fma_f32 v247, v247, v240, v241
v_cvt_pk_bf16_f32 v155, v246, v247
s_waitcnt lgkmcnt(4)
v_mfma_f32_32x32x16_bf16 v[64:79], v[24:27], v[148:151], v[64:79]
ds_read_b64_tr_b16 v[16:17], v1 offset:63488
ds_read_b64_tr_b16 v[18:19], v1 offset:64000
v_lshlrev_b32 v244, 16, v156
v_and_b32 v245, s60, v156
v_fma_f32 v244, v244, v240, v241
v_fma_f32 v245, v245, v240, v241
v_cvt_pk_bf16_f32 v156, v244, v245
v_lshlrev_b32 v246, 16, v157
v_and_b32 v247, s60, v157
v_fma_f32 v246, v246, v240, v241
v_fma_f32 v247, v247, v240, v241
v_cvt_pk_bf16_f32 v157, v246, v247
v_lshlrev_b32 v244, 16, v158
v_mfma_f32_32x32x16_bf16 v[80:95], v[28:31], v[148:151], v[80:95]
ds_read_b64_tr_b16 v[20:21], v6 offset:63488
ds_read_b64_tr_b16 v[22:23], v6 offset:64000
v_and_b32 v245, s60, v158
v_fma_f32 v244, v244, v240, v241
v_fma_f32 v245, v245, v240, v241
v_cvt_pk_bf16_f32 v158, v244, v245
v_lshlrev_b32 v246, 16, v159
v_and_b32 v247, s60, v159
v_fma_f32 v246, v246, v240, v241
v_fma_f32 v247, v247, v240, v241
v_cvt_pk_bf16_f32 v159, v246, v247
s_waitcnt lgkmcnt(4)
v_mfma_f32_32x32x16_bf16 v[64:79], v[8:11], v[152:155], v[64:79]
v_add_u32 v1, 0x00010000, v1
v_add_u32 v6, 0x00010000, v6
v_add_u32 v2, 0x00010000, v2
ds_read_b64_tr_b16 v[24:25], v1 offset:0
ds_read_b64_tr_b16 v[26:27], v1 offset:512
v_lshlrev_b32 v244, 16, v160
v_and_b32 v245, s60, v160
v_fma_f32 v244, v244, v240, v241
v_fma_f32 v245, v245, v240, v241
v_cvt_pk_bf16_f32 v160, v244, v245
v_lshlrev_b32 v246, 16, v161
v_and_b32 v247, s60, v161
v_fma_f32 v246, v246, v240, v241
v_fma_f32 v247, v247, v240, v241
v_cvt_pk_bf16_f32 v161, v246, v247
v_lshlrev_b32 v244, 16, v162
v_mfma_f32_32x32x16_bf16 v[80:95], v[12:15], v[152:155], v[80:95]
ds_read_b64_tr_b16 v[28:29], v6 offset:0
ds_read_b64_tr_b16 v[30:31], v6 offset:512
v_and_b32 v245, s60, v162
v_fma_f32 v244, v244, v240, v241
v_fma_f32 v245, v245, v240, v241
v_cvt_pk_bf16_f32 v162, v244, v245
v_lshlrev_b32 v246, 16, v163
v_and_b32 v247, s60, v163
v_fma_f32 v246, v246, v240, v241
v_fma_f32 v247, v247, v240, v241
v_cvt_pk_bf16_f32 v163, v246, v247
s_waitcnt lgkmcnt(4)
v_mfma_f32_32x32x16_bf16 v[64:79], v[16:19], v[156:159], v[64:79]
ds_read_b64_tr_b16 v[8:9], v1 offset:2048
ds_read_b64_tr_b16 v[10:11], v1 offset:2560
v_lshlrev_b32 v244, 16, v164
v_and_b32 v245, s60, v164
v_fma_f32 v244, v244, v240, v241
v_fma_f32 v245, v245, v240, v241
v_cvt_pk_bf16_f32 v164, v244, v245
v_lshlrev_b32 v246, 16, v165
v_and_b32 v247, s60, v165
v_fma_f32 v246, v246, v240, v241
v_fma_f32 v247, v247, v240, v241
v_cvt_pk_bf16_f32 v165, v246, v247
v_lshlrev_b32 v244, 16, v166
v_mfma_f32_32x32x16_bf16 v[80:95], v[20:23], v[156:159], v[80:95]
ds_read_b64_tr_b16 v[12:13], v6 offset:2048
ds_read_b64_tr_b16 v[14:15], v6 offset:2560
v_and_b32 v245, s60, v166
v_fma_f32 v244, v244, v240, v241
v_fma_f32 v245, v245, v240, v241
v_cvt_pk_bf16_f32 v166, v244, v245
v_lshlrev_b32 v246, 16, v167
v_and_b32 v247, s60, v167
v_fma_f32 v246, v246, v240, v241
v_fma_f32 v247, v247, v240, v241
v_cvt_pk_bf16_f32 v167, v246, v247
s_waitcnt lgkmcnt(4)
v_mfma_f32_32x32x16_bf16 v[64:79], v[24:27], v[160:163], v[64:79]
ds_read_b64_tr_b16 v[16:17], v1 offset:4096
ds_read_b64_tr_b16 v[18:19], v1 offset:4608
v_lshlrev_b32 v244, 16, v168
v_and_b32 v245, s60, v168
v_fma_f32 v244, v244, v240, v241
v_fma_f32 v245, v245, v240, v241
v_cvt_pk_bf16_f32 v168, v244, v245
v_lshlrev_b32 v246, 16, v169
v_and_b32 v247, s60, v169
v_fma_f32 v246, v246, v240, v241
v_fma_f32 v247, v247, v240, v241
v_cvt_pk_bf16_f32 v169, v246, v247
v_lshlrev_b32 v244, 16, v170
v_mfma_f32_32x32x16_bf16 v[80:95], v[28:31], v[160:163], v[80:95]
ds_read_b64_tr_b16 v[20:21], v6 offset:4096
ds_read_b64_tr_b16 v[22:23], v6 offset:4608
v_and_b32 v245, s60, v170
v_fma_f32 v244, v244, v240, v241
v_fma_f32 v245, v245, v240, v241
v_cvt_pk_bf16_f32 v170, v244, v245
v_lshlrev_b32 v246, 16, v171
v_and_b32 v247, s60, v171
v_fma_f32 v246, v246, v240, v241
v_fma_f32 v247, v247, v240, v241
v_cvt_pk_bf16_f32 v171, v246, v247
s_waitcnt lgkmcnt(4)
v_mfma_f32_32x32x16_bf16 v[64:79], v[8:11], v[164:167], v[64:79]
ds_read_b64_tr_b16 v[24:25], v1 offset:6144
ds_read_b64_tr_b16 v[26:27], v1 offset:6656
v_lshlrev_b32 v244, 16, v172
v_and_b32 v245, s60, v172
v_fma_f32 v244, v244, v240, v241
v_fma_f32 v245, v245, v240, v241
v_cvt_pk_bf16_f32 v172, v244, v245
v_lshlrev_b32 v246, 16, v173
v_and_b32 v247, s60, v173
v_fma_f32 v246, v246, v240, v241
v_fma_f32 v247, v247, v240, v241
v_cvt_pk_bf16_f32 v173, v246, v247
v_lshlrev_b32 v244, 16, v174
v_mfma_f32_32x32x16_bf16 v[80:95], v[12:15], v[164:167], v[80:95]
ds_read_b64_tr_b16 v[28:29], v6 offset:6144
ds_read_b64_tr_b16 v[30:31], v6 offset:6656
v_and_b32 v245, s60, v174
v_fma_f32 v244, v244, v240, v241
v_fma_f32 v245, v245, v240, v241
v_cvt_pk_bf16_f32 v174, v244, v245
v_lshlrev_b32 v246, 16, v175
v_and_b32 v247, s60, v175
v_fma_f32 v246, v246, v240, v241
v_fma_f32 v247, v247, v240, v241
v_cvt_pk_bf16_f32 v175, v246, v247
s_barrier
s_waitcnt lgkmcnt(4)
v_mfma_f32_32x32x16_bf16 v[64:79], v[16:19], v[168:171], v[64:79]
ds_read_b64_tr_b16 v[8:9], v1 offset:8192
ds_read_b64_tr_b16 v[10:11], v1 offset:8704
v_lshlrev_b32 v244, 16, v176
v_and_b32 v245, s60, v176
v_fma_f32 v244, v244, v240, v241
v_fma_f32 v245, v245, v240, v241
v_cvt_pk_bf16_f32 v176, v244, v245
v_lshlrev_b32 v246, 16, v177
v_and_b32 v247, s60, v177
v_fma_f32 v246, v246, v240, v241
v_fma_f32 v247, v247, v240, v241
v_cvt_pk_bf16_f32 v177, v246, v247
v_lshlrev_b32 v244, 16, v178
v_mfma_f32_32x32x16_bf16 v[80:95], v[20:23], v[168:171], v[80:95]
ds_read_b64_tr_b16 v[12:13], v6 offset:8192
ds_read_b64_tr_b16 v[14:15], v6 offset:8704
v_and_b32 v245, s60, v178
v_fma_f32 v244, v244, v240, v241
v_fma_f32 v245, v245, v240, v241
v_cvt_pk_bf16_f32 v178, v244, v245
v_lshlrev_b32 v246, 16, v179
v_and_b32 v247, s60, v179
v_fma_f32 v246, v246, v240, v241
v_fma_f32 v247, v247, v240, v241
v_cvt_pk_bf16_f32 v179, v246, v247
s_waitcnt lgkmcnt(4)
v_mfma_f32_32x32x16_bf16 v[64:79], v[24:27], v[172:175], v[64:79]
ds_read_b64_tr_b16 v[16:17], v1 offset:10240
ds_read_b64_tr_b16 v[18:19], v1 offset:10752
v_lshlrev_b32 v244, 16, v180
v_and_b32 v245, s60, v180
v_fma_f32 v244, v244, v240, v241
v_fma_f32 v245, v245, v240, v241
v_cvt_pk_bf16_f32 v180, v244, v245
v_lshlrev_b32 v246, 16, v181
v_and_b32 v247, s60, v181
v_fma_f32 v246, v246, v240, v241
v_fma_f32 v247, v247, v240, v241
v_cvt_pk_bf16_f32 v181, v246, v247
v_lshlrev_b32 v244, 16, v182
v_mfma_f32_32x32x16_bf16 v[80:95], v[28:31], v[172:175], v[80:95]
ds_read_b64_tr_b16 v[20:21], v6 offset:10240
ds_read_b64_tr_b16 v[22:23], v6 offset:10752
v_and_b32 v245, s60, v182
v_fma_f32 v244, v244, v240, v241
v_fma_f32 v245, v245, v240, v241
v_cvt_pk_bf16_f32 v182, v244, v245
v_lshlrev_b32 v246, 16, v183
v_and_b32 v247, s60, v183
v_fma_f32 v246, v246, v240, v241
v_fma_f32 v247, v247, v240, v241
v_cvt_pk_bf16_f32 v183, v246, v247
s_waitcnt lgkmcnt(4)
v_mfma_f32_32x32x16_bf16 v[64:79], v[8:11], v[176:179], v[64:79]
ds_read_b64_tr_b16 v[24:25], v1 offset:12288
ds_read_b64_tr_b16 v[26:27], v1 offset:12800
v_lshlrev_b32 v244, 16, v184
v_and_b32 v245, s60, v184
v_fma_f32 v244, v244, v240, v241
v_fma_f32 v245, v245, v240, v241
v_cvt_pk_bf16_f32 v184, v244, v245
v_lshlrev_b32 v246, 16, v185
v_and_b32 v247, s60, v185
v_fma_f32 v246, v246, v240, v241
v_fma_f32 v247, v247, v240, v241
v_cvt_pk_bf16_f32 v185, v246, v247
v_lshlrev_b32 v244, 16, v186
v_mfma_f32_32x32x16_bf16 v[80:95], v[12:15], v[176:179], v[80:95]
ds_read_b64_tr_b16 v[28:29], v6 offset:12288
ds_read_b64_tr_b16 v[30:31], v6 offset:12800
v_and_b32 v245, s60, v186
v_fma_f32 v244, v244, v240, v241
v_fma_f32 v245, v245, v240, v241
v_cvt_pk_bf16_f32 v186, v244, v245
v_lshlrev_b32 v246, 16, v187
v_and_b32 v247, s60, v187
v_fma_f32 v246, v246, v240, v241
v_fma_f32 v247, v247, v240, v241
v_cvt_pk_bf16_f32 v187, v246, v247
s_waitcnt lgkmcnt(4)
v_mfma_f32_32x32x16_bf16 v[64:79], v[16:19], v[180:183], v[64:79]
ds_read_b64_tr_b16 v[8:9], v1 offset:14336
ds_read_b64_tr_b16 v[10:11], v1 offset:14848
v_lshlrev_b32 v244, 16, v188
v_and_b32 v245, s60, v188
v_fma_f32 v244, v244, v240, v241
v_fma_f32 v245, v245, v240, v241
v_cvt_pk_bf16_f32 v188, v244, v245
v_lshlrev_b32 v246, 16, v189
v_and_b32 v247, s60, v189
v_fma_f32 v246, v246, v240, v241
v_fma_f32 v247, v247, v240, v241
v_cvt_pk_bf16_f32 v189, v246, v247
v_lshlrev_b32 v244, 16, v190
v_mfma_f32_32x32x16_bf16 v[80:95], v[20:23], v[180:183], v[80:95]
ds_read_b64_tr_b16 v[12:13], v6 offset:14336
ds_read_b64_tr_b16 v[14:15], v6 offset:14848
v_and_b32 v245, s60, v190
v_fma_f32 v244, v244, v240, v241
v_fma_f32 v245, v245, v240, v241
v_cvt_pk_bf16_f32 v190, v244, v245
v_lshlrev_b32 v246, 16, v191
v_and_b32 v247, s60, v191
v_fma_f32 v246, v246, v240, v241
v_fma_f32 v247, v247, v240, v241
v_cvt_pk_bf16_f32 v191, v246, v247
s_waitcnt lgkmcnt(4)
v_mfma_f32_32x32x16_bf16 v[64:79], v[24:27], v[184:187], v[64:79]
ds_read_b64_tr_b16 v[16:17], v1 offset:16384
ds_read_b64_tr_b16 v[18:19], v1 offset:16896
v_lshlrev_b32 v244, 16, v192
v_and_b32 v245, s60, v192
v_fma_f32 v244, v244, v240, v241
v_fma_f32 v245, v245, v240, v241
v_cvt_pk_bf16_f32 v192, v244, v245
v_lshlrev_b32 v246, 16, v193
v_and_b32 v247, s60, v193
v_fma_f32 v246, v246, v240, v241
v_fma_f32 v247, v247, v240, v241
v_cvt_pk_bf16_f32 v193, v246, v247
v_lshlrev_b32 v244, 16, v194
v_mfma_f32_32x32x16_bf16 v[80:95], v[28:31], v[184:187], v[80:95]
ds_read_b64_tr_b16 v[20:21], v6 offset:16384
ds_read_b64_tr_b16 v[22:23], v6 offset:16896
v_and_b32 v245, s60, v194
v_fma_f32 v244, v244, v240, v241
v_fma_f32 v245, v245, v240, v241
v_cvt_pk_bf16_f32 v194, v244, v245
v_lshlrev_b32 v246, 16, v195
v_and_b32 v247, s60, v195
v_fma_f32 v246, v246, v240, v241
v_fma_f32 v247, v247, v240, v241
v_cvt_pk_bf16_f32 v195, v246, v247
s_waitcnt lgkmcnt(4)
v_mfma_f32_32x32x16_bf16 v[64:79], v[8:11], v[188:191], v[64:79]
ds_read_b64_tr_b16 v[24:25], v1 offset:18432
ds_read_b64_tr_b16 v[26:27], v1 offset:18944
v_lshlrev_b32 v244, 16, v196
v_and_b32 v245, s60, v196
v_fma_f32 v244, v244, v240, v241
v_fma_f32 v245, v245, v240, v241
v_cvt_pk_bf16_f32 v196, v244, v245
v_lshlrev_b32 v246, 16, v197
v_and_b32 v247, s60, v197
v_fma_f32 v246, v246, v240, v241
v_fma_f32 v247, v247, v240, v241
v_cvt_pk_bf16_f32 v197, v246, v247
v_lshlrev_b32 v244, 16, v198
v_mfma_f32_32x32x16_bf16 v[80:95], v[12:15], v[188:191], v[80:95]
ds_read_b64_tr_b16 v[28:29], v6 offset:18432
ds_read_b64_tr_b16 v[30:31], v6 offset:18944
v_and_b32 v245, s60, v198
v_fma_f32 v244, v244, v240, v241
v_fma_f32 v245, v245, v240, v241
v_cvt_pk_bf16_f32 v198, v244, v245
v_lshlrev_b32 v246, 16, v199
v_and_b32 v247, s60, v199
v_fma_f32 v246, v246, v240, v241
v_fma_f32 v247, v247, v240, v241
v_cvt_pk_bf16_f32 v199, v246, v247
s_waitcnt lgkmcnt(4)
v_mfma_f32_32x32x16_bf16 v[64:79], v[16:19], v[192:195], v[64:79]
ds_read_b64_tr_b16 v[8:9], v1 offset:20480
ds_read_b64_tr_b16 v[10:11], v1 offset:20992
v_lshlrev_b32 v244, 16, v200
v_and_b32 v245, s60, v200
v_fma_f32 v244, v244, v240, v241
v_fma_f32 v245, v245, v240, v241
v_cvt_pk_bf16_f32 v200, v244, v245
v_lshlrev_b32 v246, 16, v201
v_and_b32 v247, s60, v201
v_fma_f32 v246, v246, v240, v241
v_fma_f32 v247, v247, v240, v241
v_cvt_pk_bf16_f32 v201, v246, v247
v_lshlrev_b32 v244, 16, v202
v_mfma_f32_32x32x16_bf16 v[80:95], v[20:23], v[192:195], v[80:95]
ds_read_b64_tr_b16 v[12:13], v6 offset:20480
ds_read_b64_tr_b16 v[14:15], v6 offset:20992
v_and_b32 v245, s60, v202
v_fma_f32 v244, v244, v240, v241
v_fma_f32 v245, v245, v240, v241
v_cvt_pk_bf16_f32 v202, v244, v245
v_lshlrev_b32 v246, 16, v203
v_and_b32 v247, s60, v203
v_fma_f32 v246, v246, v240, v241
v_fma_f32 v247, v247, v240, v241
v_cvt_pk_bf16_f32 v203, v246, v247
s_waitcnt lgkmcnt(4)
v_mfma_f32_32x32x16_bf16 v[64:79], v[24:27], v[196:199], v[64:79]
ds_read_b64_tr_b16 v[16:17], v1 offset:22528
ds_read_b64_tr_b16 v[18:19], v1 offset:23040
v_lshlrev_b32 v244, 16, v204
v_and_b32 v245, s60, v204
v_fma_f32 v244, v244, v240, v241
v_fma_f32 v245, v245, v240, v241
v_cvt_pk_bf16_f32 v204, v244, v245
v_lshlrev_b32 v246, 16, v205
v_and_b32 v247, s60, v205
v_fma_f32 v246, v246, v240, v241
v_fma_f32 v247, v247, v240, v241
v_cvt_pk_bf16_f32 v205, v246, v247
v_lshlrev_b32 v244, 16, v206
v_mfma_f32_32x32x16_bf16 v[80:95], v[28:31], v[196:199], v[80:95]
ds_read_b64_tr_b16 v[20:21], v6 offset:22528
ds_read_b64_tr_b16 v[22:23], v6 offset:23040
v_and_b32 v245, s60, v206
v_fma_f32 v244, v244, v240, v241
v_fma_f32 v245, v245, v240, v241
v_cvt_pk_bf16_f32 v206, v244, v245
v_lshlrev_b32 v246, 16, v207
v_and_b32 v247, s60, v207
v_fma_f32 v246, v246, v240, v241
v_fma_f32 v247, v247, v240, v241
v_cvt_pk_bf16_f32 v207, v246, v247
s_waitcnt lgkmcnt(4)
v_mfma_f32_32x32x16_bf16 v[64:79], v[8:11], v[200:203], v[64:79]
ds_read_b64_tr_b16 v[24:25], v1 offset:24576
ds_read_b64_tr_b16 v[26:27], v1 offset:25088
v_lshlrev_b32 v244, 16, v208
v_and_b32 v245, s60, v208
v_fma_f32 v244, v244, v240, v241
v_fma_f32 v245, v245, v240, v241
v_cvt_pk_bf16_f32 v208, v244, v245
v_lshlrev_b32 v246, 16, v209
v_and_b32 v247, s60, v209
v_fma_f32 v246, v246, v240, v241
v_fma_f32 v247, v247, v240, v241
v_cvt_pk_bf16_f32 v209, v246, v247
v_lshlrev_b32 v244, 16, v210
v_mfma_f32_32x32x16_bf16 v[80:95], v[12:15], v[200:203], v[80:95]
ds_read_b64_tr_b16 v[28:29], v6 offset:24576
ds_read_b64_tr_b16 v[30:31], v6 offset:25088
v_and_b32 v245, s60, v210
v_fma_f32 v244, v244, v240, v241
v_fma_f32 v245, v245, v240, v241
v_cvt_pk_bf16_f32 v210, v244, v245
v_lshlrev_b32 v246, 16, v211
v_and_b32 v247, s60, v211
v_fma_f32 v246, v246, v240, v241
v_fma_f32 v247, v247, v240, v241
v_cvt_pk_bf16_f32 v211, v246, v247
s_waitcnt lgkmcnt(4)
v_mfma_f32_32x32x16_bf16 v[64:79], v[16:19], v[204:207], v[64:79]
ds_read_b64_tr_b16 v[8:9], v1 offset:26624
ds_read_b64_tr_b16 v[10:11], v1 offset:27136
v_lshlrev_b32 v244, 16, v212
v_and_b32 v245, s60, v212
v_fma_f32 v244, v244, v240, v241
v_fma_f32 v245, v245, v240, v241
v_cvt_pk_bf16_f32 v212, v244, v245
v_lshlrev_b32 v246, 16, v213
v_and_b32 v247, s60, v213
v_fma_f32 v246, v246, v240, v241
v_fma_f32 v247, v247, v240, v241
v_cvt_pk_bf16_f32 v213, v246, v247
v_lshlrev_b32 v244, 16, v214
v_mfma_f32_32x32x16_bf16 v[80:95], v[20:23], v[204:207], v[80:95]
ds_read_b64_tr_b16 v[12:13], v6 offset:26624
ds_read_b64_tr_b16 v[14:15], v6 offset:27136
v_and_b32 v245, s60, v214
v_fma_f32 v244, v244, v240, v241
v_fma_f32 v245, v245, v240, v241
v_cvt_pk_bf16_f32 v214, v244, v245
v_lshlrev_b32 v246, 16, v215
v_and_b32 v247, s60, v215
v_fma_f32 v246, v246, v240, v241
v_fma_f32 v247, v247, v240, v241
v_cvt_pk_bf16_f32 v215, v246, v247
s_waitcnt lgkmcnt(4)
v_mfma_f32_32x32x16_bf16 v[64:79], v[24:27], v[208:211], v[64:79]
ds_read_b64_tr_b16 v[16:17], v1 offset:28672
ds_read_b64_tr_b16 v[18:19], v1 offset:29184
v_lshlrev_b32 v244, 16, v216
v_and_b32 v245, s60, v216
v_fma_f32 v244, v244, v240, v241
v_fma_f32 v245, v245, v240, v241
v_cvt_pk_bf16_f32 v216, v244, v245
v_lshlrev_b32 v246, 16, v217
v_and_b32 v247, s60, v217
v_fma_f32 v246, v246, v240, v241
v_fma_f32 v247, v247, v240, v241
v_cvt_pk_bf16_f32 v217, v246, v247
v_lshlrev_b32 v244, 16, v218
v_mfma_f32_32x32x16_bf16 v[80:95], v[28:31], v[208:211], v[80:95]
ds_read_b64_tr_b16 v[20:21], v6 offset:28672
ds_read_b64_tr_b16 v[22:23], v6 offset:29184
v_and_b32 v245, s60, v218
v_fma_f32 v244, v244, v240, v241
v_fma_f32 v245, v245, v240, v241
v_cvt_pk_bf16_f32 v218, v244, v245
v_lshlrev_b32 v246, 16, v219
v_and_b32 v247, s60, v219
v_fma_f32 v246, v246, v240, v241
v_fma_f32 v247, v247, v240, v241
v_cvt_pk_bf16_f32 v219, v246, v247
s_waitcnt lgkmcnt(4)
v_mfma_f32_32x32x16_bf16 v[64:79], v[8:11], v[212:215], v[64:79]
ds_read_b64_tr_b16 v[24:25], v1 offset:30720
ds_read_b64_tr_b16 v[26:27], v1 offset:31232
v_lshlrev_b32 v244, 16, v220
v_and_b32 v245, s60, v220
v_fma_f32 v244, v244, v240, v241
v_fma_f32 v245, v245, v240, v241
v_cvt_pk_bf16_f32 v220, v244, v245
v_lshlrev_b32 v246, 16, v221
v_and_b32 v247, s60, v221
v_fma_f32 v246, v246, v240, v241
v_fma_f32 v247, v247, v240, v241
v_cvt_pk_bf16_f32 v221, v246, v247
v_lshlrev_b32 v244, 16, v222
v_mfma_f32_32x32x16_bf16 v[80:95], v[12:15], v[212:215], v[80:95]
ds_read_b64_tr_b16 v[28:29], v6 offset:30720
ds_read_b64_tr_b16 v[30:31], v6 offset:31232
v_and_b32 v245, s60, v222
v_fma_f32 v244, v244, v240, v241
v_fma_f32 v245, v245, v240, v241
v_cvt_pk_bf16_f32 v222, v244, v245
v_lshlrev_b32 v246, 16, v223
v_and_b32 v247, s60, v223
v_fma_f32 v246, v246, v240, v241
v_fma_f32 v247, v247, v240, v241
v_cvt_pk_bf16_f32 v223, v246, v247
s_barrier
s_waitcnt lgkmcnt(4)
v_mfma_f32_32x32x16_bf16 v[64:79], v[16:19], v[216:219], v[64:79]
ds_read_b64_tr_b16 v[8:9], v1 offset:32768
ds_read_b64_tr_b16 v[10:11], v1 offset:33280
v_lshlrev_b32 v244, 16, v224
v_and_b32 v245, s60, v224
v_fma_f32 v244, v244, v240, v241
v_fma_f32 v245, v245, v240, v241
v_cvt_pk_bf16_f32 v224, v244, v245
v_lshlrev_b32 v246, 16, v225
v_and_b32 v247, s60, v225
v_fma_f32 v246, v246, v240, v241
v_fma_f32 v247, v247, v240, v241
v_cvt_pk_bf16_f32 v225, v246, v247
v_lshlrev_b32 v244, 16, v226
v_mfma_f32_32x32x16_bf16 v[80:95], v[20:23], v[216:219], v[80:95]
ds_read_b64_tr_b16 v[12:13], v6 offset:32768
ds_read_b64_tr_b16 v[14:15], v6 offset:33280
v_and_b32 v245, s60, v226
v_fma_f32 v244, v244, v240, v241
v_fma_f32 v245, v245, v240, v241
v_cvt_pk_bf16_f32 v226, v244, v245
v_lshlrev_b32 v246, 16, v227
v_and_b32 v247, s60, v227
v_fma_f32 v246, v246, v240, v241
v_fma_f32 v247, v247, v240, v241
v_cvt_pk_bf16_f32 v227, v246, v247
s_waitcnt lgkmcnt(4)
v_mfma_f32_32x32x16_bf16 v[64:79], v[24:27], v[220:223], v[64:79]
ds_read_b64_tr_b16 v[16:17], v1 offset:34816
ds_read_b64_tr_b16 v[18:19], v1 offset:35328
v_lshlrev_b32 v244, 16, v228
v_and_b32 v245, s60, v228
v_fma_f32 v244, v244, v240, v241
v_fma_f32 v245, v245, v240, v241
v_cvt_pk_bf16_f32 v228, v244, v245
v_lshlrev_b32 v246, 16, v229
v_and_b32 v247, s60, v229
v_fma_f32 v246, v246, v240, v241
v_fma_f32 v247, v247, v240, v241
v_cvt_pk_bf16_f32 v229, v246, v247
v_lshlrev_b32 v244, 16, v230
v_mfma_f32_32x32x16_bf16 v[80:95], v[28:31], v[220:223], v[80:95]
ds_read_b64_tr_b16 v[20:21], v6 offset:34816
ds_read_b64_tr_b16 v[22:23], v6 offset:35328
v_and_b32 v245, s60, v230
v_fma_f32 v244, v244, v240, v241
v_fma_f32 v245, v245, v240, v241
v_cvt_pk_bf16_f32 v230, v244, v245
v_lshlrev_b32 v246, 16, v231
v_and_b32 v247, s60, v231
v_fma_f32 v246, v246, v240, v241
v_fma_f32 v247, v247, v240, v241
v_cvt_pk_bf16_f32 v231, v246, v247
s_waitcnt vmcnt(0)
v_cmp_eq_u32 vcc, 0, v7
s_nop 1
s_cbranch_vccz L_tagc_x
s_mov_b32 s58, 0
v_mov_b32 v252, 0
L_tagc:
buffer_load_dword v7, v252, s[32:35], 0 offen sc1
s_add_u32 s58, s58, 1
s_waitcnt vmcnt(0)
v_cmp_eq_u32 vcc, 0, v7
s_cmp_gt_u32 s58, 0x40000
s_cbranch_scc1 L_tagc_x
s_cbranch_vccnz L_tagc
L_tagc_x:
s_waitcnt lgkmcnt(4)
v_mfma_f32_32x32x16_bf16 v[64:79], v[8:11], v[224:227], v[64:79]
ds_read_b64_tr_b16 v[24:25], v1 offset:36864
ds_read_b64_tr_b16 v[26:27], v1 offset:37376
v_lshlrev_b32 v244, 16, v232
v_and_b32 v245, s60, v232
v_fma_f32 v244, v244, v240, v241
v_fma_f32 v245, v245, v240, v241
v_cvt_pk_bf16_f32 v232, v244, v245
v_lshlrev_b32 v246, 16, v233
v_and_b32 v247, s60, v233
v_fma_f32 v246, v246, v240, v241
v_fma_f32 v247, v247, v240, v241
v_cvt_pk_bf16_f32 v233, v246, v247
v_lshlrev_b32 v244, 16, v234
v_mfma_f32_32x32x16_bf16 v[80:95], v[12:15], v[224:227], v[80:95]
ds_read_b64_tr_b16 v[28:29], v6 offset:36864
ds_read_b64_tr_b16 v[30:31], v6 offset:37376
v_and_b32 v245, s60, v234
v_fma_f32 v244, v244, v240, v241
v_fma_f32 v245, v245, v240, v241
v_cvt_pk_bf16_f32 v234, v244, v245
v_lshlrev_b32 v246, 16, v235
v_and_b32 v247, s60, v235
v_fma_f32 v246, v246, v240, v241
v_fma_f32 v247, v247, v240, v241
v_cvt_pk_bf16_f32 v235, v246, v247
s_waitcnt lgkmcnt(4)
v_mfma_f32_32x32x16_bf16 v[64:79], v[16:19], v[228:231], v[64:79]
ds_read_b64_tr_b16 v[8:9], v1 offset:38912
ds_read_b64_tr_b16 v[10:11], v1 offset:39424
v_lshlrev_b32 v244, 16, v236
v_and_b32 v245, s60, v236
v_fma_f32 v244, v244, v240, v241
v_fma_f32 v245, v245, v240, v241
v_cvt_pk_bf16_f32 v236, v244, v245
v_lshlrev_b32 v246, 16, v237
v_and_b32 v247, s60, v237
v_fma_f32 v246, v246, v240, v241
v_fma_f32 v247, v247, v240, v241
v_cvt_pk_bf16_f32 v237, v246, v247
v_lshlrev_b32 v244, 16, v238
v_mfma_f32_32x32x16_bf16 v[80:95], v[20:23], v[228:231], v[80:95]
ds_read_b64_tr_b16 v[12:13], v6 offset:38912
ds_read_b64_tr_b16 v[14:15], v6 offset:39424
v_and_b32 v245, s60, v238
v_fma_f32 v244, v244, v240, v241
v_fma_f32 v245, v245, v240, v241
v_cvt_pk_bf16_f32 v238, v244, v245
v_lshlrev_b32 v246, 16, v239
v_and_b32 v247, s60, v239
v_fma_f32 v246, v246, v240, v241
v_fma_f32 v247, v247, v240, v241
v_cvt_pk_bf16_f32 v239, v246, v247
s_waitcnt lgkmcnt(4)
v_mfma_f32_32x32x16_bf16 v[64:79], v[24:27], v[232:235], v[64:79]
ds_read_b64_tr_b16 v[16:17], v1 offset:40960
ds_read_b64_tr_b16 v[18:19], v1 offset:41472
v_mfma_f32_32x32x16_bf16 v[80:95], v[28:31], v[232:235], v[80:95]
ds_read_b64_tr_b16 v[20:21], v2 offset:40960
ds_read_b64_tr_b16 v[22:23], v2 offset:41472
s_waitcnt lgkmcnt(4)
v_mfma_f32_32x32x16_bf16 v[64:79], v[8:11], v[236:239], v[64:79]
ds_read_b64_tr_b16 v[24:25], v1 offset:43008
ds_read_b64_tr_b16 v[26:27], v1 offset:43520
v_mfma_f32_32x32x16_bf16 v[80:95], v[12:15], v[236:239], v[80:95]
ds_read_b64_tr_b16 v[28:29], v2 offset:43008
ds_read_b64_tr_b16 v[30:31], v2 offset:43520
s_cmp_eq_u32 s50, 1
s_cbranch_scc1 L_CA
s_lshl_b32 s54, s44, 10
s_add_u32 s54, s54, 32768
v_add_u32 v241, s54, v3
s_lshl_b32 s54, s44, 12
s_add_u32 s54, s54, 16384
v_add_u32 v5, s54, v3
s_waitcnt lgkmcnt(4)
v_mfma_f32_32x32x16_bf16 v[32:47], v[128:131], v[16:19], 0
ds_read_b64_tr_b16 v[8:9], v1 offset:45056
ds_read_b64_tr_b16 v[10:11], v1 offset:45568
v_mfma_f32_32x32x16_bf16 v[48:63], v[128:131], v[20:23], 0
ds_read_b64_tr_b16 v[12:13], v2 offset:45056
ds_read_b64_tr_b16 v[14:15], v2 offset:45568
s_waitcnt lgkmcnt(4)
v_mfma_f32_32x32x16_bf16 v[32:47], v[132:135], v[24:27], v[32:47]
ds_read_b64_tr_b16 v[16:17], v1 offset:47104
ds_read_b64_tr_b16 v[18:19], v1 offset:47616
v_mul_f32 v244, v64, v64
v_mul_f32 v245, v65, v65
v_fmaak_f32 v244, v244, v242, 0xc0135761
v_fmaak_f32 v245, v245, v242, 0xc0135761
v_mfma_f32_32x32x16_bf16 v[48:63], v[132:135], v[28:31], v[48:63]
ds_read_b64_tr_b16 v[20:21], v2 offset:47104
ds_read_b64_tr_b16 v[22:23], v2 offset:47616
v_mul_f32 v244, v64, v244
v_mul_f32 v245, v65, v245
v_exp_f32 v244, v244
s_waitcnt lgkmcnt(4)
v_mfma_f32_32x32x16_bf16 v[32:47], v[136:139], v[8:11], v[32:47]
ds_read_b64_tr_b16 v[24:25], v1 offset:49152
ds_read_b64_tr_b16 v[26:27], v1 offset:49664
v_exp_f32 v245, v245
v_add_f32 v244, 1.0, v244
v_add_f32 v245, 1.0, v245
v_mfma_f32_32x32x16_bf16 v[48:63], v[136:139], v[12:15], v[48:63]
ds_read_b64_tr_b16 v[28:29], v2 offset:49152
ds_read_b64_tr_b16 v[30:31], v2 offset:49664
v_rcp_f32 v244, v244
s_waitcnt lgkmcnt(4)
v_mfma_f32_32x32x16_bf16 v[32:47], v[140:143], v[16:19], v[32:47]
ds_read_b64_tr_b16 v[8:9], v1 offset:51200
ds_read_b64_tr_b16 v[10:11], v1 offset:51712
v_rcp_f32 v245, v245
v_mul_f32 v64, v64, v244
v_mul_f32 v65, v65, v245
v_mul_f32 v246, v66, v66
v_mfma_f32_32x32x16_bf16 v[48:63], v[140:143], v[20:23], v[48:63]
ds_read_b64_tr_b16 v[12:13], v2 offset:51200
ds_read_b64_tr_b16 v[14:15], v2 offset:51712
v_mul_f32 v247, v67, v67
v_fmaak_f32 v246, v246, v242, 0xc0135761
v_fmaak_f32 v247, v247, v242, 0xc0135761
s_waitcnt lgkmcnt(4)
v_mfma_f32_32x32x16_bf16 v[32:47], v[144:147], v[24:27], v[32:47]
ds_read_b64_tr_b16 v[16:17], v1 offset:53248
ds_read_b64_tr_b16 v[18:19], v1 offset:53760
v_mul_f32 v246, v66, v246
v_mul_f32 v247, v67, v247
v_exp_f32 v246, v246
v_mfma_f32_32x32x16_bf16 v[48:63], v[144:147], v[28:31], v[48:63]
ds_read_b64_tr_b16 v[20:21], v2 offset:53248
ds_read_b64_tr_b16 v[22:23], v2 offset:53760
v_exp_f32 v247, v247
v_add_f32 v246, 1.0, v246
s_waitcnt lgkmcnt(4)
v_mfma_f32_32x32x16_bf16 v[32:47], v[148:151], v[8:11], v[32:47]
ds_read_b64_tr_b16 v[24:25], v1 offset:55296
ds_read_b64_tr_b16 v[26:27], v1 offset:55808
v_add_f32 v247, 1.0, v247
v_rcp_f32 v246, v246
v_rcp_f32 v247, v247
v_mfma_f32_32x32x16_bf16 v[48:63], v[148:151], v[12:15], v[48:63]
ds_read_b64_tr_b16 v[28:29], v2 offset:55296
ds_read_b64_tr_b16 v[30:31], v2 offset:55808
v_mul_f32 v66, v66, v246
v_mul_f32 v67, v67, v247
v_mul_f32 v244, v68, v68
s_waitcnt lgkmcnt(4)
v_mfma_f32_32x32x16_bf16 v[32:47], v[152:155], v[16:19], v[32:47]
ds_read_b64_tr_b16 v[8:9], v1 offset:57344
ds_read_b64_tr_b16 v[10:11], v1 offset:57856
v_mul_f32 v245, v69, v69
v_fmaak_f32 v244, v244, v242, 0xc0135761
v_fmaak_f32 v245, v245, v242, 0xc0135761
v_mul_f32 v244, v68, v244
v_mfma_f32_32x32x16_bf16 v[48:63], v[152:155], v[20:23], v[48:63]
ds_read_b64_tr_b16 v[12:13], v2 offset:57344
ds_read_b64_tr_b16 v[14:15], v2 offset:57856
v_mul_f32 v245, v69, v245
v_exp_f32 v244, v244
s_waitcnt lgkmcnt(4)
v_mfma_f32_32x32x16_bf16 v[32:47], v[156:159], v[24:27], v[32:47]
ds_read_b64_tr_b16 v[16:17], v1 offset:59392
ds_read_b64_tr_b16 v[18:19], v1 offset:59904
v_exp_f32 v245, v245
v_add_f32 v244, 1.0, v244
v_add_f32 v245, 1.0, v245
v_mfma_f32_32x32x16_bf16 v[48:63], v[156:159], v[28:31], v[48:63]
ds_read_b64_tr_b16 v[20:21], v2 offset:59392
ds_read_b64_tr_b16 v[22:23], v2 offset:59904
v_rcp_f32 v244, v244
v_rcp_f32 v245, v245
s_waitcnt lgkmcnt(4)
v_mfma_f32_32x32x16_bf16 v[32:47], v[160:163], v[8:11], v[32:47]
ds_read_b64_tr_b16 v[24:25], v1 offset:61440
ds_read_b64_tr_b16 v[26:27], v1 offset:61952
v_mul_f32 v68, v68, v244
v_mul_f32 v69, v69, v245
v_mul_f32 v246, v70, v70
v_mul_f32 v247, v71, v71
v_mfma_f32_32x32x16_bf16 v[48:63], v[160:163], v[12:15], v[48:63]
ds_read_b64_tr_b16 v[28:29], v2 offset:61440
ds_read_b64_tr_b16 v[30:31], v2 offset:61952
v_fmaak_f32 v246, v246, v242, 0xc0135761
v_fmaak_f32 v247, v247, v242, 0xc0135761
v_mul_f32 v246, v70, v246
s_waitcnt lgkmcnt(4)
v_mfma_f32_32x32x16_bf16 v[32:47], v[164:167], v[16:19], v[32:47]
ds_read_b64_tr_b16 v[8:9], v1 offset:63488
ds_read_b64_tr_b16 v[10:11], v1 offset:64000
v_mul_f32 v247, v71, v247
v_exp_f32 v246, v246
v_mfma_f32_32x32x16_bf16 v[48:63], v[164:167], v[20:23], v[48:63]
ds_read_b64_tr_b16 v[12:13], v2 offset:63488
ds_read_b64_tr_b16 v[14:15], v2 offset:64000
v_exp_f32 v247, v247
v_add_f32 v246, 1.0, v246
v_add_f32 v247, 1.0, v247
s_barrier
s_waitcnt lgkmcnt(4)
v_mfma_f32_32x32x16_bf16 v[32:47], v[168:171], v[24:27], v[32:47]
v_add_u32 v1, 0x00010000, v1
v_add_u32 v6, 0x00010000, v6
v_add_u32 v2, 0x00010000, v2
ds_read_b64_tr_b16 v[16:17], v1 offset:0
ds_read_b64_tr_b16 v[18:19], v1 offset:512
v_rcp_f32 v246, v246
v_rcp_f32 v247, v247
v_mfma_f32_32x32x16_bf16 v[48:63], v[168:171], v[28:31], v[48:63]
ds_read_b64_tr_b16 v[20:21], v2 offset:0
ds_read_b64_tr_b16 v[22:23], v2 offset:512
v_mul_f32 v70, v70, v246
v_mul_f32 v71, v71, v247
v_mul_f32 v244, v72, v72
s_waitcnt lgkmcnt(4)
v_mfma_f32_32x32x16_bf16 v[32:47], v[172:175], v[8:11], v[32:47]
ds_read_b64_tr_b16 v[24:25], v1 offset:2048
ds_read_b64_tr_b16 v[26:27], v1 offset:2560
v_mul_f32 v245, v73, v73
v_fmaak_f32 v244, v244, v242, 0xc0135761
v_fmaak_f32 v245, v245, v242, 0xc0135761
v_mul_f32 v244, v72, v244
v_mul_f32 v245, v73, v245
v_mfma_f32_32x32x16_bf16 v[48:63], v[172:175], v[12:15], v[48:63]
ds_read_b64_tr_b16 v[28:29], v2 offset:2048
ds_read_b64_tr_b16 v[30:31], v2 offset:2560
v_exp_f32 v244, v244
s_waitcnt lgkmcnt(4)
v_mfma_f32_32x32x16_bf16 v[32:47], v[176:179], v[16:19], v[32:47]
ds_read_b64_tr_b16 v[8:9], v1 offset:4096
ds_read_b64_tr_b16 v[10:11], v1 offset:4608
v_exp_f32 v245, v245
v_add_f32 v244, 1.0, v244
v_add_f32 v245, 1.0, v245
v_mfma_f32_32x32x16_bf16 v[48:63], v[176:179], v[20:23], v[48:63]
ds_read_b64_tr_b16 v[12:13], v2 offset:4096
ds_read_b64_tr_b16 v[14:15], v2 offset:4608
v_rcp_f32 v244, v244
v_rcp_f32 v245, v245
s_waitcnt lgkmcnt(4)
v_mfma_f32_32x32x16_bf16 v[32:47], v[180:183], v[24:27], v[32:47]
ds_read_b64_tr_b16 v[16:17], v1 offset:6144
ds_read_b64_tr_b16 v[18:19], v1 offset:6656
v_mul_f32 v72, v72, v244
v_mul_f32 v73, v73, v245
v_mul_f32 v246, v74, v74
v_mul_f32 v247, v75, v75
v_mfma_f32_32x32x16_bf16 v[48:63], v[180:183], v[28:31], v[48:63]
ds_read_b64_tr_b16 v[20:21], v2 offset:6144
ds_read_b64_tr_b16 v[22:23], v2 offset:6656
v_fmaak_f32 v246, v246, v242, 0xc0135761
v_fmaak_f32 v247, v247, v242, 0xc0135761
v_mul_f32 v246, v74, v246
s_waitcnt lgkmcnt(4)
v_mfma_f32_32x32x16_bf16 v[32:47], v[184:187], v[8:11], v[32:47]
ds_read_b64_tr_b16 v[24:25], v1 offset:8192
ds_read_b64_tr_b16 v[26:27], v1 offset:8704
v_mul_f32 v247, v75, v247
v_exp_f32 v246, v246
v_exp_f32 v247, v247
v_mfma_f32_32x32x16_bf16 v[48:63], v[184:187], v[12:15], v[48:63]
ds_read_b64_tr_b16 v[28:29], v2 offset:8192
ds_read_b64_tr_b16 v[30:31], v2 offset:8704
v_add_f32 v246, 1.0, v246
v_add_f32 v247, 1.0, v247
s_waitcnt lgkmcnt(4)
v_mfma_f32_32x32x16_bf16 v[32:47], v[188:191], v[16:19], v[32:47]
ds_read_b64_tr_b16 v[8:9], v1 offset:10240
ds_read_b64_tr_b16 v[10:11], v1 offset:10752
v_rcp_f32 v246, v246
v_rcp_f32 v247, v247
v_mul_f32 v74, v74, v246
v_mfma_f32_32x32x16_bf16 v[48:63], v[188:191], v[20:23], v[48:63]
ds_read_b64_tr_b16 v[12:13], v2 offset:10240
ds_read_b64_tr_b16 v[14:15], v2 offset:10752
v_mul_f32 v75, v75, v247
v_mul_f32 v244, v76, v76
v_mul_f32 v245, v77, v77
s_waitcnt lgkmcnt(4)
v_mfma_f32_32x32x16_bf16 v[32:47], v[192:195], v[24:27], v[32:47]
ds_read_b64_tr_b16 v[16:17], v1 offset:12288
ds_read_b64_tr_b16 v[18:19], v1 offset:12800
v_fmaak_f32 v244, v244, v242, 0xc0135761
v_fmaak_f32 v245, v245, v242, 0xc0135761
v_mul_f32 v244, v76, v244
v_mul_f32 v245, v77, v245
v_mfma_f32_32x32x16_bf16 v[48:63], v[192:195], v[28:31], v[48:63]
ds_read_b64_tr_b16 v[20:21], v2 offset:12288
ds_read_b64_tr_b16 v[22:23], v2 offset:12800
v_exp_f32 v244, v244
v_exp_f32 v245, v245
s_waitcnt lgkmcnt(4)
v_mfma_f32_32x32x16_bf16 v[32:47], v[196:199], v[8:11], v[32:47]
ds_read_b64_tr_b16 v[24:25], v1 offset:14336
ds_read_b64_tr_b16 v[26:27], v1 offset:14848
v_add_f32 v244, 1.0, v244
v_add_f32 v245, 1.0, v245
v_rcp_f32 v244, v244
v_mfma_f32_32x32x16_bf16 v[48:63], v[196:199], v[12:15], v[48:63]
ds_read_b64_tr_b16 v[28:29], v2 offset:14336
ds_read_b64_tr_b16 v[30:31], v2 offset:14848
v_rcp_f32 v245, v245
v_mul_f32 v76, v76, v244
s_waitcnt lgkmcnt(4)
v_mfma_f32_32x32x16_bf16 v[32:47], v[200:203], v[16:19], v[32:47]
ds_read_b64_tr_b16 v[8:9], v1 offset:16384
ds_read_b64_tr_b16 v[10:11], v1 offset:16896
v_mul_f32 v77, v77, v245
v_mul_f32 v246, v78, v78
v_mul_f32 v247, v79, v79
v_fmaak_f32 v246, v246, v242, 0xc0135761
v_mfma_f32_32x32x16_bf16 v[48:63], v[200:203], v[20:23], v[48:63]
ds_read_b64_tr_b16 v[12:13], v2 offset:16384
ds_read_b64_tr_b16 v[14:15], v2 offset:16896
v_fmaak_f32 v247, v247, v242, 0xc0135761
v_mul_f32 v246, v78, v246
v_mul_f32 v247, v79, v247
s_waitcnt lgkmcnt(4)
v_mfma_f32_32x32x16_bf16 v[32:47], v[204:207], v[24:27], v[32:47]
ds_read_b64_tr_b16 v[16:17], v1 offset:18432
ds_read_b64_tr_b16 v[18:19], v1 offset:18944
v_exp_f32 v246, v246
v_exp_f32 v247, v247
v_mfma_f32_32x32x16_bf16 v[48:63], v[204:207], v[28:31], v[48:63]
ds_read_b64_tr_b16 v[20:21], v2 offset:18432
ds_read_b64_tr_b16 v[22:23], v2 offset:18944
v_add_f32 v246, 1.0, v246
v_add_f32 v247, 1.0, v247
v_rcp_f32 v246, v246
s_waitcnt lgkmcnt(4)
v_mfma_f32_32x32x16_bf16 v[32:47], v[208:211], v[8:11], v[32:47]
ds_read_b64_tr_b16 v[24:25], v1 offset:20480
ds_read_b64_tr_b16 v[26:27], v1 offset:20992
v_rcp_f32 v247, v247
v_mul_f32 v78, v78, v246
v_mul_f32 v79, v79, v247
v_mfma_f32_32x32x16_bf16 v[48:63], v[208:211], v[12:15], v[48:63]
ds_read_b64_tr_b16 v[28:29], v2 offset:20480
ds_read_b64_tr_b16 v[30:31], v2 offset:20992
v_mul_f32 v244, v80, v80
v_mul_f32 v245, v81, v81
v_fmaak_f32 v244, v244, v242, 0xc0135761
s_waitcnt lgkmcnt(4)
v_mfma_f32_32x32x16_bf16 v[32:47], v[212:215], v[16:19], v[32:47]
ds_read_b64_tr_b16 v[8:9], v1 offset:22528
ds_read_b64_tr_b16 v[10:11], v1 offset:23040
v_fmaak_f32 v245, v245, v242, 0xc0135761
v_mul_f32 v244, v80, v244
v_mul_f32 v245, v81, v245
v_mfma_f32_32x32x16_bf16 v[48:63], v[212:215], v[20:23], v[48:63]
ds_read_b64_tr_b16 v[12:13], v2 offset:22528
ds_read_b64_tr_b16 v[14:15], v2 offset:23040
v_exp_f32 v244, v244
v_exp_f32 v245, v245
s_barrier
s_waitcnt lgkmcnt(4)
v_mfma_f32_32x32x16_bf16 v[32:47], v[216:219], v[24:27], v[32:47]
ds_read_b64_tr_b16 v[16:17], v1 offset:24576
ds_read_b64_tr_b16 v[18:19], v1 offset:25088
v_add_f32 v244, 1.0, v244
v_add_f32 v245, 1.0, v245
v_rcp_f32 v244, v244
v_mfma_f32_32x32x16_bf16 v[48:63], v[216:219], v[28:31], v[48:63]
ds_read_b64_tr_b16 v[20:21], v2 offset:24576
ds_read_b64_tr_b16 v[22:23], v2 offset:25088
v_rcp_f32 v245, v245
v_mul_f32 v80, v80, v244
s_waitcnt lgkmcnt(4)
v_mfma_f32_32x32x16_bf16 v[32:47], v[220:223], v[8:11], v[32:47]
ds_read_b64_tr_b16 v[24:25], v1 offset:26624
ds_read_b64_tr_b16 v[26:27], v1 offset:27136
v_mul_f32 v81, v81, v245
v_mul_f32 v246, v82, v82
v_mul_f32 v247, v83, v83
v_fmaak_f32 v246, v246, v242, 0xc0135761
v_fmaak_f32 v247, v247, v242, 0xc0135761
v_mfma_f32_32x32x16_bf16 v[48:63], v[220:223], v[12:15], v[48:63]
ds_read_b64_tr_b16 v[28:29], v2 offset:26624
ds_read_b64_tr_b16 v[30:31], v2 offset:27136
v_mul_f32 v246, v82, v246
v_mul_f32 v247, v83, v247
s_waitcnt lgkmcnt(4)
v_mfma_f32_32x32x16_bf16 v[32:47], v[224:227], v[16:19], v[32:47]
ds_read_b64_tr_b16 v[8:9], v1 offset:28672
ds_read_b64_tr_b16 v[10:11], v1 offset:29184
v_exp_f32 v246, v246
v_exp_f32 v247, v247
v_add_f32 v246, 1.0, v246
v_mfma_f32_32x32x16_bf16 v[48:63], v[224:227], v[20:23], v[48:63]
ds_read_b64_tr_b16 v[12:13], v2 offset:28672
ds_read_b64_tr_b16 v[14:15], v2 offset:29184
v_add_f32 v247, 1.0, v247
v_rcp_f32 v246, v246
s_waitcnt lgkmcnt(4)
v_mfma_f32_32x32x16_bf16 v[32:47], v[228:231], v[24:27], v[32:47]
ds_read_b64_tr_b16 v[16:17], v1 offset:30720
ds_read_b64_tr_b16 v[18:19], v1 offset:31232
v_rcp_f32 v247, v247
v_mul_f32 v82, v82, v246
v_mul_f32 v83, v83, v247
v_mfma_f32_32x32x16_bf16 v[48:63], v[228:231], v[28:31], v[48:63]
ds_read_b64_tr_b16 v[20:21], v2 offset:30720
ds_read_b64_tr_b16 v[22:23], v2 offset:31232
v_mul_f32 v244, v84, v84
v_mul_f32 v245, v85, v85
v_fmaak_f32 v244, v244, v242, 0xc0135761
s_waitcnt lgkmcnt(4)
v_mfma_f32_32x32x16_bf16 v[32:47], v[232:235], v[8:11], v[32:47]
v_add_u32 v1, 0xfffe0000, v1
v_add_u32 v6, 0xfffe0000, v6
ds_read_b64_tr_b16 v[24:25], v1 offset:49152
ds_read_b64_tr_b16 v[26:27], v1 offset:49664
v_fmaak_f32 v245, v245, v242, 0xc0135761
v_mul_f32 v244, v84, v244
v_mul_f32 v245, v85, v245
v_exp_f32 v244, v244
v_mfma_f32_32x32x16_bf16 v[48:63], v[232:235], v[12:15], v[48:63]
ds_read_b64_tr_b16 v[28:29], v6 offset:49152
ds_read_b64_tr_b16 v[30:31], v6 offset:49664
v_exp_f32 v245, v245
v_add_f32 v244, 1.0, v244
s_waitcnt lgkmcnt(4)
v_mfma_f32_32x32x16_bf16 v[32:47], v[236:239], v[16:19], v[32:47]
ds_read_b64_tr_b16 v[8:9], v1 offset:51200
ds_read_b64_tr_b16 v[10:11], v1 offset:51712
v_add_f32 v245, 1.0, v245
v_rcp_f32 v244, v244
v_mfma_f32_32x32x16_bf16 v[48:63], v[236:239], v[20:23], v[48:63]
ds_read_b64_tr_b16 v[12:13], v6 offset:51200
ds_read_b64_tr_b16 v[14:15], v6 offset:51712
v_rcp_f32 v245, v245
v_mul_f32 v84, v84, v244
v_mul_f32 v85, v85, v245
s_waitcnt lgkmcnt(4)
v_mfma_f32_32x32x16_bf16 v[96:111], v[24:27], v[128:131], 0
ds_read_b64_tr_b16 v[16:17], v1 offset:53248
ds_read_b64_tr_b16 v[18:19], v1 offset:53760
v_mfma_f32_32x32x16_bf16 v[112:127], v[28:31], v[128:131], 0
ds_read_b64_tr_b16 v[20:21], v6 offset:53248
ds_read_b64_tr_b16 v[22:23], v6 offset:53760
s_waitcnt lgkmcnt(4)
v_mfma_f32_32x32x16_bf16 v[96:111], v[8:11], v[132:135], v[96:111]
ds_read_b64_tr_b16 v[24:25], v1 offset:55296
ds_read_b64_tr_b16 v[26:27], v1 offset:55808
v_cvt_pk_bf16_f32 v48, v48, v49
v_cvt_pk_bf16_f32 v49, v50, v51
v_cndmask_b32 v48, v48, v243, s[62:63]
v_cvt_pk_bf16_f32 v50, v52, v53
v_cndmask_b32 v49, v49, v243, s[62:63]
v_mfma_f32_32x32x16_bf16 v[112:127], v[12:15], v[132:135], v[112:127]
ds_read_b64_tr_b16 v[28:29], v6 offset:55296
ds_read_b64_tr_b16 v[30:31], v6 offset:55808
v_cvt_pk_bf16_f32 v51, v54, v55
v_cndmask_b32 v50, v50, v243, s[62:63]
v_cvt_pk_bf16_f32 v52, v56, v57
v_cndmask_b32 v51, v51, v243, s[62:63]
s_waitcnt lgkmcnt(4)
v_mfma_f32_32x32x16_bf16 v[96:111], v[16:19], v[136:139], v[96:111]
ds_read_b64_tr_b16 v[8:9], v1 offset:57344
ds_read_b64_tr_b16 v[10:11], v1 offset:57856
v_cvt_pk_bf16_f32 v53, v58, v59
v_cndmask_b32 v52, v52, v243, s[62:63]
v_cvt_pk_bf16_f32 v54, v60, v61
v_cndmask_b32 v53, v53, v243, s[62:63]
v_cvt_pk_bf16_f32 v55, v62, v63
v_mfma_f32_32x32x16_bf16 v[112:127], v[20:23], v[136:139], v[112:127]
ds_read_b64_tr_b16 v[12:13], v6 offset:57344
ds_read_b64_tr_b16 v[14:15], v6 offset:57856
v_cndmask_b32 v54, v54, v243, s[62:63]
v_cndmask_b32 v55, v55, v243, s[62:63]
v_mul_f32 v244, s68, v32
s_waitcnt lgkmcnt(4)
v_mfma_f32_32x32x16_bf16 v[96:111], v[24:27], v[140:143], v[96:111]
ds_read_b64_tr_b16 v[16:17], v1 offset:59392
ds_read_b64_tr_b16 v[18:19], v1 offset:59904
v_mul_f32 v245, s68, v33
v_exp_f32_e64 v244, v244 clamp
v_exp_f32_e64 v245, v245 clamp
v_mfma_f32_32x32x16_bf16 v[112:127], v[28:31], v[140:143], v[112:127]
ds_read_b64_tr_b16 v[20:21], v6 offset:59392
ds_read_b64_tr_b16 v[22:23], v6 offset:59904
v_max_f32 v32, 0x358637bd, v32
v_max_f32 v33, 0x358637bd, v33
v_add_f32 v32, v32, v244
v_add_f32 v33, v33, v245
s_waitcnt lgkmcnt(4)
v_mfma_f32_32x32x16_bf16 v[96:111], v[8:11], v[144:147], v[96:111]
ds_read_b64_tr_b16 v[24:25], v1 offset:61440
ds_read_b64_tr_b16 v[26:27], v1 offset:61952
v_mul_f32 v246, s68, v34
v_mul_f32 v247, s68, v35
v_exp_f32_e64 v246, v246 clamp
v_mfma_f32_32x32x16_bf16 v[112:127], v[12:15], v[144:147], v[112:127]
ds_read_b64_tr_b16 v[28:29], v6 offset:61440
ds_read_b64_tr_b16 v[30:31], v6 offset:61952
v_exp_f32_e64 v247, v247 clamp
v_max_f32 v34, 0x358637bd, v34
v_max_f32 v35, 0x358637bd, v35
v_add_f32 v34, v34, v246
s_waitcnt lgkmcnt(4)
v_mfma_f32_32x32x16_bf16 v[96:111], v[16:19], v[148:151], v[96:111]
ds_read_b64_tr_b16 v[8:9], v1 offset:63488
ds_read_b64_tr_b16 v[10:11], v1 offset:64000
v_add_f32 v35, v35, v247
v_mul_f32 v244, s68, v36
v_mul_f32 v245, s68, v37
v_exp_f32_e64 v244, v244 clamp
v_mfma_f32_32x32x16_bf16 v[112:127], v[20:23], v[148:151], v[112:127]
ds_read_b64_tr_b16 v[12:13], v6 offset:63488
ds_read_b64_tr_b16 v[14:15], v6 offset:64000
v_exp_f32_e64 v245, v245 clamp
v_max_f32 v36, 0x358637bd, v36
v_max_f32 v37, 0x358637bd, v37
s_waitcnt lgkmcnt(4)
v_mfma_f32_32x32x16_bf16 v[96:111], v[24:27], v[152:155], v[96:111]
v_add_u32 v1, 0x00010000, v1
v_add_u32 v6, 0x00010000, v6
ds_read_b64_tr_b16 v[16:17], v1 offset:0
ds_read_b64_tr_b16 v[18:19], v1 offset:512
v_add_f32 v36, v36, v244
v_add_f32 v37, v37, v245
v_mul_f32 v246, s68, v38
v_mul_f32 v247, s68, v39
v_mfma_f32_32x32x16_bf16 v[112:127], v[28:31], v[152:155], v[112:127]
ds_read_b64_tr_b16 v[20:21], v6 offset:0
ds_read_b64_tr_b16 v[22:23], v6 offset:512
v_exp_f32_e64 v246, v246 clamp
v_exp_f32_e64 v247, v247 clamp
s_waitcnt lgkmcnt(4)
v_mfma_f32_32x32x16_bf16 v[96:111], v[8:11], v[156:159], v[96:111]
ds_read_b64_tr_b16 v[24:25], v1 offset:2048
ds_read_b64_tr_b16 v[26:27], v1 offset:2560
v_max_f32 v38, 0x358637bd, v38
v_max_f32 v39, 0x358637bd, v39
v_add_f32 v38, v38, v246
v_add_f32 v39, v39, v247
v_cvt_pk_bf16_f32 v56, v32, v33
v_mfma_f32_32x32x16_bf16 v[112:127], v[12:15], v[156:159], v[112:127]
ds_read_b64_tr_b16 v[28:29], v6 offset:2048
ds_read_b64_tr_b16 v[30:31], v6 offset:2560
v_cvt_pk_bf16_f32 v57, v34, v35
v_cvt_pk_bf16_f32 v58, v36, v37
v_cvt_pk_bf16_f32 v59, v38, v39
v_mul_f32 v244, s68, v40
s_waitcnt lgkmcnt(4)
v_mfma_f32_32x32x16_bf16 v[96:111], v[16:19], v[160:163], v[96:111]
ds_read_b64_tr_b16 v[8:9], v1 offset:4096
ds_read_b64_tr_b16 v[10:11], v1 offset:4608
v_mul_f32 v245, s68, v41
v_exp_f32_e64 v244, v244 clamp
v_exp_f32_e64 v245, v245 clamp
v_mfma_f32_32x32x16_bf16 v[112:127], v[20:23], v[160:163], v[112:127]
ds_read_b64_tr_b16 v[12:13], v6 offset:4096
ds_read_b64_tr_b16 v[14:15], v6 offset:4608
v_max_f32 v40, 0x358637bd, v40
v_max_f32 v41, 0x358637bd, v41
v_add_f32 v40, v40, v244
v_add_f32 v41, v41, v245
s_waitcnt lgkmcnt(4)
v_mfma_f32_32x32x16_bf16 v[96:111], v[24:27], v[164:167], v[96:111]
ds_read_b64_tr_b16 v[16:17], v1 offset:6144
ds_read_b64_tr_b16 v[18:19], v1 offset:6656
v_mul_f32 v246, s68, v42
v_mul_f32 v247, s68, v43
v_exp_f32_e64 v246, v246 clamp
v_mfma_f32_32x32x16_bf16 v[112:127], v[28:31], v[164:167], v[112:127]
ds_read_b64_tr_b16 v[20:21], v6 offset:6144
ds_read_b64_tr_b16 v[22:23], v6 offset:6656
v_exp_f32_e64 v247, v247 clamp
v_max_f32 v42, 0x358637bd, v42
v_max_f32 v43, 0x358637bd, v43
s_barrier
s_waitcnt lgkmcnt(4)
v_mfma_f32_32x32x16_bf16 v[96:111], v[8:11], v[168:171], v[96:111]
ds_read_b64_tr_b16 v[24:25], v1 offset:8192
ds_read_b64_tr_b16 v[26:27], v1 offset:8704
v_add_f32 v42, v42, v246
v_add_f32 v43, v43, v247
v_mul_f32 v244, s68, v44
v_mul_f32 v245, s68, v45
v_exp_f32_e64 v244, v244 clamp
v_mfma_f32_32x32x16_bf16 v[112:127], v[12:15], v[168:171], v[112:127]
ds_read_b64_tr_b16 v[28:29], v6 offset:8192
ds_read_b64_tr_b16 v[30:31], v6 offset:8704
v_exp_f32_e64 v245, v245 clamp
v_max_f32 v44, 0x358637bd, v44
s_waitcnt lgkmcnt(4)
v_mfma_f32_32x32x16_bf16 v[96:111], v[16:19], v[172:175], v[96:111]
ds_read_b64_tr_b16 v[8:9], v1 offset:10240
ds_read_b64_tr_b16 v[10:11], v1 offset:10752
v_max_f32 v45, 0x358637bd, v45
v_add_f32 v44, v44, v244
v_add_f32 v45, v45, v245
v_mul_f32 v246, s68, v46
v_mul_f32 v247, s68, v47
v_mfma_f32_32x32x16_bf16 v[112:127], v[20:23], v[172:175], v[112:127]
ds_read_b64_tr_b16 v[12:13], v6 offset:10240
ds_read_b64_tr_b16 v[14:15], v6 offset:10752
v_exp_f32_e64 v246, v246 clamp
v_exp_f32_e64 v247, v247 clamp
s_waitcnt lgkmcnt(4)
v_mfma_f32_32x32x16_bf16 v[96:111], v[24:27], v[176:179], v[96:111]
ds_read_b64_tr_b16 v[16:17], v1 offset:12288
ds_read_b64_tr_b16 v[18:19], v1 offset:12800
v_max_f32 v46, 0x358637bd, v46
v_max_f32 v47, 0x358637bd, v47
v_add_f32 v46, v46, v246
v_add_f32 v47, v47, v247
v_cvt_pk_bf16_f32 v60, v40, v41
v_mfma_f32_32x32x16_bf16 v[112:127], v[28:31], v[176:179], v[112:127]
ds_read_b64_tr_b16 v[20:21], v6 offset:12288
ds_read_b64_tr_b16 v[22:23], v6 offset:12800
v_cvt_pk_bf16_f32 v61, v42, v43
v_cvt_pk_bf16_f32 v62, v44, v45
v_cvt_pk_bf16_f32 v63, v46, v47
s_waitcnt lgkmcnt(4)
v_mfma_f32_32x32x16_bf16 v[96:111], v[8:11], v[180:183], v[96:111]
ds_read_b64_tr_b16 v[24:25], v1 offset:14336
ds_read_b64_tr_b16 v[26:27], v1 offset:14848
s_nop 1
v_mfma_f32_32x32x16_bf16 v[32:47], v[56:59], v[48:51], 0
v_mfma_f32_32x32x16_bf16 v[112:127], v[12:15], v[180:183], v[112:127]
ds_read_b64_tr_b16 v[28:29], v6 offset:14336
ds_read_b64_tr_b16 v[30:31], v6 offset:14848
s_waitcnt lgkmcnt(4)
v_mfma_f32_32x32x16_bf16 v[96:111], v[16:19], v[184:187], v[96:111]
ds_read_b64_tr_b16 v[8:9], v1 offset:16384
ds_read_b64_tr_b16 v[10:11], v1 offset:16896
v_mfma_f32_32x32x16_bf16 v[32:47], v[60:63], v[52:55], v[32:47]
v_mfma_f32_32x32x16_bf16 v[112:127], v[20:23], v[184:187], v[112:127]
ds_read_b64_tr_b16 v[12:13], v6 offset:16384
ds_read_b64_tr_b16 v[14:15], v6 offset:16896
s_waitcnt lgkmcnt(4)
v_mfma_f32_32x32x16_bf16 v[96:111], v[24:27], v[188:191], v[96:111]
ds_read_b64_tr_b16 v[16:17], v1 offset:18432
ds_read_b64_tr_b16 v[18:19], v1 offset:18944
v_mfma_f32_32x32x16_bf16 v[112:127], v[28:31], v[188:191], v[112:127]
ds_read_b64_tr_b16 v[20:21], v6 offset:18432
ds_read_b64_tr_b16 v[22:23], v6 offset:18944
s_waitcnt lgkmcnt(4)
v_mfma_f32_32x32x16_bf16 v[96:111], v[8:11], v[192:195], v[96:111]
ds_read_b64_tr_b16 v[24:25], v1 offset:20480
ds_read_b64_tr_b16 v[26:27], v1 offset:20992
ds_write_b128 v241, v[32:35] offset:0
ds_write_b128 v241, v[36:39] offset:4096
v_mfma_f32_32x32x16_bf16 v[112:127], v[12:15], v[192:195], v[112:127]
ds_read_b64_tr_b16 v[28:29], v6 offset:20480
ds_read_b64_tr_b16 v[30:31], v6 offset:20992
ds_write_b128 v241, v[40:43] offset:8192
s_waitcnt lgkmcnt(7)
v_mfma_f32_32x32x16_bf16 v[96:111], v[16:19], v[196:199], v[96:111]
ds_read_b64_tr_b16 v[8:9], v1 offset:22528
ds_read_b64_tr_b16 v[10:11], v1 offset:23040
ds_write_b128 v241, v[44:47] offset:12288
v_mfma_f32_32x32x16_bf16 v[112:127], v[20:23], v[196:199], v[112:127]
ds_read_b64_tr_b16 v[12:13], v6 offset:22528
ds_read_b64_tr_b16 v[14:15], v6 offset:23040
v_mul_f32 v246, v86, v86
v_mul_f32 v247, v87, v87
v_fmaak_f32 v246, v246, v242, 0xc0135761
s_waitcnt lgkmcnt(6)
v_mfma_f32_32x32x16_bf16 v[96:111], v[24:27], v[200:203], v[96:111]
ds_read_b64_tr_b16 v[16:17], v1 offset:24576
ds_read_b64_tr_b16 v[18:19], v1 offset:25088
v_fmaak_f32 v247, v247, v242, 0xc0135761
v_mul_f32 v246, v86, v246
v_mul_f32 v247, v87, v247
v_exp_f32 v246, v246
v_mfma_f32_32x32x16_bf16 v[112:127], v[28:31], v[200:203], v[112:127]
ds_read_b64_tr_b16 v[20:21], v6 offset:24576
ds_read_b64_tr_b16 v[22:23], v6 offset:25088
v_exp_f32 v247, v247
v_add_f32 v246, 1.0, v246
v_add_f32 v247, 1.0, v247
s_waitcnt lgkmcnt(4)
v_mfma_f32_32x32x16_bf16 v[96:111], v[8:11], v[204:207], v[96:111]
ds_read_b64_tr_b16 v[24:25], v1 offset:26624
ds_read_b64_tr_b16 v[26:27], v1 offset:27136
v_rcp_f32 v246, v246
v_rcp_f32 v247, v247
v_mul_f32 v86, v86, v246
v_mfma_f32_32x32x16_bf16 v[112:127], v[12:15], v[204:207], v[112:127]
ds_read_b64_tr_b16 v[28:29], v6 offset:26624
ds_read_b64_tr_b16 v[30:31], v6 offset:27136
v_mul_f32 v87, v87, v247
v_mul_f32 v244, v88, v88
v_mul_f32 v245, v89, v89
s_waitcnt lgkmcnt(4)
v_mfma_f32_32x32x16_bf16 v[96:111], v[16:19], v[208:211], v[96:111]
ds_read_b64_tr_b16 v[8:9], v1 offset:28672
ds_read_b64_tr_b16 v[10:11], v1 offset:29184
v_fmaak_f32 v244, v244, v242, 0xc0135761
v_fmaak_f32 v245, v245, v242, 0xc0135761
v_mul_f32 v244, v88, v244
v_mul_f32 v245, v89, v245
v_exp_f32 v244, v244
v_mfma_f32_32x32x16_bf16 v[112:127], v[20:23], v[208:211], v[112:127]
ds_read_b64_tr_b16 v[12:13], v6 offset:28672
ds_read_b64_tr_b16 v[14:15], v6 offset:29184
v_exp_f32 v245, v245
v_add_f32 v244, 1.0, v244
s_waitcnt lgkmcnt(4)
v_mfma_f32_32x32x16_bf16 v[96:111], v[24:27], v[212:215], v[96:111]
ds_read_b64_tr_b16 v[16:17], v1 offset:30720
ds_read_b64_tr_b16 v[18:19], v1 offset:31232
v_add_f32 v245, 1.0, v245
v_rcp_f32 v244, v244
v_rcp_f32 v245, v245
v_mfma_f32_32x32x16_bf16 v[112:127], v[28:31], v[212:215], v[112:127]
ds_read_b64_tr_b16 v[20:21], v6 offset:30720
ds_read_b64_tr_b16 v[22:23], v6 offset:31232
v_mul_f32 v88, v88, v244
v_mul_f32 v89, v89, v245
v_mul_f32 v246, v90, v90
v_mul_f32 v247, v91, v91
s_barrier
s_waitcnt lgkmcnt(4)
v_mfma_f32_32x32x16_bf16 v[96:111], v[8:11], v[216:219], v[96:111]
ds_read_b64_tr_b16 v[24:25], v1 offset:32768
ds_read_b64_tr_b16 v[26:27], v1 offset:33280
v_fmaak_f32 v246, v246, v242, 0xc0135761
v_fmaak_f32 v247, v247, v242, 0xc0135761
v_mul_f32 v246, v90, v246
v_mul_f32 v247, v91, v247
v_mfma_f32_32x32x16_bf16 v[112:127], v[12:15], v[216:219], v[112:127]
ds_read_b64_tr_b16 v[28:29], v6 offset:32768
ds_read_b64_tr_b16 v[30:31], v6 offset:33280
v_exp_f32 v246, v246
v_exp_f32 v247, v247
s_waitcnt lgkmcnt(4)
v_mfma_f32_32x32x16_bf16 v[96:111], v[16:19], v[220:223], v[96:111]
ds_read_b64_tr_b16 v[8:9], v1 offset:34816
ds_read_b64_tr_b16 v[10:11], v1 offset:35328
v_add_f32 v246, 1.0, v246
v_add_f32 v247, 1.0, v247
v_rcp_f32 v246, v246
v_rcp_f32 v247, v247
v_mfma_f32_32x32x16_bf16 v[112:127], v[20:23], v[220:223], v[112:127]
ds_read_b64_tr_b16 v[12:13], v6 offset:34816
ds_read_b64_tr_b16 v[14:15], v6 offset:35328
v_mul_f32 v90, v90, v246
v_mul_f32 v91, v91, v247
v_mul_f32 v244, v92, v92
s_waitcnt lgkmcnt(4)
v_mfma_f32_32x32x16_bf16 v[96:111], v[24:27], v[224:227], v[96:111]
ds_read_b64_tr_b16 v[16:17], v1 offset:36864
ds_read_b64_tr_b16 v[18:19], v1 offset:37376
v_mul_f32 v245, v93, v93
v_fmaak_f32 v244, v244, v242, 0xc0135761
v_fmaak_f32 v245, v245, v242, 0xc0135761
v_mul_f32 v244, v92, v244
v_mul_f32 v245, v93, v245
v_mfma_f32_32x32x16_bf16 v[112:127], v[28:31], v[224:227], v[112:127]
ds_read_b64_tr_b16 v[20:21], v6 offset:36864
ds_read_b64_tr_b16 v[22:23], v6 offset:37376
v_exp_f32 v244, v244
v_exp_f32 v245, v245
s_waitcnt lgkmcnt(4)
v_mfma_f32_32x32x16_bf16 v[96:111], v[8:11], v[228:231], v[96:111]
ds_read_b64_tr_b16 v[24:25], v1 offset:38912
ds_read_b64_tr_b16 v[26:27], v1 offset:39424
v_add_f32 v244, 1.0, v244
v_add_f32 v245, 1.0, v245
v_rcp_f32 v244, v244
v_mfma_f32_32x32x16_bf16 v[112:127], v[12:15], v[228:231], v[112:127]
ds_read_b64_tr_b16 v[28:29], v6 offset:38912
ds_read_b64_tr_b16 v[30:31], v6 offset:39424
v_rcp_f32 v245, v245
v_mul_f32 v92, v92, v244
v_mul_f32 v93, v93, v245
v_mul_f32 v246, v94, v94
s_waitcnt lgkmcnt(4)
v_mfma_f32_32x32x16_bf16 v[96:111], v[16:19], v[232:235], v[96:111]
ds_read_b64_tr_b16 v[8:9], v1 offset:40960
ds_read_b64_tr_b16 v[10:11], v1 offset:41472
v_mul_f32 v247, v95, v95
v_fmaak_f32 v246, v246, v242, 0xc0135761
v_fmaak_f32 v247, v247, v242, 0xc0135761
v_mul_f32 v246, v94, v246
v_mfma_f32_32x32x16_bf16 v[112:127], v[20:23], v[232:235], v[112:127]
ds_read_b64_tr_b16 v[12:13], v6 offset:40960
ds_read_b64_tr_b16 v[14:15], v6 offset:41472
v_mul_f32 v247, v95, v247
v_exp_f32 v246, v246
v_exp_f32 v247, v247
s_waitcnt lgkmcnt(4)
v_mfma_f32_32x32x16_bf16 v[96:111], v[24:27], v[236:239], v[96:111]
ds_read_b64_tr_b16 v[16:17], v1 offset:43008
ds_read_b64_tr_b16 v[18:19], v1 offset:43520
v_add_f32 v246, 1.0, v246
v_add_f32 v247, 1.0, v247
v_rcp_f32 v246, v246
v_mfma_f32_32x32x16_bf16 v[112:127], v[28:31], v[236:239], v[112:127]
ds_read_b64_tr_b16 v[20:21], v6 offset:43008
ds_read_b64_tr_b16 v[22:23], v6 offset:43520
v_rcp_f32 v247, v247
v_mul_f32 v94, v94, v246
v_mul_f32 v95, v95, v247
s_waitcnt lgkmcnt(4)
v_mfma_f32_32x32x16_bf16 v[32:47], v[8:11], v[128:131], 0
ds_read_b64_tr_b16 v[24:25], v1 offset:45056
ds_read_b64_tr_b16 v[26:27], v1 offset:45568
v_mfma_f32_32x32x16_bf16 v[48:63], v[12:15], v[128:131], 0
ds_read_b64_tr_b16 v[28:29], v6 offset:45056
ds_read_b64_tr_b16 v[30:31], v6 offset:45568
s_waitcnt lgkmcnt(4)
v_mfma_f32_32x32x16_bf16 v[32:47], v[16:19], v[132:135], v[32:47]
ds_read_b64_tr_b16 v[8:9], v1 offset:47104
ds_read_b64_tr_b16 v[10:11], v1 offset:47616
v_mfma_f32_32x32x16_bf16 v[48:63], v[20:23], v[132:135], v[48:63]
ds_read_b64_tr_b16 v[12:13], v6 offset:47104
ds_read_b64_tr_b16 v[14:15], v6 offset:47616
s_barrier
s_waitcnt lgkmcnt(4)
v_mfma_f32_32x32x16_bf16 v[32:47], v[24:27], v[136:139], v[32:47]
ds_read_b64_tr_b16 v[16:17], v1 offset:49152
ds_read_b64_tr_b16 v[18:19], v1 offset:49664
v_mfma_f32_32x32x16_bf16 v[48:63], v[28:31], v[136:139], v[48:63]
ds_read_b64_tr_b16 v[20:21], v6 offset:49152
ds_read_b64_tr_b16 v[22:23], v6 offset:49664
s_waitcnt lgkmcnt(4)
v_mfma_f32_32x32x16_bf16 v[32:47], v[8:11], v[140:143], v[32:47]
ds_read_b64_tr_b16 v[24:25], v1 offset:51200
ds_read_b64_tr_b16 v[26:27], v1 offset:51712
v_mfma_f32_32x32x16_bf16 v[48:63], v[12:15], v[140:143], v[48:63]
ds_read_b64_tr_b16 v[28:29], v6 offset:51200
ds_read_b64_tr_b16 v[30:31], v6 offset:51712
s_waitcnt lgkmcnt(4)
v_mfma_f32_32x32x16_bf16 v[32:47], v[16:19], v[144:147], v[32:47]
ds_read_b64_tr_b16 v[8:9], v1 offset:53248
ds_read_b64_tr_b16 v[10:11], v1 offset:53760
v_mfma_f32_32x32x16_bf16 v[48:63], v[20:23], v[144:147], v[48:63]
ds_read_b64_tr_b16 v[12:13], v6 offset:53248
ds_read_b64_tr_b16 v[14:15], v6 offset:53760
s_waitcnt lgkmcnt(4)
v_mfma_f32_32x32x16_bf16 v[32:47], v[24:27], v[148:151], v[32:47]
ds_read_b64_tr_b16 v[16:17], v1 offset:55296
ds_read_b64_tr_b16 v[18:19], v1 offset:55808
v_mfma_f32_32x32x16_bf16 v[48:63], v[28:31], v[148:151], v[48:63]
ds_read_b64_tr_b16 v[20:21], v6 offset:55296
ds_read_b64_tr_b16 v[22:23], v6 offset:55808
s_waitcnt lgkmcnt(4)
v_mfma_f32_32x32x16_bf16 v[32:47], v[8:11], v[152:155], v[32:47]
ds_read_b64_tr_b16 v[24:25], v1 offset:57344
ds_read_b64_tr_b16 v[26:27], v1 offset:57856
v_mfma_f32_32x32x16_bf16 v[48:63], v[12:15], v[152:155], v[48:63]
ds_read_b64_tr_b16 v[28:29], v6 offset:57344
ds_read_b64_tr_b16 v[30:31], v6 offset:57856
s_waitcnt lgkmcnt(4)
v_mfma_f32_32x32x16_bf16 v[32:47], v[16:19], v[156:159], v[32:47]
ds_read_b64_tr_b16 v[8:9], v1 offset:59392
ds_read_b64_tr_b16 v[10:11], v1 offset:59904
v_mfma_f32_32x32x16_bf16 v[48:63], v[20:23], v[156:159], v[48:63]
ds_read_b64_tr_b16 v[12:13], v6 offset:59392
ds_read_b64_tr_b16 v[14:15], v6 offset:59904
s_waitcnt lgkmcnt(4)
v_mfma_f32_32x32x16_bf16 v[32:47], v[24:27], v[160:163], v[32:47]
ds_read_b64_tr_b16 v[16:17], v1 offset:61440
ds_read_b64_tr_b16 v[18:19], v1 offset:61952
s_mov_b32 s69, 0
v_mul_f32 v96, v64, v96
v_mul_f32 v97, v65, v97
v_mul_f32 v98, v66, v98
v_mul_f32 v99, v67, v99
v_mul_f32 v100, v68, v100
v_mfma_f32_32x32x16_bf16 v[48:63], v[28:31], v[160:163], v[48:63]
ds_read_b64_tr_b16 v[20:21], v6 offset:61440
ds_read_b64_tr_b16 v[22:23], v6 offset:61952
v_mul_f32 v101, v69, v101
v_mul_f32 v102, v70, v102
v_mul_f32 v103, v71, v103
v_cvt_pk_bf16_f32 v248, v96, v97
s_waitcnt lgkmcnt(4)
v_mfma_f32_32x32x16_bf16 v[32:47], v[8:11], v[164:167], v[32:47]
ds_read_b64_tr_b16 v[24:25], v1 offset:63488
ds_read_b64_tr_b16 v[26:27], v1 offset:64000
v_cvt_pk_bf16_f32 v249, v98, v99
v_cvt_pk_bf16_f32 v250, v100, v101
v_cvt_pk_bf16_f32 v251, v102, v103
v_mfma_f32_32x32x16_bf16 v[48:63], v[12:15], v[164:167], v[48:63]
ds_read_b64_tr_b16 v[28:29], v6 offset:63488
ds_read_b64_tr_b16 v[30:31], v6 offset:64000
s_waitcnt lgkmcnt(4)
v_mfma_f32_32x32x16_bf16 v[32:47], v[16:19], v[168:171], v[32:47]
v_add_u32 v1, 0x00010000, v1
v_add_u32 v6, 0x00010000, v6
ds_read_b64_tr_b16 v[8:9], v1 offset:0
ds_read_b64_tr_b16 v[10:11], v1 offset:512
buffer_store_dwordx4 v[248:251], v3, s[36:39], s66 offen offset:0 sc1
v_mfma_f32_32x32x16_bf16 v[48:63], v[20:23], v[168:171], v[48:63]
ds_read_b64_tr_b16 v[12:13], v6 offset:0
ds_read_b64_tr_b16 v[14:15], v6 offset:512
s_waitcnt lgkmcnt(4)
v_mfma_f32_32x32x16_bf16 v[32:47], v[24:27], v[172:175], v[32:47]
ds_read_b64_tr_b16 v[16:17], v1 offset:2048
ds_read_b64_tr_b16 v[18:19], v1 offset:2560
v_mul_f32 v104, v72, v104
v_mul_f32 v105, v73, v105
v_mul_f32 v106, v74, v106
v_mfma_f32_32x32x16_bf16 v[48:63], v[28:31], v[172:175], v[48:63]
ds_read_b64_tr_b16 v[20:21], v6 offset:2048
ds_read_b64_tr_b16 v[22:23], v6 offset:2560
v_mul_f32 v107, v75, v107
v_mul_f32 v108, v76, v108
v_mul_f32 v109, v77, v109
v_mul_f32 v110, v78, v110
s_waitcnt lgkmcnt(4)
v_mfma_f32_32x32x16_bf16 v[32:47], v[8:11], v[176:179], v[32:47]
ds_read_b64_tr_b16 v[24:25], v1 offset:4096
ds_read_b64_tr_b16 v[26:27], v1 offset:4608
v_mul_f32 v111, v79, v111
v_cvt_pk_bf16_f32 v252, v104, v105
v_cvt_pk_bf16_f32 v253, v106, v107
v_cvt_pk_bf16_f32 v254, v108, v109
v_cvt_pk_bf16_f32 v255, v110, v111
v_mfma_f32_32x32x16_bf16 v[48:63], v[12:15], v[176:179], v[48:63]
ds_read_b64_tr_b16 v[28:29], v6 offset:4096
ds_read_b64_tr_b16 v[30:31], v6 offset:4608
s_waitcnt lgkmcnt(4)
v_mfma_f32_32x32x16_bf16 v[32:47], v[16:19], v[180:183], v[32:47]
ds_read_b64_tr_b16 v[8:9], v1 offset:6144
ds_read_b64_tr_b16 v[10:11], v1 offset:6656
buffer_store_dwordx4 v[252:255], v3, s[36:39], s66 offen offset:1024 sc1
v_mfma_f32_32x32x16_bf16 v[48:63], v[20:23], v[180:183], v[48:63]
ds_read_b64_tr_b16 v[12:13], v6 offset:6144
ds_read_b64_tr_b16 v[14:15], v6 offset:6656
s_waitcnt lgkmcnt(4)
v_mfma_f32_32x32x16_bf16 v[32:47], v[24:27], v[184:187], v[32:47]
ds_read_b64_tr_b16 v[16:17], v1 offset:8192
ds_read_b64_tr_b16 v[18:19], v1 offset:8704
v_mul_f32 v112, v80, v112
v_mfma_f32_32x32x16_bf16 v[48:63], v[28:31], v[184:187], v[48:63]
ds_read_b64_tr_b16 v[20:21], v6 offset:8192
ds_read_b64_tr_b16 v[22:23], v6 offset:8704
v_mul_f32 v113, v81, v113
v_mul_f32 v114, v82, v114
v_mul_f32 v115, v83, v115
v_mul_f32 v116, v84, v116
s_waitcnt lgkmcnt(4)
v_mfma_f32_32x32x16_bf16 v[32:47], v[8:11], v[188:191], v[32:47]
ds_read_b64_tr_b16 v[24:25], v1 offset:10240
ds_read_b64_tr_b16 v[26:27], v1 offset:10752
v_mul_f32 v117, v85, v117
v_mul_f32 v118, v86, v118
v_mul_f32 v119, v87, v119
v_cvt_pk_bf16_f32 v248, v112, v113
v_cvt_pk_bf16_f32 v249, v114, v115
v_cvt_pk_bf16_f32 v250, v116, v117
v_mfma_f32_32x32x16_bf16 v[48:63], v[12:15], v[188:191], v[48:63]
ds_read_b64_tr_b16 v[28:29], v6 offset:10240
ds_read_b64_tr_b16 v[30:31], v6 offset:10752
v_cvt_pk_bf16_f32 v251, v118, v119
s_waitcnt lgkmcnt(4)
v_mfma_f32_32x32x16_bf16 v[32:47], v[16:19], v[192:195], v[32:47]
ds_read_b64_tr_b16 v[8:9], v1 offset:12288
ds_read_b64_tr_b16 v[10:11], v1 offset:12800
v_mfma_f32_32x32x16_bf16 v[48:63], v[20:23], v[192:195], v[48:63]
ds_read_b64_tr_b16 v[12:13], v6 offset:12288
ds_read_b64_tr_b16 v[14:15], v6 offset:12800
buffer_store_dwordx4 v[248:251], v3, s[36:39], s66 offen offset:2048 sc1
s_waitcnt lgkmcnt(4)
v_mfma_f32_32x32x16_bf16 v[32:47], v[24:27], v[196:199], v[32:47]
ds_read_b64_tr_b16 v[16:17], v1 offset:14336
ds_read_b64_tr_b16 v[18:19], v1 offset:14848
v_mfma_f32_32x32x16_bf16 v[48:63], v[28:31], v[196:199], v[48:63]
ds_read_b64_tr_b16 v[20:21], v6 offset:14336
ds_read_b64_tr_b16 v[22:23], v6 offset:14848
v_mul_f32 v120, v88, v120
v_mul_f32 v121, v89, v121
v_mul_f32 v122, v90, v122
s_waitcnt lgkmcnt(4)
v_mfma_f32_32x32x16_bf16 v[32:47], v[8:11], v[200:203], v[32:47]
ds_read_b64_tr_b16 v[24:25], v1 offset:16384
ds_read_b64_tr_b16 v[26:27], v1 offset:16896
v_mul_f32 v123, v91, v123
v_mul_f32 v124, v92, v124
v_mul_f32 v125, v93, v125
v_mul_f32 v126, v94, v126
v_mul_f32 v127, v95, v127
v_cvt_pk_bf16_f32 v252, v120, v121
v_mfma_f32_32x32x16_bf16 v[48:63], v[12:15], v[200:203], v[48:63]
ds_read_b64_tr_b16 v[28:29], v6 offset:16384
ds_read_b64_tr_b16 v[30:31], v6 offset:16896
v_cvt_pk_bf16_f32 v253, v122, v123
v_cvt_pk_bf16_f32 v254, v124, v125
v_cvt_pk_bf16_f32 v255, v126, v127
s_waitcnt lgkmcnt(4)
v_mfma_f32_32x32x16_bf16 v[32:47], v[16:19], v[204:207], v[32:47]
ds_read_b64_tr_b16 v[8:9], v1 offset:18432
ds_read_b64_tr_b16 v[10:11], v1 offset:18944
v_mfma_f32_32x32x16_bf16 v[48:63], v[20:23], v[204:207], v[48:63]
ds_read_b64_tr_b16 v[12:13], v6 offset:18432
ds_read_b64_tr_b16 v[14:15], v6 offset:18944
buffer_store_dwordx4 v[252:255], v3, s[36:39], s66 offen offset:3072 sc1
s_waitcnt lgkmcnt(4)
v_mfma_f32_32x32x16_bf16 v[32:47], v[24:27], v[208:211], v[32:47]
ds_read_b64_tr_b16 v[16:17], v1 offset:20480
ds_read_b64_tr_b16 v[18:19], v1 offset:20992
v_mfma_f32_32x32x16_bf16 v[48:63], v[28:31], v[208:211], v[48:63]
ds_read_b64_tr_b16 v[20:21], v6 offset:20480
ds_read_b64_tr_b16 v[22:23], v6 offset:20992
s_waitcnt lgkmcnt(4)
v_mfma_f32_32x32x16_bf16 v[32:47], v[8:11], v[212:215], v[32:47]
ds_read_b64_tr_b16 v[24:25], v1 offset:22528
ds_read_b64_tr_b16 v[26:27], v1 offset:23040
v_mfma_f32_32x32x16_bf16 v[48:63], v[12:15], v[212:215], v[48:63]
ds_read_b64_tr_b16 v[28:29], v6 offset:22528
ds_read_b64_tr_b16 v[30:31], v6 offset:23040
s_barrier
s_waitcnt lgkmcnt(4)
v_mfma_f32_32x32x16_bf16 v[32:47], v[16:19], v[216:219], v[32:47]
ds_read_b64_tr_b16 v[8:9], v1 offset:24576
ds_read_b64_tr_b16 v[10:11], v1 offset:25088
v_mfma_f32_32x32x16_bf16 v[48:63], v[20:23], v[216:219], v[48:63]
ds_read_b64_tr_b16 v[12:13], v6 offset:24576
ds_read_b64_tr_b16 v[14:15], v6 offset:25088
s_waitcnt lgkmcnt(4)
v_mfma_f32_32x32x16_bf16 v[32:47], v[24:27], v[220:223], v[32:47]
ds_read_b64_tr_b16 v[16:17], v1 offset:26624
ds_read_b64_tr_b16 v[18:19], v1 offset:27136
v_mfma_f32_32x32x16_bf16 v[48:63], v[28:31], v[220:223], v[48:63]
ds_read_b64_tr_b16 v[20:21], v6 offset:26624
ds_read_b64_tr_b16 v[22:23], v6 offset:27136
s_waitcnt lgkmcnt(4)
v_mfma_f32_32x32x16_bf16 v[32:47], v[8:11], v[224:227], v[32:47]
ds_read_b64_tr_b16 v[24:25], v1 offset:28672
ds_read_b64_tr_b16 v[26:27], v1 offset:29184
v_mfma_f32_32x32x16_bf16 v[48:63], v[12:15], v[224:227], v[48:63]
ds_read_b64_tr_b16 v[28:29], v6 offset:28672
ds_read_b64_tr_b16 v[30:31], v6 offset:29184
s_waitcnt lgkmcnt(4)
v_mfma_f32_32x32x16_bf16 v[32:47], v[16:19], v[228:231], v[32:47]
ds_read_b64_tr_b16 v[8:9], v1 offset:30720
ds_read_b64_tr_b16 v[10:11], v1 offset:31232
v_mfma_f32_32x32x16_bf16 v[48:63], v[20:23], v[228:231], v[48:63]
ds_read_b64_tr_b16 v[12:13], v6 offset:30720
ds_read_b64_tr_b16 v[14:15], v6 offset:31232
s_waitcnt lgkmcnt(4)
v_mfma_f32_32x32x16_bf16 v[32:47], v[24:27], v[232:235], v[32:47]
v_add_u32 v1, 0xfffe0000, v1
ds_read_b64_tr_b16 v[16:17], v1 offset:49152
ds_read_b64_tr_b16 v[18:19], v1 offset:49664
v_mfma_f32_32x32x16_bf16 v[48:63], v[28:31], v[232:235], v[48:63]
ds_read_b64_tr_b16 v[20:21], v1 offset:51200
ds_read_b64_tr_b16 v[22:23], v1 offset:51712
s_waitcnt lgkmcnt(4)
v_mfma_f32_32x32x16_bf16 v[32:47], v[8:11], v[236:239], v[32:47]
ds_read_b64_tr_b16 v[24:25], v1 offset:53248
ds_read_b64_tr_b16 v[26:27], v1 offset:53760
v_mfma_f32_32x32x16_bf16 v[48:63], v[12:15], v[236:239], v[48:63]
ds_read_b64_tr_b16 v[28:29], v1 offset:55296
ds_read_b64_tr_b16 v[30:31], v1 offset:55808
s_getreg_b32 s54, hwreg(HW_REG_IB_STS, 0, 4)
s_or_b32 s54, s54, s69
s_cbranch_scc1 L_tf28
buffer_store_dword v7, v4, s[36:39], s67 offen sc1
s_mov_b32 s69, 1
L_tf28:
s_waitcnt lgkmcnt(4)
v_mfma_f32_32x32x16_bf16 v[64:79], v[16:19], v[128:131], 0
ds_read_b64_tr_b16 v[8:9], v1 offset:57344
ds_read_b64_tr_b16 v[10:11], v1 offset:57856
v_mfma_f32_32x32x16_bf16 v[64:79], v[20:23], v[132:135], v[64:79]
ds_read_b64_tr_b16 v[12:13], v1 offset:59392
ds_read_b64_tr_b16 v[14:15], v1 offset:59904
s_waitcnt lgkmcnt(4)
v_mfma_f32_32x32x16_bf16 v[64:79], v[24:27], v[136:139], v[64:79]
ds_read_b64_tr_b16 v[16:17], v1 offset:61440
ds_read_b64_tr_b16 v[18:19], v1 offset:61952
s_xor_b32 s59, s66, 4096
v_mul_f32 v244, v32, v32
v_mul_f32 v245, v33, v33
v_fmaak_f32 v244, v244, v242, 0xc0135761
v_fmaak_f32 v245, v245, v242, 0xc0135761
v_mul_f32 v244, v32, v244
v_mul_f32 v245, v33, v245
v_mfma_f32_32x32x16_bf16 v[64:79], v[28:31], v[140:143], v[64:79]
ds_read_b64_tr_b16 v[20:21], v1 offset:63488
ds_read_b64_tr_b16 v[22:23], v1 offset:64000
v_exp_f32 v244, v244
v_exp_f32 v245, v245
v_add_f32 v244, 1.0, v244
v_add_f32 v245, 1.0, v245
s_waitcnt lgkmcnt(4)
v_mfma_f32_32x32x16_bf16 v[64:79], v[8:11], v[144:147], v[64:79]
v_add_u32 v1, 0x00010000, v1
ds_read_b64_tr_b16 v[24:25], v1 offset:0
ds_read_b64_tr_b16 v[26:27], v1 offset:512
v_rcp_f32 v244, v244
v_rcp_f32 v245, v245
v_mul_f32 v32, v32, v244
v_mul_f32 v33, v33, v245
v_mul_f32 v246, v34, v34
v_mfma_f32_32x32x16_bf16 v[64:79], v[12:15], v[148:151], v[64:79]
ds_read_b64_tr_b16 v[28:29], v1 offset:2048
ds_read_b64_tr_b16 v[30:31], v1 offset:2560
v_mul_f32 v247, v35, v35
v_fmaak_f32 v246, v246, v242, 0xc0135761
v_fmaak_f32 v247, v247, v242, 0xc0135761
v_mul_f32 v246, v34, v246
v_mul_f32 v247, v35, v247
v_exp_f32 v246, v246
s_waitcnt lgkmcnt(4)
v_mfma_f32_32x32x16_bf16 v[64:79], v[16:19], v[152:155], v[64:79]
ds_read_b64_tr_b16 v[8:9], v1 offset:4096
ds_read_b64_tr_b16 v[10:11], v1 offset:4608
v_exp_f32 v247, v247
v_add_f32 v246, 1.0, v246
v_add_f32 v247, 1.0, v247
v_rcp_f32 v246, v246
v_mfma_f32_32x32x16_bf16 v[64:79], v[20:23], v[156:159], v[64:79]
ds_read_b64_tr_b16 v[12:13], v1 offset:6144
ds_read_b64_tr_b16 v[14:15], v1 offset:6656
v_rcp_f32 v247, v247
v_mul_f32 v34, v34, v246
v_mul_f32 v35, v35, v247
v_mul_f32 v244, v36, v36
v_mul_f32 v245, v37, v37
s_waitcnt lgkmcnt(4)
v_mfma_f32_32x32x16_bf16 v[64:79], v[24:27], v[160:163], v[64:79]
ds_read_b64_tr_b16 v[16:17], v1 offset:8192
ds_read_b64_tr_b16 v[18:19], v1 offset:8704
v_fmaak_f32 v244, v244, v242, 0xc0135761
v_fmaak_f32 v245, v245, v242, 0xc0135761
v_mul_f32 v244, v36, v244
v_mul_f32 v245, v37, v245
v_exp_f32 v244, v244
v_exp_f32 v245, v245
v_mfma_f32_32x32x16_bf16 v[64:79], v[28:31], v[164:167], v[64:79]
ds_read_b64_tr_b16 v[20:21], v1 offset:10240
ds_read_b64_tr_b16 v[22:23], v1 offset:10752
v_add_f32 v244, 1.0, v244
v_add_f32 v245, 1.0, v245
v_rcp_f32 v244, v244
v_rcp_f32 v245, v245
s_waitcnt lgkmcnt(4)
v_mfma_f32_32x32x16_bf16 v[64:79], v[8:11], v[168:171], v[64:79]
ds_read_b64_tr_b16 v[24:25], v1 offset:12288
ds_read_b64_tr_b16 v[26:27], v1 offset:12800
v_mul_f32 v36, v36, v244
v_mul_f32 v37, v37, v245
v_mul_f32 v246, v38, v38
v_mul_f32 v247, v39, v39
v_fmaak_f32 v246, v246, v242, 0xc0135761
v_fmaak_f32 v247, v247, v242, 0xc0135761
v_mfma_f32_32x32x16_bf16 v[64:79], v[12:15], v[172:175], v[64:79]
ds_read_b64_tr_b16 v[28:29], v1 offset:14336
ds_read_b64_tr_b16 v[30:31], v1 offset:14848
v_mul_f32 v246, v38, v246
v_mul_f32 v247, v39, v247
v_exp_f32 v246, v246
v_exp_f32 v247, v247
s_getreg_b32 s54, hwreg(HW_REG_IB_STS, 0, 4)
s_or_b32 s54, s54, s69
s_cbranch_scc1 L_tf34
buffer_store_dword v7, v4, s[36:39], s67 offen sc1
s_mov_b32 s69, 1
L_tf34:
s_waitcnt lgkmcnt(4)
v_mfma_f32_32x32x16_bf16 v[64:79], v[16:19], v[176:179], v[64:79]
ds_read_b64_tr_b16 v[8:9], v1 offset:16384
ds_read_b64_tr_b16 v[10:11], v1 offset:16896
v_add_f32 v246, 1.0, v246
v_add_f32 v247, 1.0, v247
v_rcp_f32 v246, v246
v_rcp_f32 v247, v247
v_mul_f32 v38, v38, v246
v_mfma_f32_32x32x16_bf16 v[64:79], v[20:23], v[180:183], v[64:79]
ds_read_b64_tr_b16 v[12:13], v1 offset:18432
ds_read_b64_tr_b16 v[14:15], v1 offset:18944
v_mul_f32 v39, v39, v247
v_mul_f32 v244, v40, v40
v_mul_f32 v245, v41, v41
v_fmaak_f32 v244, v244, v242, 0xc0135761
v_fmaak_f32 v245, v245, v242, 0xc0135761
v_mul_f32 v244, v40, v244
s_waitcnt lgkmcnt(4)
v_mfma_f32_32x32x16_bf16 v[64:79], v[24:27], v[184:187], v[64:79]
ds_read_b64_tr_b16 v[16:17], v1 offset:20480
ds_read_b64_tr_b16 v[18:19], v1 offset:20992
v_mul_f32 v245, v41, v245
v_exp_f32 v244, v244
v_exp_f32 v245, v245
v_add_f32 v244, 1.0, v244
v_add_f32 v245, 1.0, v245
v_mfma_f32_32x32x16_bf16 v[64:79], v[28:31], v[188:191], v[64:79]
ds_read_b64_tr_b16 v[20:21], v1 offset:22528
ds_read_b64_tr_b16 v[22:23], v1 offset:23040
v_rcp_f32 v244, v244
v_rcp_f32 v245, v245
v_mul_f32 v40, v40, v244
v_mul_f32 v41, v41, v245
v_mul_f32 v246, v42, v42
s_waitcnt lgkmcnt(4)
v_mfma_f32_32x32x16_bf16 v[64:79], v[8:11], v[192:195], v[64:79]
ds_read_b64_tr_b16 v[24:25], v1 offset:24576
ds_read_b64_tr_b16 v[26:27], v1 offset:25088
v_mul_f32 v247, v43, v43
v_fmaak_f32 v246, v246, v242, 0xc0135761
v_fmaak_f32 v247, v247, v242, 0xc0135761
v_mul_f32 v246, v42, v246
v_mul_f32 v247, v43, v247
v_exp_f32 v246, v246
v_mfma_f32_32x32x16_bf16 v[64:79], v[12:15], v[196:199], v[64:79]
ds_read_b64_tr_b16 v[28:29], v1 offset:26624
ds_read_b64_tr_b16 v[30:31], v1 offset:27136
v_exp_f32 v247, v247
v_add_f32 v246, 1.0, v246
v_add_f32 v247, 1.0, v247
v_rcp_f32 v246, v246
s_waitcnt lgkmcnt(4)
v_mfma_f32_32x32x16_bf16 v[64:79], v[16:19], v[200:203], v[64:79]
ds_read_b64_tr_b16 v[8:9], v1 offset:28672
ds_read_b64_tr_b16 v[10:11], v1 offset:29184
v_rcp_f32 v247, v247
v_mul_f32 v42, v42, v246
v_mul_f32 v43, v43, v247
v_mul_f32 v244, v44, v44
v_mul_f32 v245, v45, v45
v_fmaak_f32 v244, v244, v242, 0xc0135761
v_mfma_f32_32x32x16_bf16 v[64:79], v[20:23], v[204:207], v[64:79]
ds_read_b64_tr_b16 v[12:13], v1 offset:30720
ds_read_b64_tr_b16 v[14:15], v1 offset:31232
v_fmaak_f32 v245, v245, v242, 0xc0135761
v_mul_f32 v244, v44, v244
v_mul_f32 v245, v45, v245
v_exp_f32 v244, v244
s_waitcnt lgkmcnt(4)
v_mfma_f32_32x32x16_bf16 v[64:79], v[24:27], v[208:211], v[64:79]
ds_read_b64_tr_b16 v[16:17], v1 offset:32768
ds_read_b64_tr_b16 v[18:19], v1 offset:33280
v_exp_f32 v245, v245
v_add_f32 v244, 1.0, v244
v_add_f32 v245, 1.0, v245
v_rcp_f32 v244, v244
v_rcp_f32 v245, v245
v_mfma_f32_32x32x16_bf16 v[64:79], v[28:31], v[212:215], v[64:79]
ds_read_b64_tr_b16 v[20:21], v1 offset:34816
ds_read_b64_tr_b16 v[22:23], v1 offset:35328
v_mul_f32 v44, v44, v244
v_mul_f32 v45, v45, v245
v_mul_f32 v246, v46, v46
v_mul_f32 v247, v47, v47
v_fmaak_f32 v246, v246, v242, 0xc0135761
v_fmaak_f32 v247, v247, v242, 0xc0135761
s_waitcnt lgkmcnt(4)
v_mfma_f32_32x32x16_bf16 v[64:79], v[8:11], v[216:219], v[64:79]
ds_read_b64_tr_b16 v[24:25], v1 offset:36864
ds_read_b64_tr_b16 v[26:27], v1 offset:37376
v_mul_f32 v246, v46, v246
v_mul_f32 v247, v47, v247
v_exp_f32 v246, v246
v_exp_f32 v247, v247
v_add_f32 v246, 1.0, v246
v_mfma_f32_32x32x16_bf16 v[64:79], v[12:15], v[220:223], v[64:79]
ds_read_b64_tr_b16 v[28:29], v1 offset:38912
ds_read_b64_tr_b16 v[30:31], v1 offset:39424
v_add_f32 v247, 1.0, v247
v_rcp_f32 v246, v246
v_rcp_f32 v247, v247
v_mul_f32 v46, v46, v246
s_getreg_b32 s54, hwreg(HW_REG_IB_STS, 0, 4)
s_or_b32 s54, s54, s69
s_cbranch_scc1 L_tf40
buffer_store_dword v7, v4, s[36:39], s67 offen sc1
s_mov_b32 s69, 1
L_tf40:
s_waitcnt lgkmcnt(4)
v_mfma_f32_32x32x16_bf16 v[64:79], v[16:19], v[224:227], v[64:79]
v_add_u32 v6, 0xfffe0000, v6
ds_read_b64_tr_b16 v[8:9], v6 offset:49152
ds_read_b64_tr_b16 v[10:11], v6 offset:49664
v_mul_f32 v47, v47, v247
v_mul_f32 v244, v48, v48
v_mul_f32 v245, v49, v49
v_fmaak_f32 v244, v244, v242, 0xc0135761
v_fmaak_f32 v245, v245, v242, 0xc0135761
v_mul_f32 v244, v48, v244
v_mul_f32 v245, v49, v245
v_mfma_f32_32x32x16_bf16 v[64:79], v[20:23], v[228:231], v[64:79]
ds_read_b64_tr_b16 v[12:13], v6 offset:51200
ds_read_b64_tr_b16 v[14:15], v6 offset:51712
v_exp_f32 v244, v244
v_exp_f32 v245, v245
v_add_f32 v244, 1.0, v244
v_add_f32 v245, 1.0, v245
s_waitcnt lgkmcnt(4)
v_mfma_f32_32x32x16_bf16 v[64:79], v[24:27], v[232:235], v[64:79]
ds_read_b64_tr_b16 v[16:17], v6 offset:53248
ds_read_b64_tr_b16 v[18:19], v6 offset:53760
v_rcp_f32 v244, v244
v_rcp_f32 v245, v245
v_mul_f32 v48, v48, v244
v_mul_f32 v49, v49, v245
v_mfma_f32_32x32x16_bf16 v[64:79], v[28:31], v[236:239], v[64:79]
ds_read_b64_tr_b16 v[20:21], v6 offset:55296
ds_read_b64_tr_b16 v[22:23], v6 offset:55808
s_waitcnt lgkmcnt(4)
v_mfma_f32_32x32x16_bf16 v[80:95], v[8:11], v[128:131], 0
ds_read_b64_tr_b16 v[24:25], v6 offset:57344
ds_read_b64_tr_b16 v[26:27], v6 offset:57856
v_mfma_f32_32x32x16_bf16 v[80:95], v[12:15], v[132:135], v[80:95]
ds_read_b64_tr_b16 v[28:29], v6 offset:59392
ds_read_b64_tr_b16 v[30:31], v6 offset:59904
s_cmp_eq_u32 s69, 1
s_cbranch_scc1 L_tfz
s_waitcnt vmcnt(0)
buffer_store_dword v7, v4, s[36:39], s67 offen sc1
L_tfz:
s_waitcnt lgkmcnt(4)
v_mfma_f32_32x32x16_bf16 v[80:95], v[16:19], v[136:139], v[80:95]
ds_read_b64_tr_b16 v[8:9], v6 offset:61440
ds_read_b64_tr_b16 v[10:11], v6 offset:61952
v_mul_f32 v64, v32, v64
v_mul_f32 v65, v33, v65
v_mul_f32 v66, v34, v66
v_mul_f32 v67, v35, v67
v_mul_f32 v68, v36, v68
v_mul_f32 v69, v37, v69
v_mul_f32 v70, v38, v70
v_mul_f32 v71, v39, v71
v_cvt_pk_bf16_f32 v248, v64, v65
v_cvt_pk_bf16_f32 v249, v66, v67
v_cvt_pk_bf16_f32 v250, v68, v69
v_cvt_pk_bf16_f32 v251, v70, v71
buffer_store_dwordx4 v[248:251], v3, s[36:39], s59 offen offset:0 sc1
v_mfma_f32_32x32x16_bf16 v[80:95], v[20:23], v[140:143], v[80:95]
ds_read_b64_tr_b16 v[12:13], v6 offset:63488
ds_read_b64_tr_b16 v[14:15], v6 offset:64000
v_mul_f32 v72, v40, v72
s_waitcnt lgkmcnt(4)
v_mfma_f32_32x32x16_bf16 v[80:95], v[24:27], v[144:147], v[80:95]
v_add_u32 v6, 0x00010000, v6
ds_read_b64_tr_b16 v[16:17], v6 offset:0
ds_read_b64_tr_b16 v[18:19], v6 offset:512
v_mul_f32 v73, v41, v73
v_mul_f32 v74, v42, v74
v_mul_f32 v75, v43, v75
v_mul_f32 v76, v44, v76
v_mul_f32 v77, v45, v77
v_mul_f32 v78, v46, v78
v_mul_f32 v79, v47, v79
v_mfma_f32_32x32x16_bf16 v[80:95], v[28:31], v[148:151], v[80:95]
ds_read_b64_tr_b16 v[20:21], v6 offset:2048
ds_read_b64_tr_b16 v[22:23], v6 offset:2560
v_cvt_pk_bf16_f32 v252, v72, v73
v_cvt_pk_bf16_f32 v253, v74, v75
v_cvt_pk_bf16_f32 v254, v76, v77
v_cvt_pk_bf16_f32 v255, v78, v79
s_waitcnt lgkmcnt(4)
v_mfma_f32_32x32x16_bf16 v[80:95], v[8:11], v[152:155], v[80:95]
ds_read_b64_tr_b16 v[24:25], v6 offset:4096
ds_read_b64_tr_b16 v[26:27], v6 offset:4608
v_mfma_f32_32x32x16_bf16 v[80:95], v[12:15], v[156:159], v[80:95]
ds_read_b64_tr_b16 v[28:29], v6 offset:6144
ds_read_b64_tr_b16 v[30:31], v6 offset:6656
buffer_store_dwordx4 v[252:255], v3, s[36:39], s59 offen offset:1024 sc1
s_waitcnt lgkmcnt(4)
v_mfma_f32_32x32x16_bf16 v[80:95], v[16:19], v[160:163], v[80:95]
ds_read_b64_tr_b16 v[8:9], v6 offset:8192
ds_read_b64_tr_b16 v[10:11], v6 offset:8704
v_mul_f32 v246, v50, v50
v_mul_f32 v247, v51, v51
v_mfma_f32_32x32x16_bf16 v[80:95], v[20:23], v[164:167], v[80:95]
ds_read_b64_tr_b16 v[12:13], v6 offset:10240
ds_read_b64_tr_b16 v[14:15], v6 offset:10752
v_fmaak_f32 v246, v246, v242, 0xc0135761
v_fmaak_f32 v247, v247, v242, 0xc0135761
v_mul_f32 v246, v50, v246
v_mul_f32 v247, v51, v247
v_exp_f32 v246, v246
s_waitcnt lgkmcnt(4)
v_mfma_f32_32x32x16_bf16 v[80:95], v[24:27], v[168:171], v[80:95]
ds_read_b64_tr_b16 v[16:17], v6 offset:12288
ds_read_b64_tr_b16 v[18:19], v6 offset:12800
v_exp_f32 v247, v247
v_add_f32 v246, 1.0, v246
v_add_f32 v247, 1.0, v247
v_rcp_f32 v246, v246
v_rcp_f32 v247, v247
v_mfma_f32_32x32x16_bf16 v[80:95], v[28:31], v[172:175], v[80:95]
ds_read_b64_tr_b16 v[20:21], v6 offset:14336
ds_read_b64_tr_b16 v[22:23], v6 offset:14848
v_mul_f32 v50, v50, v246
v_mul_f32 v51, v51, v247
v_mul_f32 v244, v52, v52
v_mul_f32 v245, v53, v53
v_fmaak_f32 v244, v244, v242, 0xc0135761
s_waitcnt lgkmcnt(4)
v_mfma_f32_32x32x16_bf16 v[80:95], v[8:11], v[176:179], v[80:95]
ds_read_b64_tr_b16 v[24:25], v6 offset:16384
ds_read_b64_tr_b16 v[26:27], v6 offset:16896
v_fmaak_f32 v245, v245, v242, 0xc0135761
v_mul_f32 v244, v52, v244
v_mul_f32 v245, v53, v245
v_exp_f32 v244, v244
v_exp_f32 v245, v245
v_mfma_f32_32x32x16_bf16 v[80:95], v[12:15], v[180:183], v[80:95]
ds_read_b64_tr_b16 v[28:29], v6 offset:18432
ds_read_b64_tr_b16 v[30:31], v6 offset:18944
v_add_f32 v244, 1.0, v244
v_add_f32 v245, 1.0, v245
v_rcp_f32 v244, v244
v_rcp_f32 v245, v245
s_waitcnt lgkmcnt(4)
v_mfma_f32_32x32x16_bf16 v[80:95], v[16:19], v[184:187], v[80:95]
ds_read_b64_tr_b16 v[8:9], v6 offset:20480
ds_read_b64_tr_b16 v[10:11], v6 offset:20992
v_mul_f32 v52, v52, v244
v_mul_f32 v53, v53, v245
v_mul_f32 v246, v54, v54
v_mul_f32 v247, v55, v55
v_fmaak_f32 v246, v246, v242, 0xc0135761
v_fmaak_f32 v247, v247, v242, 0xc0135761
v_mul_f32 v246, v54, v246
v_mul_f32 v247, v55, v247
v_mfma_f32_32x32x16_bf16 v[80:95], v[20:23], v[188:191], v[80:95]
ds_read_b64_tr_b16 v[12:13], v6 offset:22528
ds_read_b64_tr_b16 v[14:15], v6 offset:23040
v_exp_f32 v246, v246
v_exp_f32 v247, v247
v_add_f32 v246, 1.0, v246
v_add_f32 v247, 1.0, v247
s_waitcnt lgkmcnt(4)
v_mfma_f32_32x32x16_bf16 v[80:95], v[24:27], v[192:195], v[80:95]
ds_read_b64_tr_b16 v[16:17], v6 offset:24576
ds_read_b64_tr_b16 v[18:19], v6 offset:25088
v_rcp_f32 v246, v246
v_rcp_f32 v247, v247
v_mul_f32 v54, v54, v246
v_mul_f32 v55, v55, v247
v_mul_f32 v244, v56, v56
v_mfma_f32_32x32x16_bf16 v[80:95], v[28:31], v[196:199], v[80:95]
ds_read_b64_tr_b16 v[20:21], v6 offset:26624
ds_read_b64_tr_b16 v[22:23], v6 offset:27136
v_mul_f32 v245, v57, v57
v_fmaak_f32 v244, v244, v242, 0xc0135761
v_fmaak_f32 v245, v245, v242, 0xc0135761
v_mul_f32 v244, v56, v244
v_mul_f32 v245, v57, v245
s_waitcnt lgkmcnt(4)
v_mfma_f32_32x32x16_bf16 v[80:95], v[8:11], v[200:203], v[80:95]
ds_read_b64_tr_b16 v[24:25], v6 offset:28672
ds_read_b64_tr_b16 v[26:27], v6 offset:29184
v_exp_f32 v244, v244
v_exp_f32 v245, v245
v_add_f32 v244, 1.0, v244
v_add_f32 v245, 1.0, v245
v_rcp_f32 v244, v244
v_mfma_f32_32x32x16_bf16 v[80:95], v[12:15], v[204:207], v[80:95]
ds_read_b64_tr_b16 v[28:29], v6 offset:30720
ds_read_b64_tr_b16 v[30:31], v6 offset:31232
v_rcp_f32 v245, v245
v_mul_f32 v56, v56, v244
v_mul_f32 v57, v57, v245
v_mul_f32 v246, v58, v58
v_mul_f32 v247, v59, v59
s_waitcnt lgkmcnt(4)
v_mfma_f32_32x32x16_bf16 v[80:95], v[16:19], v[208:211], v[80:95]
ds_read_b64_tr_b16 v[8:9], v6 offset:32768
ds_read_b64_tr_b16 v[10:11], v6 offset:33280
v_fmaak_f32 v246, v246, v242, 0xc0135761
v_fmaak_f32 v247, v247, v242, 0xc0135761
v_mul_f32 v246, v58, v246
v_mul_f32 v247, v59, v247
v_exp_f32 v246, v246
v_mfma_f32_32x32x16_bf16 v[80:95], v[20:23], v[212:215], v[80:95]
ds_read_b64_tr_b16 v[12:13], v6 offset:34816
ds_read_b64_tr_b16 v[14:15], v6 offset:35328
v_exp_f32 v247, v247
v_add_f32 v246, 1.0, v246
v_add_f32 v247, 1.0, v247
v_rcp_f32 v246, v246
s_waitcnt lgkmcnt(4)
v_mfma_f32_32x32x16_bf16 v[80:95], v[24:27], v[216:219], v[80:95]
ds_read_b64_tr_b16 v[16:17], v6 offset:36864
ds_read_b64_tr_b16 v[18:19], v6 offset:37376
v_rcp_f32 v247, v247
v_mul_f32 v58, v58, v246
v_mul_f32 v59, v59, v247
v_mul_f32 v244, v60, v60
v_mul_f32 v245, v61, v61
v_fmaak_f32 v244, v244, v242, 0xc0135761
v_fmaak_f32 v245, v245, v242, 0xc0135761
v_mfma_f32_32x32x16_bf16 v[80:95], v[28:31], v[220:223], v[80:95]
ds_read_b64_tr_b16 v[20:21], v6 offset:38912
ds_read_b64_tr_b16 v[22:23], v6 offset:39424
v_mul_f32 v244, v60, v244
v_mul_f32 v245, v61, v245
v_exp_f32 v244, v244
v_exp_f32 v245, v245
s_waitcnt lgkmcnt(4)
v_mfma_f32_32x32x16_bf16 v[80:95], v[8:11], v[224:227], v[80:95]
v_add_f32 v244, 1.0, v244
v_add_f32 v245, 1.0, v245
v_rcp_f32 v244, v244
v_rcp_f32 v245, v245
v_mul_f32 v60, v60, v244
v_mfma_f32_32x32x16_bf16 v[80:95], v[12:15], v[228:231], v[80:95]
v_mul_f32 v61, v61, v245
v_mul_f32 v246, v62, v62
v_mul_f32 v247, v63, v63
v_fmaak_f32 v246, v246, v242, 0xc0135761
v_fmaak_f32 v247, v247, v242, 0xc0135761
v_mul_f32 v246, v62, v246
s_waitcnt lgkmcnt(0)
v_mfma_f32_32x32x16_bf16 v[80:95], v[16:19], v[232:235], v[80:95]
v_mul_f32 v247, v63, v247
v_exp_f32 v246, v246
v_exp_f32 v247, v247
v_add_f32 v246, 1.0, v246
v_add_f32 v247, 1.0, v247
v_mfma_f32_32x32x16_bf16 v[80:95], v[20:23], v[236:239], v[80:95]
v_rcp_f32 v246, v246
v_rcp_f32 v247, v247
v_mul_f32 v62, v62, v246
v_mul_f32 v63, v63, v247
s_nop 7
v_mul_f32 v80, v48, v80
v_mul_f32 v81, v49, v81
v_mul_f32 v82, v50, v82
v_mul_f32 v83, v51, v83
v_mul_f32 v84, v52, v84
v_mul_f32 v85, v53, v85
v_mul_f32 v86, v54, v86
v_mul_f32 v87, v55, v87
v_cvt_pk_bf16_f32 v248, v80, v81
v_cvt_pk_bf16_f32 v249, v82, v83
v_cvt_pk_bf16_f32 v250, v84, v85
v_cvt_pk_bf16_f32 v251, v86, v87
buffer_store_dwordx4 v[248:251], v3, s[36:39], s59 offen offset:2048 sc1
v_mul_f32 v88, v56, v88
v_mul_f32 v89, v57, v89
v_mul_f32 v90, v58, v90
v_mul_f32 v91, v59, v91
v_mul_f32 v92, v60, v92
v_mul_f32 v93, v61, v93
v_mul_f32 v94, v62, v94
v_mul_f32 v95, v63, v95
v_cvt_pk_bf16_f32 v252, v88, v89
v_cvt_pk_bf16_f32 v253, v90, v91
v_cvt_pk_bf16_f32 v254, v92, v93
v_cvt_pk_bf16_f32 v255, v94, v95
buffer_store_dwordx4 v[252:255], v3, s[36:39], s59 offen offset:3072 sc1
s_setprio 3
v_mov_b32 v244, v7
s_waitcnt vmcnt(0)
s_add_u32 s67, s67, 16384
buffer_store_dword v244, v4, s[36:39], s67 offen sc1
s_mov_b32 s100, s44
s_lshr_b32 s54, s46, 3
s_mul_i32 s54, s54, 0
s_mul_i32 s55, s48, 3
s_add_u32 s54, s54, s55
s_sub_u32 s55, s54, 7
s_cmp_ge_u32 s54, 7
s_cselect_b32 s54, s55, s54
s_sub_u32 s55, s54, 7
s_cmp_ge_u32 s54, 7
s_cselect_b32 s54, s55, s54
s_mov_b32 s99, s54
s_lshl_b32 s74, s100, 12
s_lshl_b32 s71, s46, 7
s_mul_i32 s54, s3, 57344
s_add_u32 s72, s71, s54
s_sub_u32 s73, 57344, s54
s_add_u32 s73, s73, s71
v_and_b32 v8, 7, v0
v_lshrrev_b32 v9, 2, v0
v_and_b32 v9, 4, v9
v_xor_b32 v8, v8, v9
v_lshrrev_b32 v9, 3, v0
v_mul_u32_u24 v9, 896, v9
v_lshl_add_u32 v3, v8, 4, v9
v_lshrrev_b32 v8, 3, v0
v_mul_u32_u24 v8, 896, v8
v_and_b32 v9, 7, v0
v_lshl_add_u32 v7, v9, 4, v8
s_lshl_b32 s54, s45, 7
s_lshl_b32 s55, s47, 6
s_add_u32 s54, s54, s55
s_lshl_b32 s55, s44, 3
s_add_u32 s54, s54, s55
s_mul_i32 s54, s54, 896
s_lshl_b32 s55, s46, 7
s_add_u32 s59, s54, s55
buffer_load_dwordx4 v[60:63], v7, s[4:7], s59 offen
s_barrier
s_mul_i32 s54, s100, 7
s_add_u32 s54, s54, s99
s_add_u32 s54, s54, 6
s_sub_u32 s55, s54, 28
s_cmp_ge_u32 s54, 28
s_cselect_b32 s54, s55, s54
s_lshr_b32 s55, s54, 1
s_mul_i32 s55, s55, 114688
s_and_b32 s56, s54, 1
s_mul_i32 s56, s56, 28672
s_add_u32 s55, s55, s56
s_add_u32 s55, s55, s73
s_add_u32 m0, s74, 147456
s_nop 0
buffer_load_dwordx4 v3, s[24:27], s55 offen  lds
s_add_u32 m0, s74, 148480
s_add_u32 s55, s55, 7168
buffer_load_dwordx4 v3, s[24:27], s55 offen  lds
s_add_u32 m0, s74, 149504
s_add_u32 s55, s55, 7168
buffer_load_dwordx4 v3, s[24:27], s55 offen  lds
s_add_u32 m0, s74, 150528
s_add_u32 s55, s55, 7168
buffer_load_dwordx4 v3, s[24:27], s55 offen  lds
s_mul_i32 s54, s100, 4
s_add_u32 s54, s54, s99
s_and_b32 s54, s54, 15
s_mul_i32 s55, s54, 25088
s_add_u32 s55, s55, s71
s_add_u32 m0, s74, 49152
s_nop 0
buffer_load_dwordx4 v3, s[12:15], s55 offen  lds
s_add_u32 m0, s74, 50176
s_add_u32 s55, s55, 7168
buffer_load_dwordx4 v3, s[12:15], s55 offen  lds
s_add_u32 m0, s74, 51200
s_add_u32 s55, s55, 7168
buffer_load_dwordx4 v3, s[12:15], s55 offen  lds
s_add_u32 m0, s74, 52224
s_add_u32 s55, s55, 7168
v_cmp_gt_u32 vcc, 32, v0
v_mov_b32 v10, 0x40000000
s_nop 0
v_cndmask_b32 v10, v10, v3, vcc
buffer_load_dwordx4 v10, s[12:15], s55 offen  lds
s_mul_i32 s54, s100, 4
s_add_u32 s54, s54, s99
s_add_u32 s54, s54, 1
s_and_b32 s54, s54, 15
s_mul_i32 s55, s54, 25088
s_add_u32 s55, s55, s71
s_add_u32 m0, s74, 65536
s_nop 0
buffer_load_dwordx4 v3, s[12:15], s55 offen  lds
s_add_u32 m0, s74, 66560
s_add_u32 s55, s55, 7168
buffer_load_dwordx4 v3, s[12:15], s55 offen  lds
s_add_u32 m0, s74, 67584
s_add_u32 s55, s55, 7168
buffer_load_dwordx4 v3, s[12:15], s55 offen  lds
s_add_u32 m0, s74, 68608
s_add_u32 s55, s55, 7168
v_cmp_gt_u32 vcc, 32, v0
v_mov_b32 v10, 0x40000000
s_nop 0
v_cndmask_b32 v10, v10, v3, vcc
buffer_load_dwordx4 v10, s[12:15], s55 offen  lds
s_mul_i32 s54, s100, 4
s_add_u32 s54, s54, s99
s_add_u32 s54, s54, 2
s_and_b32 s54, s54, 15
s_mul_i32 s55, s54, 25088
s_add_u32 s55, s55, s71
s_add_u32 m0, s74, 81920
s_nop 0
buffer_load_dwordx4 v3, s[12:15], s55 offen  lds
s_add_u32 m0, s74, 82944
s_add_u32 s55, s55, 7168
buffer_load_dwordx4 v3, s[12:15], s55 offen  lds
s_add_u32 m0, s74, 83968
s_add_u32 s55, s55, 7168
buffer_load_dwordx4 v3, s[12:15], s55 offen  lds
s_add_u32 m0, s74, 84992
s_add_u32 s55, s55, 7168
v_cmp_gt_u32 vcc, 32, v0
v_mov_b32 v10, 0x40000000
s_nop 0
v_cndmask_b32 v10, v10, v3, vcc
buffer_load_dwordx4 v10, s[12:15], s55 offen  lds
s_mul_i32 s54, s100, 4
s_add_u32 s54, s54, s99
s_add_u32 s54, s54, 3
s_and_b32 s54, s54, 15
s_mul_i32 s55, s54, 25088
s_add_u32 s55, s55, s71
s_add_u32 m0, s74, 98304
s_nop 0
buffer_load_dwordx4 v3, s[12:15], s55 offen  lds
s_add_u32 m0, s74, 99328
s_add_u32 s55, s55, 7168
buffer_load_dwordx4 v3, s[12:15], s55 offen  lds
s_add_u32 m0, s74, 100352
s_add_u32 s55, s55, 7168
buffer_load_dwordx4 v3, s[12:15], s55 offen  lds
s_add_u32 m0, s74, 101376
s_add_u32 s55, s55, 7168
v_cmp_gt_u32 vcc, 32, v0
v_mov_b32 v10, 0x40000000
s_nop 0
v_cndmask_b32 v10, v10, v3, vcc
buffer_load_dwordx4 v10, s[12:15], s55 offen  lds
s_waitcnt vmcnt(0)
s_barrier
v_lshrrev_b32 v3, 3, v0
v_and_b32 v4, 7, v0
v_lshlrev_b32 v4, 1, v4
v_xor_b32 v4, v4, v3
v_lshlrev_b32 v4, 4, v4
v_lshl_add_u32 v4, v3, 8, v4
s_lshr_b32 s54, s44, 1
s_lshl_b32 s54, s54, 14
s_and_b32 s55, s44, 1
s_lshl_b32 s55, s55, 11
s_add_u32 s54, s54, s55
v_add_u32 v1, s54, v4
v_xor_b32 v2, 16, v1
s_barrier
ds_read_b128 v[8:11], v1 offset:0
ds_read_b128 v[12:15], v2 offset:0
ds_read_b128 v[16:19], v1 offset:4096
ds_read_b128 v[20:23], v2 offset:4096
ds_read_b128 v[24:27], v1 offset:8192
ds_read_b128 v[28:31], v2 offset:8192
ds_read_b128 v[32:35], v1 offset:12288
ds_read_b128 v[36:39], v2 offset:12288
v_lshlrev_b32 v40, 16, v60
v_and_b32 v41, 0xffff0000, v60
v_lshlrev_b32 v42, 16, v61
v_and_b32 v43, 0xffff0000, v61
v_lshlrev_b32 v44, 16, v62
v_and_b32 v45, 0xffff0000, v62
v_lshlrev_b32 v46, 16, v63
v_and_b32 v47, 0xffff0000, v63
s_waitcnt lgkmcnt(6)
v_add_f32 v40, v40, v8
v_add_f32 v41, v41, v9
v_add_f32 v42, v42, v10
v_add_f32 v43, v43, v11
v_add_f32 v44, v44, v12
v_add_f32 v45, v45, v13
v_add_f32 v46, v46, v14
v_add_f32 v47, v47, v15
s_waitcnt lgkmcnt(4)
v_add_f32 v40, v40, v16
v_add_f32 v41, v41, v17
v_add_f32 v42, v42, v18
v_add_f32 v43, v43, v19
v_add_f32 v44, v44, v20
v_add_f32 v45, v45, v21
v_add_f32 v46, v46, v22
v_add_f32 v47, v47, v23
s_waitcnt lgkmcnt(2)
v_add_f32 v40, v40, v24
v_add_f32 v41, v41, v25
v_add_f32 v42, v42, v26
v_add_f32 v43, v43, v27
v_add_f32 v44, v44, v28
v_add_f32 v45, v45, v29
v_add_f32 v46, v46, v30
v_add_f32 v47, v47, v31
s_waitcnt lgkmcnt(0)
v_add_f32 v40, v40, v32
v_add_f32 v41, v41, v33
v_add_f32 v42, v42, v34
v_add_f32 v43, v43, v35
v_add_f32 v44, v44, v36
v_add_f32 v45, v45, v37
v_add_f32 v46, v46, v38
v_add_f32 v47, v47, v39
v_cvt_pk_bf16_f32 v48, v40, v41
v_cvt_pk_bf16_f32 v49, v42, v43
v_cvt_pk_bf16_f32 v50, v44, v45
v_cvt_pk_bf16_f32 v51, v46, v47
buffer_store_dwordx4 v[48:51], v7, s[28:31], s59 offen
s_endpgm
.p2align 3
L_CA:
s_lshl_b32 s54, s44, 10
s_add_u32 s54, s54, 32768
v_add_u32 v241, s54, v3
s_waitcnt lgkmcnt(4)
v_mfma_f32_32x32x16_bf16 v[96:111], v[128:131], v[16:19], 0
ds_read_b64_tr_b16 v[8:9], v1 offset:45056
ds_read_b64_tr_b16 v[10:11], v1 offset:45568
v_mfma_f32_32x32x16_bf16 v[112:127], v[128:131], v[20:23], 0
ds_read_b64_tr_b16 v[12:13], v2 offset:45056
ds_read_b64_tr_b16 v[14:15], v2 offset:45568
s_waitcnt lgkmcnt(4)
v_mfma_f32_32x32x16_bf16 v[96:111], v[132:135], v[24:27], v[96:111]
ds_read_b64_tr_b16 v[16:17], v1 offset:47104
ds_read_b64_tr_b16 v[18:19], v1 offset:47616
v_mul_f32 v244, s68, v64
v_mul_f32 v245, s68, v65
v_exp_f32_e64 v244, v244 clamp
v_mfma_f32_32x32x16_bf16 v[112:127], v[132:135], v[28:31], v[112:127]
ds_read_b64_tr_b16 v[20:21], v2 offset:47104
ds_read_b64_tr_b16 v[22:23], v2 offset:47616
v_exp_f32_e64 v245, v245 clamp
v_max_f32 v64, 0x358637bd, v64
s_waitcnt lgkmcnt(4)
v_mfma_f32_32x32x16_bf16 v[96:111], v[136:139], v[8:11], v[96:111]
ds_read_b64_tr_b16 v[24:25], v1 offset:49152
ds_read_b64_tr_b16 v[26:27], v1 offset:49664
v_max_f32 v65, 0x358637bd, v65
v_add_f32 v64, v64, v244
v_add_f32 v65, v65, v245
v_mul_f32 v246, s68, v66
v_mfma_f32_32x32x16_bf16 v[112:127], v[136:139], v[12:15], v[112:127]
ds_read_b64_tr_b16 v[28:29], v2 offset:49152
ds_read_b64_tr_b16 v[30:31], v2 offset:49664
v_mul_f32 v247, s68, v67
v_exp_f32_e64 v246, v246 clamp
s_waitcnt lgkmcnt(4)
v_mfma_f32_32x32x16_bf16 v[96:111], v[140:143], v[16:19], v[96:111]
ds_read_b64_tr_b16 v[8:9], v1 offset:51200
ds_read_b64_tr_b16 v[10:11], v1 offset:51712
v_exp_f32_e64 v247, v247 clamp
v_max_f32 v66, 0x358637bd, v66
v_max_f32 v67, 0x358637bd, v67
v_mfma_f32_32x32x16_bf16 v[112:127], v[140:143], v[20:23], v[112:127]
ds_read_b64_tr_b16 v[12:13], v2 offset:51200
ds_read_b64_tr_b16 v[14:15], v2 offset:51712
v_add_f32 v66, v66, v246
v_add_f32 v67, v67, v247
v_mul_f32 v244, s68, v68
s_waitcnt lgkmcnt(4)
v_mfma_f32_32x32x16_bf16 v[96:111], v[144:147], v[24:27], v[96:111]
ds_read_b64_tr_b16 v[16:17], v1 offset:53248
ds_read_b64_tr_b16 v[18:19], v1 offset:53760
v_mul_f32 v245, s68, v69
v_exp_f32_e64 v244, v244 clamp
v_exp_f32_e64 v245, v245 clamp
v_mfma_f32_32x32x16_bf16 v[112:127], v[144:147], v[28:31], v[112:127]
ds_read_b64_tr_b16 v[20:21], v2 offset:53248
ds_read_b64_tr_b16 v[22:23], v2 offset:53760
v_max_f32 v68, 0x358637bd, v68
v_max_f32 v69, 0x358637bd, v69
s_waitcnt lgkmcnt(4)
v_mfma_f32_32x32x16_bf16 v[96:111], v[148:151], v[8:11], v[96:111]
ds_read_b64_tr_b16 v[24:25], v1 offset:55296
ds_read_b64_tr_b16 v[26:27], v1 offset:55808
v_add_f32 v68, v68, v244
v_add_f32 v69, v69, v245
v_mul_f32 v246, s68, v70
v_mul_f32 v247, s68, v71
v_mfma_f32_32x32x16_bf16 v[112:127], v[148:151], v[12:15], v[112:127]
ds_read_b64_tr_b16 v[28:29], v2 offset:55296
ds_read_b64_tr_b16 v[30:31], v2 offset:55808
v_exp_f32_e64 v246, v246 clamp
v_exp_f32_e64 v247, v247 clamp
s_waitcnt lgkmcnt(4)
v_mfma_f32_32x32x16_bf16 v[96:111], v[152:155], v[16:19], v[96:111]
ds_read_b64_tr_b16 v[8:9], v1 offset:57344
ds_read_b64_tr_b16 v[10:11], v1 offset:57856
v_max_f32 v70, 0x358637bd, v70
v_max_f32 v71, 0x358637bd, v71
v_add_f32 v70, v70, v246
v_mfma_f32_32x32x16_bf16 v[112:127], v[152:155], v[20:23], v[112:127]
ds_read_b64_tr_b16 v[12:13], v2 offset:57344
ds_read_b64_tr_b16 v[14:15], v2 offset:57856
v_add_f32 v71, v71, v247
v_cvt_pk_bf16_f32 v64, v64, v65
v_cvt_pk_bf16_f32 v65, v66, v67
s_waitcnt lgkmcnt(4)
v_mfma_f32_32x32x16_bf16 v[96:111], v[156:159], v[24:27], v[96:111]
ds_read_b64_tr_b16 v[16:17], v1 offset:59392
ds_read_b64_tr_b16 v[18:19], v1 offset:59904
v_cvt_pk_bf16_f32 v66, v68, v69
v_cvt_pk_bf16_f32 v67, v70, v71
v_mul_f32 v244, s68, v72
v_mul_f32 v245, s68, v73
v_mfma_f32_32x32x16_bf16 v[112:127], v[156:159], v[28:31], v[112:127]
ds_read_b64_tr_b16 v[20:21], v2 offset:59392
ds_read_b64_tr_b16 v[22:23], v2 offset:59904
v_exp_f32_e64 v244, v244 clamp
v_exp_f32_e64 v245, v245 clamp
s_waitcnt lgkmcnt(4)
v_mfma_f32_32x32x16_bf16 v[96:111], v[160:163], v[8:11], v[96:111]
ds_read_b64_tr_b16 v[24:25], v1 offset:61440
ds_read_b64_tr_b16 v[26:27], v1 offset:61952
v_max_f32 v72, 0x358637bd, v72
v_max_f32 v73, 0x358637bd, v73
v_add_f32 v72, v72, v244
v_mfma_f32_32x32x16_bf16 v[112:127], v[160:163], v[12:15], v[112:127]
ds_read_b64_tr_b16 v[28:29], v2 offset:61440
ds_read_b64_tr_b16 v[30:31], v2 offset:61952
v_add_f32 v73, v73, v245
v_mul_f32 v246, s68, v74
v_mul_f32 v247, s68, v75
s_waitcnt lgkmcnt(4)
v_mfma_f32_32x32x16_bf16 v[96:111], v[164:167], v[16:19], v[96:111]
ds_read_b64_tr_b16 v[8:9], v1 offset:63488
ds_read_b64_tr_b16 v[10:11], v1 offset:64000
v_exp_f32_e64 v246, v246 clamp
v_exp_f32_e64 v247, v247 clamp
v_mfma_f32_32x32x16_bf16 v[112:127], v[164:167], v[20:23], v[112:127]
ds_read_b64_tr_b16 v[12:13], v2 offset:63488
ds_read_b64_tr_b16 v[14:15], v2 offset:64000
v_max_f32 v74, 0x358637bd, v74
v_max_f32 v75, 0x358637bd, v75
v_add_f32 v74, v74, v246
s_barrier
s_waitcnt lgkmcnt(4)
v_mfma_f32_32x32x16_bf16 v[96:111], v[168:171], v[24:27], v[96:111]
v_add_u32 v1, 0x00010000, v1
v_add_u32 v6, 0x00010000, v6
v_add_u32 v2, 0x00010000, v2
ds_read_b64_tr_b16 v[16:17], v1 offset:0
ds_read_b64_tr_b16 v[18:19], v1 offset:512
v_add_f32 v75, v75, v247
v_mul_f32 v244, s68, v76
v_mul_f32 v245, s68, v77
v_exp_f32_e64 v244, v244 clamp
v_mfma_f32_32x32x16_bf16 v[112:127], v[168:171], v[28:31], v[112:127]
ds_read_b64_tr_b16 v[20:21], v2 offset:0
ds_read_b64_tr_b16 v[22:23], v2 offset:512
v_exp_f32_e64 v245, v245 clamp
s_waitcnt lgkmcnt(4)
v_mfma_f32_32x32x16_bf16 v[96:111], v[172:175], v[8:11], v[96:111]
ds_read_b64_tr_b16 v[24:25], v1 offset:2048
ds_read_b64_tr_b16 v[26:27], v1 offset:2560
v_max_f32 v76, 0x358637bd, v76
v_max_f32 v77, 0x358637bd, v77
v_add_f32 v76, v76, v244
v_add_f32 v77, v77, v245
v_mfma_f32_32x32x16_bf16 v[112:127], v[172:175], v[12:15], v[112:127]
ds_read_b64_tr_b16 v[28:29], v2 offset:2048
ds_read_b64_tr_b16 v[30:31], v2 offset:2560
v_mul_f32 v246, s68, v78
v_mul_f32 v247, s68, v79
v_exp_f32_e64 v246, v246 clamp
s_waitcnt lgkmcnt(4)
v_mfma_f32_32x32x16_bf16 v[96:111], v[176:179], v[16:19], v[96:111]
ds_read_b64_tr_b16 v[8:9], v1 offset:4096
ds_read_b64_tr_b16 v[10:11], v1 offset:4608
v_exp_f32_e64 v247, v247 clamp
v_max_f32 v78, 0x358637bd, v78
v_mfma_f32_32x32x16_bf16 v[112:127], v[176:179], v[20:23], v[112:127]
ds_read_b64_tr_b16 v[12:13], v2 offset:4096
ds_read_b64_tr_b16 v[14:15], v2 offset:4608
v_max_f32 v79, 0x358637bd, v79
v_add_f32 v78, v78, v246
v_add_f32 v79, v79, v247
s_waitcnt lgkmcnt(4)
v_mfma_f32_32x32x16_bf16 v[96:111], v[180:183], v[24:27], v[96:111]
ds_read_b64_tr_b16 v[16:17], v1 offset:6144
ds_read_b64_tr_b16 v[18:19], v1 offset:6656
v_cvt_pk_bf16_f32 v68, v72, v73
v_cvt_pk_bf16_f32 v69, v74, v75
v_cvt_pk_bf16_f32 v70, v76, v77
v_cvt_pk_bf16_f32 v71, v78, v79
v_mfma_f32_32x32x16_bf16 v[112:127], v[180:183], v[28:31], v[112:127]
ds_read_b64_tr_b16 v[20:21], v2 offset:6144
ds_read_b64_tr_b16 v[22:23], v2 offset:6656
v_cndmask_b32 v70, v70, 0, s[64:65]
v_cndmask_b32 v71, v71, 0, s[64:65]
v_mul_f32 v244, s68, v80
s_waitcnt lgkmcnt(4)
v_mfma_f32_32x32x16_bf16 v[96:111], v[184:187], v[8:11], v[96:111]
ds_read_b64_tr_b16 v[24:25], v1 offset:8192
ds_read_b64_tr_b16 v[26:27], v1 offset:8704
v_mul_f32 v245, s68, v81
v_exp_f32_e64 v244, v244 clamp
v_exp_f32_e64 v245, v245 clamp
v_mfma_f32_32x32x16_bf16 v[112:127], v[184:187], v[12:15], v[112:127]
ds_read_b64_tr_b16 v[28:29], v2 offset:8192
ds_read_b64_tr_b16 v[30:31], v2 offset:8704
v_max_f32 v80, 0x358637bd, v80
v_max_f32 v81, 0x358637bd, v81
s_waitcnt lgkmcnt(4)
v_mfma_f32_32x32x16_bf16 v[96:111], v[188:191], v[16:19], v[96:111]
ds_read_b64_tr_b16 v[8:9], v1 offset:10240
ds_read_b64_tr_b16 v[10:11], v1 offset:10752
v_add_f32 v80, v80, v244
v_add_f32 v81, v81, v245
v_mul_f32 v246, s68, v82
v_mul_f32 v247, s68, v83
v_mfma_f32_32x32x16_bf16 v[112:127], v[188:191], v[20:23], v[112:127]
ds_read_b64_tr_b16 v[12:13], v2 offset:10240
ds_read_b64_tr_b16 v[14:15], v2 offset:10752
v_exp_f32_e64 v246, v246 clamp
v_exp_f32_e64 v247, v247 clamp
s_waitcnt lgkmcnt(4)
v_mfma_f32_32x32x16_bf16 v[96:111], v[192:195], v[24:27], v[96:111]
ds_read_b64_tr_b16 v[16:17], v1 offset:12288
ds_read_b64_tr_b16 v[18:19], v1 offset:12800
v_max_f32 v82, 0x358637bd, v82
v_max_f32 v83, 0x358637bd, v83
v_add_f32 v82, v82, v246
v_mfma_f32_32x32x16_bf16 v[112:127], v[192:195], v[28:31], v[112:127]
ds_read_b64_tr_b16 v[20:21], v2 offset:12288
ds_read_b64_tr_b16 v[22:23], v2 offset:12800
v_add_f32 v83, v83, v247
v_mul_f32 v244, s68, v84
v_mul_f32 v245, s68, v85
s_waitcnt lgkmcnt(4)
v_mfma_f32_32x32x16_bf16 v[96:111], v[196:199], v[8:11], v[96:111]
ds_read_b64_tr_b16 v[24:25], v1 offset:14336
ds_read_b64_tr_b16 v[26:27], v1 offset:14848
v_exp_f32_e64 v244, v244 clamp
v_exp_f32_e64 v245, v245 clamp
v_mfma_f32_32x32x16_bf16 v[112:127], v[196:199], v[12:15], v[112:127]
ds_read_b64_tr_b16 v[28:29], v2 offset:14336
ds_read_b64_tr_b16 v[30:31], v2 offset:14848
v_max_f32 v84, 0x358637bd, v84
v_max_f32 v85, 0x358637bd, v85
v_add_f32 v84, v84, v244
s_waitcnt lgkmcnt(4)
v_mfma_f32_32x32x16_bf16 v[96:111], v[200:203], v[16:19], v[96:111]
ds_read_b64_tr_b16 v[8:9], v1 offset:16384
ds_read_b64_tr_b16 v[10:11], v1 offset:16896
v_add_f32 v85, v85, v245
v_mul_f32 v246, s68, v86
v_mul_f32 v247, s68, v87
v_exp_f32_e64 v246, v246 clamp
v_mfma_f32_32x32x16_bf16 v[112:127], v[200:203], v[20:23], v[112:127]
ds_read_b64_tr_b16 v[12:13], v2 offset:16384
ds_read_b64_tr_b16 v[14:15], v2 offset:16896
v_exp_f32_e64 v247, v247 clamp
s_waitcnt lgkmcnt(4)
v_mfma_f32_32x32x16_bf16 v[96:111], v[204:207], v[24:27], v[96:111]
ds_read_b64_tr_b16 v[16:17], v1 offset:18432
ds_read_b64_tr_b16 v[18:19], v1 offset:18944
v_max_f32 v86, 0x358637bd, v86
v_max_f32 v87, 0x358637bd, v87
v_add_f32 v86, v86, v246
v_add_f32 v87, v87, v247
v_mfma_f32_32x32x16_bf16 v[112:127], v[204:207], v[28:31], v[112:127]
ds_read_b64_tr_b16 v[20:21], v2 offset:18432
ds_read_b64_tr_b16 v[22:23], v2 offset:18944
v_cvt_pk_bf16_f32 v72, v80, v81
v_cvt_pk_bf16_f32 v73, v82, v83
v_cvt_pk_bf16_f32 v74, v84, v85
s_waitcnt lgkmcnt(4)
v_mfma_f32_32x32x16_bf16 v[96:111], v[208:211], v[8:11], v[96:111]
ds_read_b64_tr_b16 v[24:25], v1 offset:20480
ds_read_b64_tr_b16 v[26:27], v1 offset:20992
v_cvt_pk_bf16_f32 v75, v86, v87
v_mul_f32 v244, s68, v88
v_mul_f32 v245, s68, v89
v_exp_f32_e64 v244, v244 clamp
v_mfma_f32_32x32x16_bf16 v[112:127], v[208:211], v[12:15], v[112:127]
ds_read_b64_tr_b16 v[28:29], v2 offset:20480
ds_read_b64_tr_b16 v[30:31], v2 offset:20992
v_exp_f32_e64 v245, v245 clamp
s_waitcnt lgkmcnt(4)
v_mfma_f32_32x32x16_bf16 v[96:111], v[212:215], v[16:19], v[96:111]
ds_read_b64_tr_b16 v[8:9], v1 offset:22528
ds_read_b64_tr_b16 v[10:11], v1 offset:23040
v_max_f32 v88, 0x358637bd, v88
v_max_f32 v89, 0x358637bd, v89
v_add_f32 v88, v88, v244
v_add_f32 v89, v89, v245
v_mfma_f32_32x32x16_bf16 v[112:127], v[212:215], v[20:23], v[112:127]
ds_read_b64_tr_b16 v[12:13], v2 offset:22528
ds_read_b64_tr_b16 v[14:15], v2 offset:23040
v_mul_f32 v246, s68, v90
v_mul_f32 v247, s68, v91
v_exp_f32_e64 v246, v246 clamp
s_barrier
s_waitcnt lgkmcnt(4)
v_mfma_f32_32x32x16_bf16 v[96:111], v[216:219], v[24:27], v[96:111]
ds_read_b64_tr_b16 v[16:17], v1 offset:24576
ds_read_b64_tr_b16 v[18:19], v1 offset:25088
v_exp_f32_e64 v247, v247 clamp
v_max_f32 v90, 0x358637bd, v90
v_mfma_f32_32x32x16_bf16 v[112:127], v[216:219], v[28:31], v[112:127]
ds_read_b64_tr_b16 v[20:21], v2 offset:24576
ds_read_b64_tr_b16 v[22:23], v2 offset:25088
v_max_f32 v91, 0x358637bd, v91
v_add_f32 v90, v90, v246
v_add_f32 v91, v91, v247
s_waitcnt lgkmcnt(4)
v_mfma_f32_32x32x16_bf16 v[96:111], v[220:223], v[8:11], v[96:111]
ds_read_b64_tr_b16 v[24:25], v1 offset:26624
ds_read_b64_tr_b16 v[26:27], v1 offset:27136
v_mul_f32 v244, s68, v92
v_mul_f32 v245, s68, v93
v_exp_f32_e64 v244, v244 clamp
v_mfma_f32_32x32x16_bf16 v[112:127], v[220:223], v[12:15], v[112:127]
ds_read_b64_tr_b16 v[28:29], v2 offset:26624
ds_read_b64_tr_b16 v[30:31], v2 offset:27136
v_exp_f32_e64 v245, v245 clamp
v_max_f32 v92, 0x358637bd, v92
s_waitcnt lgkmcnt(4)
v_mfma_f32_32x32x16_bf16 v[96:111], v[224:227], v[16:19], v[96:111]
ds_read_b64_tr_b16 v[8:9], v1 offset:28672
ds_read_b64_tr_b16 v[10:11], v1 offset:29184
v_max_f32 v93, 0x358637bd, v93
v_add_f32 v92, v92, v244
v_add_f32 v93, v93, v245
v_mul_f32 v246, s68, v94
v_mfma_f32_32x32x16_bf16 v[112:127], v[224:227], v[20:23], v[112:127]
ds_read_b64_tr_b16 v[12:13], v2 offset:28672
ds_read_b64_tr_b16 v[14:15], v2 offset:29184
v_mul_f32 v247, s68, v95
v_exp_f32_e64 v246, v246 clamp
s_waitcnt lgkmcnt(4)
v_mfma_f32_32x32x16_bf16 v[96:111], v[228:231], v[24:27], v[96:111]
ds_read_b64_tr_b16 v[16:17], v1 offset:30720
ds_read_b64_tr_b16 v[18:19], v1 offset:31232
v_exp_f32_e64 v247, v247 clamp
v_max_f32 v94, 0x358637bd, v94
v_max_f32 v95, 0x358637bd, v95
v_mfma_f32_32x32x16_bf16 v[112:127], v[228:231], v[28:31], v[112:127]
ds_read_b64_tr_b16 v[20:21], v2 offset:30720
ds_read_b64_tr_b16 v[22:23], v2 offset:31232
v_add_f32 v94, v94, v246
v_add_f32 v95, v95, v247
v_cvt_pk_bf16_f32 v76, v88, v89
s_waitcnt lgkmcnt(4)
v_mfma_f32_32x32x16_bf16 v[96:111], v[232:235], v[8:11], v[96:111]
v_add_u32 v1, 0xfffe0000, v1
v_add_u32 v6, 0xfffe0000, v6
ds_read_b64_tr_b16 v[24:25], v1 offset:49152
ds_read_b64_tr_b16 v[26:27], v1 offset:49664
v_cvt_pk_bf16_f32 v77, v90, v91
v_cvt_pk_bf16_f32 v78, v92, v93
v_cvt_pk_bf16_f32 v79, v94, v95
v_cndmask_b32 v78, v78, 0, s[64:65]
v_mfma_f32_32x32x16_bf16 v[112:127], v[232:235], v[12:15], v[112:127]
ds_read_b64_tr_b16 v[28:29], v6 offset:49152
ds_read_b64_tr_b16 v[30:31], v6 offset:49664
v_cndmask_b32 v79, v79, 0, s[64:65]
s_waitcnt lgkmcnt(4)
v_mfma_f32_32x32x16_bf16 v[96:111], v[236:239], v[16:19], v[96:111]
ds_read_b64_tr_b16 v[8:9], v1 offset:51200
ds_read_b64_tr_b16 v[10:11], v1 offset:51712
v_mfma_f32_32x32x16_bf16 v[112:127], v[236:239], v[20:23], v[112:127]
ds_read_b64_tr_b16 v[12:13], v6 offset:51200
ds_read_b64_tr_b16 v[14:15], v6 offset:51712
s_waitcnt lgkmcnt(4)
v_mfma_f32_32x32x16_bf16 v[32:47], v[24:27], v[128:131], 0
ds_read_b64_tr_b16 v[16:17], v1 offset:53248
ds_read_b64_tr_b16 v[18:19], v1 offset:53760
v_mfma_f32_32x32x16_bf16 v[48:63], v[28:31], v[128:131], 0
ds_read_b64_tr_b16 v[20:21], v6 offset:53248
ds_read_b64_tr_b16 v[22:23], v6 offset:53760
s_waitcnt lgkmcnt(4)
v_mfma_f32_32x32x16_bf16 v[32:47], v[8:11], v[132:135], v[32:47]
ds_read_b64_tr_b16 v[24:25], v1 offset:55296
ds_read_b64_tr_b16 v[26:27], v1 offset:55808
v_cvt_pk_bf16_f32 v112, v112, v113
v_cvt_pk_bf16_f32 v113, v114, v115
v_cndmask_b32 v112, v112, v243, s[62:63]
v_cvt_pk_bf16_f32 v114, v116, v117
v_cndmask_b32 v113, v113, v243, s[62:63]
v_cvt_pk_bf16_f32 v115, v118, v119
v_mfma_f32_32x32x16_bf16 v[48:63], v[12:15], v[132:135], v[48:63]
ds_read_b64_tr_b16 v[28:29], v6 offset:55296
ds_read_b64_tr_b16 v[30:31], v6 offset:55808
v_cndmask_b32 v114, v114, v243, s[62:63]
v_cvt_pk_bf16_f32 v116, v120, v121
v_cndmask_b32 v115, v115, v243, s[62:63]
v_cvt_pk_bf16_f32 v117, v122, v123
v_cndmask_b32 v116, v116, v243, s[62:63]
s_waitcnt lgkmcnt(4)
v_mfma_f32_32x32x16_bf16 v[32:47], v[16:19], v[136:139], v[32:47]
ds_read_b64_tr_b16 v[8:9], v1 offset:57344
ds_read_b64_tr_b16 v[10:11], v1 offset:57856
v_cvt_pk_bf16_f32 v118, v124, v125
v_cndmask_b32 v117, v117, v243, s[62:63]
v_cvt_pk_bf16_f32 v119, v126, v127
v_cndmask_b32 v118, v118, v243, s[62:63]
v_cndmask_b32 v119, v119, v243, s[62:63]
v_mul_f32 v244, s68, v96
v_mfma_f32_32x32x16_bf16 v[48:63], v[20:23], v[136:139], v[48:63]
ds_read_b64_tr_b16 v[12:13], v6 offset:57344
ds_read_b64_tr_b16 v[14:15], v6 offset:57856
v_mul_f32 v245, s68, v97
v_exp_f32_e64 v244, v244 clamp
v_exp_f32_e64 v245, v245 clamp
s_waitcnt lgkmcnt(4)
v_mfma_f32_32x32x16_bf16 v[32:47], v[24:27], v[140:143], v[32:47]
ds_read_b64_tr_b16 v[16:17], v1 offset:59392
ds_read_b64_tr_b16 v[18:19], v1 offset:59904
v_max_f32 v96, 0x358637bd, v96
v_max_f32 v97, 0x358637bd, v97
v_add_f32 v96, v96, v244
v_add_f32 v97, v97, v245
v_mul_f32 v246, s68, v98
v_mul_f32 v247, s68, v99
v_mfma_f32_32x32x16_bf16 v[48:63], v[28:31], v[140:143], v[48:63]
ds_read_b64_tr_b16 v[20:21], v6 offset:59392
ds_read_b64_tr_b16 v[22:23], v6 offset:59904
v_exp_f32_e64 v246, v246 clamp
v_exp_f32_e64 v247, v247 clamp
v_max_f32 v98, 0x358637bd, v98
s_waitcnt lgkmcnt(4)
v_mfma_f32_32x32x16_bf16 v[32:47], v[8:11], v[144:147], v[32:47]
ds_read_b64_tr_b16 v[24:25], v1 offset:61440
ds_read_b64_tr_b16 v[26:27], v1 offset:61952
v_max_f32 v99, 0x358637bd, v99
v_add_f32 v98, v98, v246
v_add_f32 v99, v99, v247
v_mul_f32 v244, s68, v100
v_mul_f32 v245, s68, v101
v_exp_f32_e64 v244, v244 clamp
v_mfma_f32_32x32x16_bf16 v[48:63], v[12:15], v[144:147], v[48:63]
ds_read_b64_tr_b16 v[28:29], v6 offset:61440
ds_read_b64_tr_b16 v[30:31], v6 offset:61952
v_exp_f32_e64 v245, v245 clamp
v_max_f32 v100, 0x358637bd, v100
v_max_f32 v101, 0x358637bd, v101
s_waitcnt lgkmcnt(4)
v_mfma_f32_32x32x16_bf16 v[32:47], v[16:19], v[148:151], v[32:47]
ds_read_b64_tr_b16 v[8:9], v1 offset:63488
ds_read_b64_tr_b16 v[10:11], v1 offset:64000
v_add_f32 v100, v100, v244
v_add_f32 v101, v101, v245
v_mul_f32 v246, s68, v102
v_mul_f32 v247, s68, v103
v_exp_f32_e64 v246, v246 clamp
v_mfma_f32_32x32x16_bf16 v[48:63], v[20:23], v[148:151], v[48:63]
ds_read_b64_tr_b16 v[12:13], v6 offset:63488
ds_read_b64_tr_b16 v[14:15], v6 offset:64000
v_exp_f32_e64 v247, v247 clamp
v_max_f32 v102, 0x358637bd, v102
v_max_f32 v103, 0x358637bd, v103
v_add_f32 v102, v102, v246
s_waitcnt lgkmcnt(4)
v_mfma_f32_32x32x16_bf16 v[32:47], v[24:27], v[152:155], v[32:47]
v_add_u32 v1, 0x00010000, v1
v_add_u32 v6, 0x00010000, v6
ds_read_b64_tr_b16 v[16:17], v1 offset:0
ds_read_b64_tr_b16 v[18:19], v1 offset:512
v_add_f32 v103, v103, v247
v_cvt_pk_bf16_f32 v120, v96, v97
v_cvt_pk_bf16_f32 v121, v98, v99
v_cvt_pk_bf16_f32 v122, v100, v101
v_cvt_pk_bf16_f32 v123, v102, v103
v_mul_f32 v244, s68, v104
v_mfma_f32_32x32x16_bf16 v[48:63], v[28:31], v[152:155], v[48:63]
ds_read_b64_tr_b16 v[20:21], v6 offset:0
ds_read_b64_tr_b16 v[22:23], v6 offset:512
v_mul_f32 v245, s68, v105
v_exp_f32_e64 v244, v244 clamp
v_exp_f32_e64 v245, v245 clamp
s_waitcnt lgkmcnt(4)
v_mfma_f32_32x32x16_bf16 v[32:47], v[8:11], v[156:159], v[32:47]
ds_read_b64_tr_b16 v[24:25], v1 offset:2048
ds_read_b64_tr_b16 v[26:27], v1 offset:2560
v_max_f32 v104, 0x358637bd, v104
v_max_f32 v105, 0x358637bd, v105
v_add_f32 v104, v104, v244
v_add_f32 v105, v105, v245
v_mul_f32 v246, s68, v106
v_mul_f32 v247, s68, v107
v_mfma_f32_32x32x16_bf16 v[48:63], v[12:15], v[156:159], v[48:63]
ds_read_b64_tr_b16 v[28:29], v6 offset:2048
ds_read_b64_tr_b16 v[30:31], v6 offset:2560
v_exp_f32_e64 v246, v246 clamp
v_exp_f32_e64 v247, v247 clamp
v_max_f32 v106, 0x358637bd, v106
s_waitcnt lgkmcnt(4)
v_mfma_f32_32x32x16_bf16 v[32:47], v[16:19], v[160:163], v[32:47]
ds_read_b64_tr_b16 v[8:9], v1 offset:4096
ds_read_b64_tr_b16 v[10:11], v1 offset:4608
v_max_f32 v107, 0x358637bd, v107
v_add_f32 v106, v106, v246
v_add_f32 v107, v107, v247
v_mul_f32 v244, s68, v108
v_mul_f32 v245, s68, v109
v_exp_f32_e64 v244, v244 clamp
v_mfma_f32_32x32x16_bf16 v[48:63], v[20:23], v[160:163], v[48:63]
ds_read_b64_tr_b16 v[12:13], v6 offset:4096
ds_read_b64_tr_b16 v[14:15], v6 offset:4608
v_exp_f32_e64 v245, v245 clamp
v_max_f32 v108, 0x358637bd, v108
v_max_f32 v109, 0x358637bd, v109
s_waitcnt lgkmcnt(4)
v_mfma_f32_32x32x16_bf16 v[32:47], v[24:27], v[164:167], v[32:47]
ds_read_b64_tr_b16 v[16:17], v1 offset:6144
ds_read_b64_tr_b16 v[18:19], v1 offset:6656
v_add_f32 v108, v108, v244
v_add_f32 v109, v109, v245
v_mul_f32 v246, s68, v110
v_mul_f32 v247, s68, v111
v_exp_f32_e64 v246, v246 clamp
v_mfma_f32_32x32x16_bf16 v[48:63], v[28:31], v[164:167], v[48:63]
ds_read_b64_tr_b16 v[20:21], v6 offset:6144
ds_read_b64_tr_b16 v[22:23], v6 offset:6656
v_exp_f32_e64 v247, v247 clamp
v_max_f32 v110, 0x358637bd, v110
v_max_f32 v111, 0x358637bd, v111
v_add_f32 v110, v110, v246
s_barrier
s_waitcnt lgkmcnt(4)
v_mfma_f32_32x32x16_bf16 v[32:47], v[8:11], v[168:171], v[32:47]
ds_read_b64_tr_b16 v[24:25], v1 offset:8192
ds_read_b64_tr_b16 v[26:27], v1 offset:8704
v_add_f32 v111, v111, v247
v_cvt_pk_bf16_f32 v124, v104, v105
v_cvt_pk_bf16_f32 v125, v106, v107
v_cvt_pk_bf16_f32 v126, v108, v109
v_cvt_pk_bf16_f32 v127, v110, v111
s_nop 1
v_mfma_f32_32x32x16_bf16 v[48:63], v[12:15], v[168:171], v[48:63]
ds_read_b64_tr_b16 v[28:29], v6 offset:8192
ds_read_b64_tr_b16 v[30:31], v6 offset:8704
v_mfma_f32_32x32x16_bf16 v[96:111], v[120:123], v[112:115], 0
s_waitcnt lgkmcnt(4)
v_mfma_f32_32x32x16_bf16 v[32:47], v[16:19], v[172:175], v[32:47]
ds_read_b64_tr_b16 v[8:9], v1 offset:10240
ds_read_b64_tr_b16 v[10:11], v1 offset:10752
v_mfma_f32_32x32x16_bf16 v[48:63], v[20:23], v[172:175], v[48:63]
ds_read_b64_tr_b16 v[12:13], v6 offset:10240
ds_read_b64_tr_b16 v[14:15], v6 offset:10752
v_mfma_f32_32x32x16_bf16 v[96:111], v[124:127], v[116:119], v[96:111]
s_waitcnt lgkmcnt(4)
v_mfma_f32_32x32x16_bf16 v[32:47], v[24:27], v[176:179], v[32:47]
ds_read_b64_tr_b16 v[16:17], v1 offset:12288
ds_read_b64_tr_b16 v[18:19], v1 offset:12800
v_mfma_f32_32x32x16_bf16 v[48:63], v[28:31], v[176:179], v[48:63]
ds_read_b64_tr_b16 v[20:21], v6 offset:12288
ds_read_b64_tr_b16 v[22:23], v6 offset:12800
s_nop 4
ds_write_b128 v241, v[96:99] offset:0
s_waitcnt lgkmcnt(5)
v_mfma_f32_32x32x16_bf16 v[32:47], v[8:11], v[180:183], v[32:47]
ds_read_b64_tr_b16 v[24:25], v1 offset:14336
ds_read_b64_tr_b16 v[26:27], v1 offset:14848
ds_write_b128 v241, v[100:103] offset:4096
v_mfma_f32_32x32x16_bf16 v[48:63], v[12:15], v[180:183], v[48:63]
ds_read_b64_tr_b16 v[28:29], v6 offset:14336
ds_read_b64_tr_b16 v[30:31], v6 offset:14848
ds_write_b128 v241, v[104:107] offset:8192
ds_write_b128 v241, v[108:111] offset:12288
s_waitcnt lgkmcnt(8)
v_mfma_f32_32x32x16_bf16 v[32:47], v[16:19], v[184:187], v[32:47]
ds_read_b64_tr_b16 v[8:9], v1 offset:16384
ds_read_b64_tr_b16 v[10:11], v1 offset:16896
v_mfma_f32_32x32x16_bf16 v[48:63], v[20:23], v[184:187], v[48:63]
ds_read_b64_tr_b16 v[12:13], v6 offset:16384
ds_read_b64_tr_b16 v[14:15], v6 offset:16896
s_waitcnt lgkmcnt(6)
v_mfma_f32_32x32x16_bf16 v[32:47], v[24:27], v[188:191], v[32:47]
ds_read_b64_tr_b16 v[16:17], v1 offset:18432
ds_read_b64_tr_b16 v[18:19], v1 offset:18944
v_mfma_f32_32x32x16_bf16 v[48:63], v[28:31], v[188:191], v[48:63]
ds_read_b64_tr_b16 v[20:21], v6 offset:18432
ds_read_b64_tr_b16 v[22:23], v6 offset:18944
s_waitcnt lgkmcnt(4)
v_mfma_f32_32x32x16_bf16 v[32:47], v[8:11], v[192:195], v[32:47]
ds_read_b64_tr_b16 v[24:25], v1 offset:20480
ds_read_b64_tr_b16 v[26:27], v1 offset:20992
v_mfma_f32_32x32x16_bf16 v[48:63], v[12:15], v[192:195], v[48:63]
ds_read_b64_tr_b16 v[28:29], v6 offset:20480
ds_read_b64_tr_b16 v[30:31], v6 offset:20992
s_waitcnt lgkmcnt(4)
v_mfma_f32_32x32x16_bf16 v[32:47], v[16:19], v[196:199], v[32:47]
ds_read_b64_tr_b16 v[8:9], v1 offset:22528
ds_read_b64_tr_b16 v[10:11], v1 offset:23040
v_mfma_f32_32x32x16_bf16 v[48:63], v[20:23], v[196:199], v[48:63]
ds_read_b64_tr_b16 v[12:13], v6 offset:22528
ds_read_b64_tr_b16 v[14:15], v6 offset:23040
s_waitcnt lgkmcnt(4)
v_mfma_f32_32x32x16_bf16 v[32:47], v[24:27], v[200:203], v[32:47]
ds_read_b64_tr_b16 v[16:17], v1 offset:24576
ds_read_b64_tr_b16 v[18:19], v1 offset:25088
v_mfma_f32_32x32x16_bf16 v[48:63], v[28:31], v[200:203], v[48:63]
ds_read_b64_tr_b16 v[20:21], v6 offset:24576
ds_read_b64_tr_b16 v[22:23], v6 offset:25088
s_waitcnt lgkmcnt(4)
v_mfma_f32_32x32x16_bf16 v[32:47], v[8:11], v[204:207], v[32:47]
ds_read_b64_tr_b16 v[24:25], v1 offset:26624
ds_read_b64_tr_b16 v[26:27], v1 offset:27136
v_mfma_f32_32x32x16_bf16 v[48:63], v[12:15], v[204:207], v[48:63]
ds_read_b64_tr_b16 v[28:29], v6 offset:26624
ds_read_b64_tr_b16 v[30:31], v6 offset:27136
s_waitcnt lgkmcnt(4)
v_mfma_f32_32x32x16_bf16 v[32:47], v[16:19], v[208:211], v[32:47]
ds_read_b64_tr_b16 v[8:9], v1 offset:28672
ds_read_b64_tr_b16 v[10:11], v1 offset:29184
v_mfma_f32_32x32x16_bf16 v[48:63], v[20:23], v[208:211], v[48:63]
ds_read_b64_tr_b16 v[12:13], v6 offset:28672
ds_read_b64_tr_b16 v[14:15], v6 offset:29184
s_waitcnt lgkmcnt(4)
v_mfma_f32_32x32x16_bf16 v[32:47], v[24:27], v[212:215], v[32:47]
ds_read_b64_tr_b16 v[16:17], v1 offset:30720
ds_read_b64_tr_b16 v[18:19], v1 offset:31232
v_mfma_f32_32x32x16_bf16 v[48:63], v[28:31], v[212:215], v[48:63]
ds_read_b64_tr_b16 v[20:21], v6 offset:30720
ds_read_b64_tr_b16 v[22:23], v6 offset:31232
s_barrier
s_waitcnt lgkmcnt(4)
v_mfma_f32_32x32x16_bf16 v[32:47], v[8:11], v[216:219], v[32:47]
ds_read_b64_tr_b16 v[24:25], v1 offset:32768
ds_read_b64_tr_b16 v[26:27], v1 offset:33280
v_mfma_f32_32x32x16_bf16 v[48:63], v[12:15], v[216:219], v[48:63]
ds_read_b64_tr_b16 v[28:29], v6 offset:32768
ds_read_b64_tr_b16 v[30:31], v6 offset:33280
s_waitcnt lgkmcnt(4)
v_mfma_f32_32x32x16_bf16 v[32:47], v[16:19], v[220:223], v[32:47]
ds_read_b64_tr_b16 v[8:9], v1 offset:34816
ds_read_b64_tr_b16 v[10:11], v1 offset:35328
v_mfma_f32_32x32x16_bf16 v[48:63], v[20:23], v[220:223], v[48:63]
ds_read_b64_tr_b16 v[12:13], v6 offset:34816
ds_read_b64_tr_b16 v[14:15], v6 offset:35328
s_waitcnt lgkmcnt(4)
v_mfma_f32_32x32x16_bf16 v[32:47], v[24:27], v[224:227], v[32:47]
ds_read_b64_tr_b16 v[16:17], v1 offset:36864
ds_read_b64_tr_b16 v[18:19], v1 offset:37376
v_mfma_f32_32x32x16_bf16 v[48:63], v[28:31], v[224:227], v[48:63]
ds_read_b64_tr_b16 v[20:21], v6 offset:36864
ds_read_b64_tr_b16 v[22:23], v6 offset:37376
s_waitcnt lgkmcnt(4)
v_mfma_f32_32x32x16_bf16 v[32:47], v[8:11], v[228:231], v[32:47]
ds_read_b64_tr_b16 v[24:25], v1 offset:38912
ds_read_b64_tr_b16 v[26:27], v1 offset:39424
v_mfma_f32_32x32x16_bf16 v[48:63], v[12:15], v[228:231], v[48:63]
ds_read_b64_tr_b16 v[28:29], v6 offset:38912
ds_read_b64_tr_b16 v[30:31], v6 offset:39424
s_waitcnt lgkmcnt(4)
v_mfma_f32_32x32x16_bf16 v[32:47], v[16:19], v[232:235], v[32:47]
ds_read_b64_tr_b16 v[8:9], v1 offset:40960
ds_read_b64_tr_b16 v[10:11], v1 offset:41472
v_mfma_f32_32x32x16_bf16 v[48:63], v[20:23], v[232:235], v[48:63]
ds_read_b64_tr_b16 v[12:13], v6 offset:40960
ds_read_b64_tr_b16 v[14:15], v6 offset:41472
s_waitcnt lgkmcnt(4)
v_mfma_f32_32x32x16_bf16 v[32:47], v[24:27], v[236:239], v[32:47]
ds_read_b64_tr_b16 v[16:17], v1 offset:43008
ds_read_b64_tr_b16 v[18:19], v1 offset:43520
v_mfma_f32_32x32x16_bf16 v[48:63], v[28:31], v[236:239], v[48:63]
ds_read_b64_tr_b16 v[20:21], v6 offset:43008
ds_read_b64_tr_b16 v[22:23], v6 offset:43520
s_waitcnt lgkmcnt(4)
v_mfma_f32_32x32x16_bf16 v[96:111], v[8:11], v[128:131], 0
ds_read_b64_tr_b16 v[24:25], v1 offset:45056
ds_read_b64_tr_b16 v[26:27], v1 offset:45568
v_mfma_f32_32x32x16_bf16 v[112:127], v[12:15], v[128:131], 0
ds_read_b64_tr_b16 v[28:29], v6 offset:45056
ds_read_b64_tr_b16 v[30:31], v6 offset:45568
s_waitcnt lgkmcnt(4)
v_mfma_f32_32x32x16_bf16 v[96:111], v[16:19], v[132:135], v[96:111]
ds_read_b64_tr_b16 v[8:9], v1 offset:47104
ds_read_b64_tr_b16 v[10:11], v1 offset:47616
v_mul_f32 v244, s68, v32
v_mul_f32 v245, s68, v33
v_exp_f32_e64 v244, v244 clamp
v_mfma_f32_32x32x16_bf16 v[112:127], v[20:23], v[132:135], v[112:127]
ds_read_b64_tr_b16 v[12:13], v6 offset:47104
ds_read_b64_tr_b16 v[14:15], v6 offset:47616
v_exp_f32_e64 v245, v245 clamp
v_max_f32 v32, 0x358637bd, v32
s_waitcnt lgkmcnt(4)
v_mfma_f32_32x32x16_bf16 v[96:111], v[24:27], v[136:139], v[96:111]
ds_read_b64_tr_b16 v[16:17], v1 offset:49152
ds_read_b64_tr_b16 v[18:19], v1 offset:49664
v_max_f32 v33, 0x358637bd, v33
v_add_f32 v32, v32, v244
v_add_f32 v33, v33, v245
v_mul_f32 v246, s68, v34
v_mfma_f32_32x32x16_bf16 v[112:127], v[28:31], v[136:139], v[112:127]
ds_read_b64_tr_b16 v[20:21], v6 offset:49152
ds_read_b64_tr_b16 v[22:23], v6 offset:49664
v_mul_f32 v247, s68, v35
v_exp_f32_e64 v246, v246 clamp
s_waitcnt lgkmcnt(4)
v_mfma_f32_32x32x16_bf16 v[96:111], v[8:11], v[140:143], v[96:111]
ds_read_b64_tr_b16 v[24:25], v1 offset:51200
ds_read_b64_tr_b16 v[26:27], v1 offset:51712
v_exp_f32_e64 v247, v247 clamp
v_max_f32 v34, 0x358637bd, v34
v_max_f32 v35, 0x358637bd, v35
v_mfma_f32_32x32x16_bf16 v[112:127], v[12:15], v[140:143], v[112:127]
ds_read_b64_tr_b16 v[28:29], v6 offset:51200
ds_read_b64_tr_b16 v[30:31], v6 offset:51712
v_add_f32 v34, v34, v246
v_add_f32 v35, v35, v247
v_mul_f32 v244, s68, v36
s_waitcnt lgkmcnt(4)
v_mfma_f32_32x32x16_bf16 v[96:111], v[16:19], v[144:147], v[96:111]
ds_read_b64_tr_b16 v[8:9], v1 offset:53248
ds_read_b64_tr_b16 v[10:11], v1 offset:53760
v_mul_f32 v245, s68, v37
v_exp_f32_e64 v244, v244 clamp
v_exp_f32_e64 v245, v245 clamp
v_mfma_f32_32x32x16_bf16 v[112:127], v[20:23], v[144:147], v[112:127]
ds_read_b64_tr_b16 v[12:13], v6 offset:53248
ds_read_b64_tr_b16 v[14:15], v6 offset:53760
v_max_f32 v36, 0x358637bd, v36
v_max_f32 v37, 0x358637bd, v37
s_waitcnt lgkmcnt(4)
v_mfma_f32_32x32x16_bf16 v[96:111], v[24:27], v[148:151], v[96:111]
ds_read_b64_tr_b16 v[16:17], v1 offset:55296
ds_read_b64_tr_b16 v[18:19], v1 offset:55808
v_add_f32 v36, v36, v244
v_add_f32 v37, v37, v245
v_mul_f32 v246, s68, v38
v_mul_f32 v247, s68, v39
v_mfma_f32_32x32x16_bf16 v[112:127], v[28:31], v[148:151], v[112:127]
ds_read_b64_tr_b16 v[20:21], v6 offset:55296
ds_read_b64_tr_b16 v[22:23], v6 offset:55808
v_exp_f32_e64 v246, v246 clamp
v_exp_f32_e64 v247, v247 clamp
s_waitcnt lgkmcnt(4)
v_mfma_f32_32x32x16_bf16 v[96:111], v[8:11], v[152:155], v[96:111]
ds_read_b64_tr_b16 v[24:25], v1 offset:57344
ds_read_b64_tr_b16 v[26:27], v1 offset:57856
v_max_f32 v38, 0x358637bd, v38
v_max_f32 v39, 0x358637bd, v39
v_add_f32 v38, v38, v246
v_mfma_f32_32x32x16_bf16 v[112:127], v[12:15], v[152:155], v[112:127]
ds_read_b64_tr_b16 v[28:29], v6 offset:57344
ds_read_b64_tr_b16 v[30:31], v6 offset:57856
v_add_f32 v39, v39, v247
v_cvt_pk_bf16_f32 v80, v32, v33
v_cvt_pk_bf16_f32 v81, v34, v35
s_waitcnt lgkmcnt(4)
v_mfma_f32_32x32x16_bf16 v[96:111], v[16:19], v[156:159], v[96:111]
ds_read_b64_tr_b16 v[8:9], v1 offset:59392
ds_read_b64_tr_b16 v[10:11], v1 offset:59904
v_cvt_pk_bf16_f32 v82, v36, v37
v_cvt_pk_bf16_f32 v83, v38, v39
v_mul_f32 v244, s68, v40
v_mul_f32 v245, s68, v41
v_mfma_f32_32x32x16_bf16 v[112:127], v[20:23], v[156:159], v[112:127]
ds_read_b64_tr_b16 v[12:13], v6 offset:59392
ds_read_b64_tr_b16 v[14:15], v6 offset:59904
v_exp_f32_e64 v244, v244 clamp
v_exp_f32_e64 v245, v245 clamp
s_waitcnt lgkmcnt(4)
v_mfma_f32_32x32x16_bf16 v[96:111], v[24:27], v[160:163], v[96:111]
ds_read_b64_tr_b16 v[16:17], v1 offset:61440
ds_read_b64_tr_b16 v[18:19], v1 offset:61952
v_max_f32 v40, 0x358637bd, v40
v_max_f32 v41, 0x358637bd, v41
v_add_f32 v40, v40, v244
v_mfma_f32_32x32x16_bf16 v[112:127], v[28:31], v[160:163], v[112:127]
ds_read_b64_tr_b16 v[20:21], v6 offset:61440
ds_read_b64_tr_b16 v[22:23], v6 offset:61952
v_add_f32 v41, v41, v245
v_mul_f32 v246, s68, v42
v_mul_f32 v247, s68, v43
s_waitcnt lgkmcnt(4)
v_mfma_f32_32x32x16_bf16 v[96:111], v[8:11], v[164:167], v[96:111]
ds_read_b64_tr_b16 v[24:25], v1 offset:63488
ds_read_b64_tr_b16 v[26:27], v1 offset:64000
v_exp_f32_e64 v246, v246 clamp
v_exp_f32_e64 v247, v247 clamp
v_mfma_f32_32x32x16_bf16 v[112:127], v[12:15], v[164:167], v[112:127]
ds_read_b64_tr_b16 v[28:29], v6 offset:63488
ds_read_b64_tr_b16 v[30:31], v6 offset:64000
v_max_f32 v42, 0x358637bd, v42
v_max_f32 v43, 0x358637bd, v43
v_add_f32 v42, v42, v246
s_barrier
s_waitcnt lgkmcnt(4)
v_mfma_f32_32x32x16_bf16 v[96:111], v[16:19], v[168:171], v[96:111]
v_add_u32 v1, 0x00010000, v1
v_add_u32 v6, 0x00010000, v6
ds_read_b64_tr_b16 v[8:9], v1 offset:0
ds_read_b64_tr_b16 v[10:11], v1 offset:512
v_add_f32 v43, v43, v247
v_mul_f32 v244, s68, v44
v_mul_f32 v245, s68, v45
v_exp_f32_e64 v244, v244 clamp
v_mfma_f32_32x32x16_bf16 v[112:127], v[20:23], v[168:171], v[112:127]
ds_read_b64_tr_b16 v[12:13], v6 offset:0
ds_read_b64_tr_b16 v[14:15], v6 offset:512
v_exp_f32_e64 v245, v245 clamp
s_waitcnt lgkmcnt(4)
v_mfma_f32_32x32x16_bf16 v[96:111], v[24:27], v[172:175], v[96:111]
ds_read_b64_tr_b16 v[16:17], v1 offset:2048
ds_read_b64_tr_b16 v[18:19], v1 offset:2560
v_max_f32 v44, 0x358637bd, v44
v_max_f32 v45, 0x358637bd, v45
v_add_f32 v44, v44, v244
v_add_f32 v45, v45, v245
v_mfma_f32_32x32x16_bf16 v[112:127], v[28:31], v[172:175], v[112:127]
ds_read_b64_tr_b16 v[20:21], v6 offset:2048
ds_read_b64_tr_b16 v[22:23], v6 offset:2560
v_mul_f32 v246, s68, v46
v_mul_f32 v247, s68, v47
v_exp_f32_e64 v246, v246 clamp
s_waitcnt lgkmcnt(4)
v_mfma_f32_32x32x16_bf16 v[96:111], v[8:11], v[176:179], v[96:111]
ds_read_b64_tr_b16 v[24:25], v1 offset:4096
ds_read_b64_tr_b16 v[26:27], v1 offset:4608
v_exp_f32_e64 v247, v247 clamp
v_max_f32 v46, 0x358637bd, v46
v_mfma_f32_32x32x16_bf16 v[112:127], v[12:15], v[176:179], v[112:127]
ds_read_b64_tr_b16 v[28:29], v6 offset:4096
ds_read_b64_tr_b16 v[30:31], v6 offset:4608
v_max_f32 v47, 0x358637bd, v47
v_add_f32 v46, v46, v246
v_add_f32 v47, v47, v247
s_waitcnt lgkmcnt(4)
v_mfma_f32_32x32x16_bf16 v[96:111], v[16:19], v[180:183], v[96:111]
ds_read_b64_tr_b16 v[8:9], v1 offset:6144
ds_read_b64_tr_b16 v[10:11], v1 offset:6656
v_cvt_pk_bf16_f32 v84, v40, v41
v_cvt_pk_bf16_f32 v85, v42, v43
v_cvt_pk_bf16_f32 v86, v44, v45
v_cvt_pk_bf16_f32 v87, v46, v47
v_mfma_f32_32x32x16_bf16 v[112:127], v[20:23], v[180:183], v[112:127]
ds_read_b64_tr_b16 v[12:13], v6 offset:6144
ds_read_b64_tr_b16 v[14:15], v6 offset:6656
v_cndmask_b32 v86, v86, 0, s[64:65]
v_cndmask_b32 v87, v87, 0, s[64:65]
v_mul_f32 v244, s68, v48
s_waitcnt lgkmcnt(4)
v_mfma_f32_32x32x16_bf16 v[96:111], v[24:27], v[184:187], v[96:111]
ds_read_b64_tr_b16 v[16:17], v1 offset:8192
ds_read_b64_tr_b16 v[18:19], v1 offset:8704
v_mul_f32 v245, s68, v49
v_exp_f32_e64 v244, v244 clamp
v_exp_f32_e64 v245, v245 clamp
v_mfma_f32_32x32x16_bf16 v[112:127], v[28:31], v[184:187], v[112:127]
ds_read_b64_tr_b16 v[20:21], v6 offset:8192
ds_read_b64_tr_b16 v[22:23], v6 offset:8704
v_max_f32 v48, 0x358637bd, v48
v_max_f32 v49, 0x358637bd, v49
s_waitcnt lgkmcnt(4)
v_mfma_f32_32x32x16_bf16 v[96:111], v[8:11], v[188:191], v[96:111]
ds_read_b64_tr_b16 v[24:25], v1 offset:10240
ds_read_b64_tr_b16 v[26:27], v1 offset:10752
v_add_f32 v48, v48, v244
v_add_f32 v49, v49, v245
v_mul_f32 v246, s68, v50
v_mul_f32 v247, s68, v51
v_mfma_f32_32x32x16_bf16 v[112:127], v[12:15], v[188:191], v[112:127]
ds_read_b64_tr_b16 v[28:29], v6 offset:10240
ds_read_b64_tr_b16 v[30:31], v6 offset:10752
v_exp_f32_e64 v246, v246 clamp
v_exp_f32_e64 v247, v247 clamp
s_waitcnt lgkmcnt(4)
v_mfma_f32_32x32x16_bf16 v[96:111], v[16:19], v[192:195], v[96:111]
ds_read_b64_tr_b16 v[8:9], v1 offset:12288
ds_read_b64_tr_b16 v[10:11], v1 offset:12800
v_max_f32 v50, 0x358637bd, v50
v_max_f32 v51, 0x358637bd, v51
v_add_f32 v50, v50, v246
v_mfma_f32_32x32x16_bf16 v[112:127], v[20:23], v[192:195], v[112:127]
ds_read_b64_tr_b16 v[12:13], v6 offset:12288
ds_read_b64_tr_b16 v[14:15], v6 offset:12800
v_add_f32 v51, v51, v247
v_mul_f32 v244, s68, v52
v_mul_f32 v245, s68, v53
s_waitcnt lgkmcnt(4)
v_mfma_f32_32x32x16_bf16 v[96:111], v[24:27], v[196:199], v[96:111]
ds_read_b64_tr_b16 v[16:17], v1 offset:14336
ds_read_b64_tr_b16 v[18:19], v1 offset:14848
v_exp_f32_e64 v244, v244 clamp
v_exp_f32_e64 v245, v245 clamp
v_mfma_f32_32x32x16_bf16 v[112:127], v[28:31], v[196:199], v[112:127]
ds_read_b64_tr_b16 v[20:21], v6 offset:14336
ds_read_b64_tr_b16 v[22:23], v6 offset:14848
v_max_f32 v52, 0x358637bd, v52
v_max_f32 v53, 0x358637bd, v53
v_add_f32 v52, v52, v244
s_waitcnt lgkmcnt(4)
v_mfma_f32_32x32x16_bf16 v[96:111], v[8:11], v[200:203], v[96:111]
ds_read_b64_tr_b16 v[24:25], v1 offset:16384
ds_read_b64_tr_b16 v[26:27], v1 offset:16896
v_add_f32 v53, v53, v245
v_mul_f32 v246, s68, v54
v_mul_f32 v247, s68, v55
v_exp_f32_e64 v246, v246 clamp
v_mfma_f32_32x32x16_bf16 v[112:127], v[12:15], v[200:203], v[112:127]
ds_read_b64_tr_b16 v[28:29], v6 offset:16384
ds_read_b64_tr_b16 v[30:31], v6 offset:16896
v_exp_f32_e64 v247, v247 clamp
s_waitcnt lgkmcnt(4)
v_mfma_f32_32x32x16_bf16 v[96:111], v[16:19], v[204:207], v[96:111]
ds_read_b64_tr_b16 v[8:9], v1 offset:18432
ds_read_b64_tr_b16 v[10:11], v1 offset:18944
v_max_f32 v54, 0x358637bd, v54
v_max_f32 v55, 0x358637bd, v55
v_add_f32 v54, v54, v246
v_add_f32 v55, v55, v247
v_mfma_f32_32x32x16_bf16 v[112:127], v[20:23], v[204:207], v[112:127]
ds_read_b64_tr_b16 v[12:13], v6 offset:18432
ds_read_b64_tr_b16 v[14:15], v6 offset:18944
v_cvt_pk_bf16_f32 v88, v48, v49
v_cvt_pk_bf16_f32 v89, v50, v51
v_cvt_pk_bf16_f32 v90, v52, v53
s_waitcnt lgkmcnt(4)
v_mfma_f32_32x32x16_bf16 v[96:111], v[24:27], v[208:211], v[96:111]
ds_read_b64_tr_b16 v[16:17], v1 offset:20480
ds_read_b64_tr_b16 v[18:19], v1 offset:20992
v_cvt_pk_bf16_f32 v91, v54, v55
v_mul_f32 v244, s68, v56
v_mul_f32 v245, s68, v57
v_exp_f32_e64 v244, v244 clamp
v_mfma_f32_32x32x16_bf16 v[112:127], v[28:31], v[208:211], v[112:127]
ds_read_b64_tr_b16 v[20:21], v6 offset:20480
ds_read_b64_tr_b16 v[22:23], v6 offset:20992
v_exp_f32_e64 v245, v245 clamp
s_waitcnt lgkmcnt(4)
v_mfma_f32_32x32x16_bf16 v[96:111], v[8:11], v[212:215], v[96:111]
ds_read_b64_tr_b16 v[24:25], v1 offset:22528
ds_read_b64_tr_b16 v[26:27], v1 offset:23040
v_max_f32 v56, 0x358637bd, v56
v_max_f32 v57, 0x358637bd, v57
v_add_f32 v56, v56, v244
v_add_f32 v57, v57, v245
v_mfma_f32_32x32x16_bf16 v[112:127], v[12:15], v[212:215], v[112:127]
ds_read_b64_tr_b16 v[28:29], v6 offset:22528
ds_read_b64_tr_b16 v[30:31], v6 offset:23040
v_mul_f32 v246, s68, v58
v_mul_f32 v247, s68, v59
v_exp_f32_e64 v246, v246 clamp
s_waitcnt lgkmcnt(4)
v_mfma_f32_32x32x16_bf16 v[96:111], v[16:19], v[216:219], v[96:111]
ds_read_b64_tr_b16 v[8:9], v1 offset:24576
ds_read_b64_tr_b16 v[10:11], v1 offset:25088
v_exp_f32_e64 v247, v247 clamp
v_max_f32 v58, 0x358637bd, v58
v_mfma_f32_32x32x16_bf16 v[112:127], v[20:23], v[216:219], v[112:127]
ds_read_b64_tr_b16 v[12:13], v6 offset:24576
ds_read_b64_tr_b16 v[14:15], v6 offset:25088
v_max_f32 v59, 0x358637bd, v59
v_add_f32 v58, v58, v246
v_add_f32 v59, v59, v247
s_waitcnt lgkmcnt(4)
v_mfma_f32_32x32x16_bf16 v[96:111], v[24:27], v[220:223], v[96:111]
ds_read_b64_tr_b16 v[16:17], v1 offset:26624
ds_read_b64_tr_b16 v[18:19], v1 offset:27136
v_mul_f32 v244, s68, v60
v_mul_f32 v245, s68, v61
v_exp_f32_e64 v244, v244 clamp
v_mfma_f32_32x32x16_bf16 v[112:127], v[28:31], v[220:223], v[112:127]
ds_read_b64_tr_b16 v[20:21], v6 offset:26624
ds_read_b64_tr_b16 v[22:23], v6 offset:27136
v_exp_f32_e64 v245, v245 clamp
v_max_f32 v60, 0x358637bd, v60
s_waitcnt lgkmcnt(4)
v_mfma_f32_32x32x16_bf16 v[96:111], v[8:11], v[224:227], v[96:111]
ds_read_b64_tr_b16 v[24:25], v1 offset:28672
ds_read_b64_tr_b16 v[26:27], v1 offset:29184
v_max_f32 v61, 0x358637bd, v61
v_add_f32 v60, v60, v244
v_add_f32 v61, v61, v245
v_mul_f32 v246, s68, v62
v_mfma_f32_32x32x16_bf16 v[112:127], v[12:15], v[224:227], v[112:127]
ds_read_b64_tr_b16 v[28:29], v6 offset:28672
ds_read_b64_tr_b16 v[30:31], v6 offset:29184
v_mul_f32 v247, s68, v63
v_exp_f32_e64 v246, v246 clamp
s_waitcnt lgkmcnt(4)
v_mfma_f32_32x32x16_bf16 v[96:111], v[16:19], v[228:231], v[96:111]
ds_read_b64_tr_b16 v[8:9], v1 offset:30720
ds_read_b64_tr_b16 v[10:11], v1 offset:31232
v_exp_f32_e64 v247, v247 clamp
v_max_f32 v62, 0x358637bd, v62
v_max_f32 v63, 0x358637bd, v63
v_mfma_f32_32x32x16_bf16 v[112:127], v[20:23], v[228:231], v[112:127]
ds_read_b64_tr_b16 v[12:13], v6 offset:30720
ds_read_b64_tr_b16 v[14:15], v6 offset:31232
v_add_f32 v62, v62, v246
v_add_f32 v63, v63, v247
v_cvt_pk_bf16_f32 v92, v56, v57
s_waitcnt lgkmcnt(4)
v_mfma_f32_32x32x16_bf16 v[96:111], v[24:27], v[232:235], v[96:111]
v_add_u32 v1, 0xfffe0000, v1
v_add_u32 v6, 0xfffe0000, v6
ds_read_b64_tr_b16 v[16:17], v1 offset:49152
ds_read_b64_tr_b16 v[18:19], v1 offset:49664
v_cvt_pk_bf16_f32 v93, v58, v59
v_cvt_pk_bf16_f32 v94, v60, v61
v_cvt_pk_bf16_f32 v95, v62, v63
v_cndmask_b32 v94, v94, 0, s[64:65]
v_mfma_f32_32x32x16_bf16 v[112:127], v[28:31], v[232:235], v[112:127]
ds_read_b64_tr_b16 v[20:21], v6 offset:49152
ds_read_b64_tr_b16 v[22:23], v6 offset:49664
v_cndmask_b32 v95, v95, 0, s[64:65]
s_waitcnt lgkmcnt(4)
v_mfma_f32_32x32x16_bf16 v[96:111], v[8:11], v[236:239], v[96:111]
ds_read_b64_tr_b16 v[24:25], v1 offset:51200
ds_read_b64_tr_b16 v[26:27], v1 offset:51712
v_mfma_f32_32x32x16_bf16 v[112:127], v[12:15], v[236:239], v[112:127]
ds_read_b64_tr_b16 v[28:29], v6 offset:51200
ds_read_b64_tr_b16 v[30:31], v6 offset:51712
s_waitcnt lgkmcnt(4)
v_mfma_f32_32x32x16_bf16 v[32:47], v[16:19], v[128:131], 0
ds_read_b64_tr_b16 v[8:9], v1 offset:53248
ds_read_b64_tr_b16 v[10:11], v1 offset:53760
v_mfma_f32_32x32x16_bf16 v[48:63], v[20:23], v[128:131], 0
ds_read_b64_tr_b16 v[12:13], v6 offset:53248
ds_read_b64_tr_b16 v[14:15], v6 offset:53760
s_waitcnt lgkmcnt(4)
v_mfma_f32_32x32x16_bf16 v[32:47], v[24:27], v[132:135], v[32:47]
ds_read_b64_tr_b16 v[16:17], v1 offset:55296
ds_read_b64_tr_b16 v[18:19], v1 offset:55808
v_mul_f32 v244, s68, v96
v_mul_f32 v245, s68, v97
v_exp_f32_e64 v244, v244 clamp
v_mfma_f32_32x32x16_bf16 v[48:63], v[28:31], v[132:135], v[48:63]
ds_read_b64_tr_b16 v[20:21], v6 offset:55296
ds_read_b64_tr_b16 v[22:23], v6 offset:55808
v_exp_f32_e64 v245, v245 clamp
v_max_f32 v96, 0x358637bd, v96
s_waitcnt lgkmcnt(4)
v_mfma_f32_32x32x16_bf16 v[32:47], v[8:11], v[136:139], v[32:47]
ds_read_b64_tr_b16 v[24:25], v1 offset:57344
ds_read_b64_tr_b16 v[26:27], v1 offset:57856
v_max_f32 v97, 0x358637bd, v97
v_add_f32 v96, v96, v244
v_add_f32 v97, v97, v245
v_mul_f32 v246, s68, v98
v_mfma_f32_32x32x16_bf16 v[48:63], v[12:15], v[136:139], v[48:63]
ds_read_b64_tr_b16 v[28:29], v6 offset:57344
ds_read_b64_tr_b16 v[30:31], v6 offset:57856
v_mul_f32 v247, s68, v99
v_exp_f32_e64 v246, v246 clamp
s_waitcnt lgkmcnt(4)
v_mfma_f32_32x32x16_bf16 v[32:47], v[16:19], v[140:143], v[32:47]
ds_read_b64_tr_b16 v[8:9], v1 offset:59392
ds_read_b64_tr_b16 v[10:11], v1 offset:59904
v_exp_f32_e64 v247, v247 clamp
v_max_f32 v98, 0x358637bd, v98
v_max_f32 v99, 0x358637bd, v99
v_add_f32 v98, v98, v246
v_mfma_f32_32x32x16_bf16 v[48:63], v[20:23], v[140:143], v[48:63]
ds_read_b64_tr_b16 v[12:13], v6 offset:59392
ds_read_b64_tr_b16 v[14:15], v6 offset:59904
v_add_f32 v99, v99, v247
v_mul_f32 v244, s68, v100
v_mul_f32 v245, s68, v101
s_waitcnt lgkmcnt(4)
v_mfma_f32_32x32x16_bf16 v[32:47], v[24:27], v[144:147], v[32:47]
ds_read_b64_tr_b16 v[16:17], v1 offset:61440
ds_read_b64_tr_b16 v[18:19], v1 offset:61952
v_exp_f32_e64 v244, v244 clamp
v_exp_f32_e64 v245, v245 clamp
v_mfma_f32_32x32x16_bf16 v[48:63], v[28:31], v[144:147], v[48:63]
ds_read_b64_tr_b16 v[20:21], v6 offset:61440
ds_read_b64_tr_b16 v[22:23], v6 offset:61952
v_max_f32 v100, 0x358637bd, v100
v_max_f32 v101, 0x358637bd, v101
v_add_f32 v100, v100, v244
s_waitcnt lgkmcnt(4)
v_mfma_f32_32x32x16_bf16 v[32:47], v[8:11], v[148:151], v[32:47]
ds_read_b64_tr_b16 v[24:25], v1 offset:63488
ds_read_b64_tr_b16 v[26:27], v1 offset:64000
v_add_f32 v101, v101, v245
v_mul_f32 v246, s68, v102
v_mul_f32 v247, s68, v103
v_exp_f32_e64 v246, v246 clamp
v_mfma_f32_32x32x16_bf16 v[48:63], v[12:15], v[148:151], v[48:63]
ds_read_b64_tr_b16 v[28:29], v6 offset:63488
ds_read_b64_tr_b16 v[30:31], v6 offset:64000
v_exp_f32_e64 v247, v247 clamp
s_waitcnt lgkmcnt(4)
v_mfma_f32_32x32x16_bf16 v[32:47], v[16:19], v[152:155], v[32:47]
v_add_u32 v1, 0x00010000, v1
v_add_u32 v6, 0x00010000, v6
ds_read_b64_tr_b16 v[8:9], v1 offset:0
ds_read_b64_tr_b16 v[10:11], v1 offset:512
v_max_f32 v102, 0x358637bd, v102
v_max_f32 v103, 0x358637bd, v103
v_add_f32 v102, v102, v246
v_add_f32 v103, v103, v247
v_mfma_f32_32x32x16_bf16 v[48:63], v[20:23], v[152:155], v[48:63]
ds_read_b64_tr_b16 v[12:13], v6 offset:0
ds_read_b64_tr_b16 v[14:15], v6 offset:512
v_cvt_pk_bf16_f32 v248, v96, v97
v_cvt_pk_bf16_f32 v249, v98, v99
v_cvt_pk_bf16_f32 v250, v100, v101
v_cvt_pk_bf16_f32 v251, v102, v103
s_waitcnt lgkmcnt(4)
v_mfma_f32_32x32x16_bf16 v[32:47], v[24:27], v[156:159], v[32:47]
ds_read_b64_tr_b16 v[16:17], v1 offset:2048
ds_read_b64_tr_b16 v[18:19], v1 offset:2560
ds_write_b128 v5, v[248:251] offset:0
v_mfma_f32_32x32x16_bf16 v[48:63], v[28:31], v[156:159], v[48:63]
ds_read_b64_tr_b16 v[20:21], v6 offset:2048
ds_read_b64_tr_b16 v[22:23], v6 offset:2560
v_mul_f32 v244, s68, v104
v_mul_f32 v245, s68, v105
s_waitcnt lgkmcnt(5)
v_mfma_f32_32x32x16_bf16 v[32:47], v[8:11], v[160:163], v[32:47]
ds_read_b64_tr_b16 v[24:25], v1 offset:4096
ds_read_b64_tr_b16 v[26:27], v1 offset:4608
v_exp_f32_e64 v244, v244 clamp
v_exp_f32_e64 v245, v245 clamp
v_max_f32 v104, 0x358637bd, v104
v_mfma_f32_32x32x16_bf16 v[48:63], v[12:15], v[160:163], v[48:63]
ds_read_b64_tr_b16 v[28:29], v6 offset:4096
ds_read_b64_tr_b16 v[30:31], v6 offset:4608
v_max_f32 v105, 0x358637bd, v105
v_add_f32 v104, v104, v244
v_add_f32 v105, v105, v245
s_waitcnt lgkmcnt(4)
v_mfma_f32_32x32x16_bf16 v[32:47], v[16:19], v[164:167], v[32:47]
ds_read_b64_tr_b16 v[8:9], v1 offset:6144
ds_read_b64_tr_b16 v[10:11], v1 offset:6656
v_mul_f32 v246, s68, v106
v_mul_f32 v247, s68, v107
v_exp_f32_e64 v246, v246 clamp
v_mfma_f32_32x32x16_bf16 v[48:63], v[20:23], v[164:167], v[48:63]
ds_read_b64_tr_b16 v[12:13], v6 offset:6144
ds_read_b64_tr_b16 v[14:15], v6 offset:6656
v_exp_f32_e64 v247, v247 clamp
v_max_f32 v106, 0x358637bd, v106
s_waitcnt lgkmcnt(4)
v_mfma_f32_32x32x16_bf16 v[32:47], v[24:27], v[168:171], v[32:47]
ds_read_b64_tr_b16 v[16:17], v1 offset:8192
ds_read_b64_tr_b16 v[18:19], v1 offset:8704
v_max_f32 v107, 0x358637bd, v107
v_add_f32 v106, v106, v246
v_add_f32 v107, v107, v247
v_mul_f32 v244, s68, v108
v_mfma_f32_32x32x16_bf16 v[48:63], v[28:31], v[168:171], v[48:63]
ds_read_b64_tr_b16 v[20:21], v6 offset:8192
ds_read_b64_tr_b16 v[22:23], v6 offset:8704
v_mul_f32 v245, s68, v109
v_exp_f32_e64 v244, v244 clamp
s_waitcnt lgkmcnt(4)
v_mfma_f32_32x32x16_bf16 v[32:47], v[8:11], v[172:175], v[32:47]
ds_read_b64_tr_b16 v[24:25], v1 offset:10240
ds_read_b64_tr_b16 v[26:27], v1 offset:10752
v_exp_f32_e64 v245, v245 clamp
v_max_f32 v108, 0x358637bd, v108
v_max_f32 v109, 0x358637bd, v109
v_add_f32 v108, v108, v244
v_mfma_f32_32x32x16_bf16 v[48:63], v[12:15], v[172:175], v[48:63]
ds_read_b64_tr_b16 v[28:29], v6 offset:10240
ds_read_b64_tr_b16 v[30:31], v6 offset:10752
v_add_f32 v109, v109, v245
v_mul_f32 v246, s68, v110
v_mul_f32 v247, s68, v111
s_waitcnt lgkmcnt(4)
v_mfma_f32_32x32x16_bf16 v[32:47], v[16:19], v[176:179], v[32:47]
ds_read_b64_tr_b16 v[8:9], v1 offset:12288
ds_read_b64_tr_b16 v[10:11], v1 offset:12800
v_exp_f32_e64 v246, v246 clamp
v_exp_f32_e64 v247, v247 clamp
v_mfma_f32_32x32x16_bf16 v[48:63], v[20:23], v[176:179], v[48:63]
ds_read_b64_tr_b16 v[12:13], v6 offset:12288
ds_read_b64_tr_b16 v[14:15], v6 offset:12800
v_max_f32 v110, 0x358637bd, v110
v_max_f32 v111, 0x358637bd, v111
v_add_f32 v110, v110, v246
s_waitcnt lgkmcnt(4)
v_mfma_f32_32x32x16_bf16 v[32:47], v[24:27], v[180:183], v[32:47]
ds_read_b64_tr_b16 v[16:17], v1 offset:14336
ds_read_b64_tr_b16 v[18:19], v1 offset:14848
v_add_f32 v111, v111, v247
v_cvt_pk_bf16_f32 v252, v104, v105
v_cvt_pk_bf16_f32 v253, v106, v107
v_cvt_pk_bf16_f32 v254, v108, v109
v_mfma_f32_32x32x16_bf16 v[48:63], v[28:31], v[180:183], v[48:63]
ds_read_b64_tr_b16 v[20:21], v6 offset:14336
ds_read_b64_tr_b16 v[22:23], v6 offset:14848
v_cvt_pk_bf16_f32 v255, v110, v111
v_cndmask_b32 v254, v254, 0, s[64:65]
v_cndmask_b32 v255, v255, 0, s[64:65]
s_waitcnt lgkmcnt(4)
v_mfma_f32_32x32x16_bf16 v[32:47], v[8:11], v[184:187], v[32:47]
ds_read_b64_tr_b16 v[24:25], v1 offset:16384
ds_read_b64_tr_b16 v[26:27], v1 offset:16896
ds_write_b128 v5, v[252:255] offset:1024
v_mul_f32 v244, s68, v112
v_mfma_f32_32x32x16_bf16 v[48:63], v[12:15], v[184:187], v[48:63]
ds_read_b64_tr_b16 v[28:29], v6 offset:16384
ds_read_b64_tr_b16 v[30:31], v6 offset:16896
v_mul_f32 v245, s68, v113
v_exp_f32_e64 v244, v244 clamp
s_waitcnt lgkmcnt(5)
v_mfma_f32_32x32x16_bf16 v[32:47], v[16:19], v[188:191], v[32:47]
ds_read_b64_tr_b16 v[8:9], v1 offset:18432
ds_read_b64_tr_b16 v[10:11], v1 offset:18944
v_exp_f32_e64 v245, v245 clamp
v_max_f32 v112, 0x358637bd, v112
v_max_f32 v113, 0x358637bd, v113
v_mfma_f32_32x32x16_bf16 v[48:63], v[20:23], v[188:191], v[48:63]
ds_read_b64_tr_b16 v[12:13], v6 offset:18432
ds_read_b64_tr_b16 v[14:15], v6 offset:18944
v_add_f32 v112, v112, v244
v_add_f32 v113, v113, v245
v_mul_f32 v246, s68, v114
s_waitcnt lgkmcnt(4)
v_mfma_f32_32x32x16_bf16 v[32:47], v[24:27], v[192:195], v[32:47]
ds_read_b64_tr_b16 v[16:17], v1 offset:20480
ds_read_b64_tr_b16 v[18:19], v1 offset:20992
v_mul_f32 v247, s68, v115
v_exp_f32_e64 v246, v246 clamp
v_exp_f32_e64 v247, v247 clamp
v_mfma_f32_32x32x16_bf16 v[48:63], v[28:31], v[192:195], v[48:63]
ds_read_b64_tr_b16 v[20:21], v6 offset:20480
ds_read_b64_tr_b16 v[22:23], v6 offset:20992
v_max_f32 v114, 0x358637bd, v114
v_max_f32 v115, 0x358637bd, v115
s_waitcnt lgkmcnt(4)
v_mfma_f32_32x32x16_bf16 v[32:47], v[8:11], v[196:199], v[32:47]
ds_read_b64_tr_b16 v[24:25], v1 offset:22528
ds_read_b64_tr_b16 v[26:27], v1 offset:23040
v_add_f32 v114, v114, v246
v_add_f32 v115, v115, v247
v_mul_f32 v244, s68, v116
v_mul_f32 v245, s68, v117
v_mfma_f32_32x32x16_bf16 v[48:63], v[12:15], v[196:199], v[48:63]
ds_read_b64_tr_b16 v[28:29], v6 offset:22528
ds_read_b64_tr_b16 v[30:31], v6 offset:23040
v_exp_f32_e64 v244, v244 clamp
v_exp_f32_e64 v245, v245 clamp
s_barrier
s_waitcnt lgkmcnt(4)
v_mfma_f32_32x32x16_bf16 v[32:47], v[16:19], v[200:203], v[32:47]
ds_read_b64_tr_b16 v[8:9], v1 offset:24576
ds_read_b64_tr_b16 v[10:11], v1 offset:25088
v_max_f32 v116, 0x358637bd, v116
v_max_f32 v117, 0x358637bd, v117
v_add_f32 v116, v116, v244
v_add_f32 v117, v117, v245
v_mfma_f32_32x32x16_bf16 v[48:63], v[20:23], v[200:203], v[48:63]
ds_read_b64_tr_b16 v[12:13], v6 offset:24576
ds_read_b64_tr_b16 v[14:15], v6 offset:25088
v_mul_f32 v246, s68, v118
v_mul_f32 v247, s68, v119
s_waitcnt lgkmcnt(4)
v_mfma_f32_32x32x16_bf16 v[32:47], v[24:27], v[204:207], v[32:47]
ds_read_b64_tr_b16 v[16:17], v1 offset:26624
ds_read_b64_tr_b16 v[18:19], v1 offset:27136
v_exp_f32_e64 v246, v246 clamp
v_exp_f32_e64 v247, v247 clamp
v_max_f32 v118, 0x358637bd, v118
v_mfma_f32_32x32x16_bf16 v[48:63], v[28:31], v[204:207], v[48:63]
ds_read_b64_tr_b16 v[20:21], v6 offset:26624
ds_read_b64_tr_b16 v[22:23], v6 offset:27136
v_max_f32 v119, 0x358637bd, v119
v_add_f32 v118, v118, v246
v_add_f32 v119, v119, v247
s_waitcnt lgkmcnt(4)
v_mfma_f32_32x32x16_bf16 v[32:47], v[8:11], v[208:211], v[32:47]
ds_read_b64_tr_b16 v[24:25], v1 offset:28672
ds_read_b64_tr_b16 v[26:27], v1 offset:29184
v_cvt_pk_bf16_f32 v248, v112, v113
v_cvt_pk_bf16_f32 v249, v114, v115
v_cvt_pk_bf16_f32 v250, v116, v117
v_cvt_pk_bf16_f32 v251, v118, v119
v_mfma_f32_32x32x16_bf16 v[48:63], v[12:15], v[208:211], v[48:63]
ds_read_b64_tr_b16 v[28:29], v6 offset:28672
ds_read_b64_tr_b16 v[30:31], v6 offset:29184
ds_write_b128 v5, v[248:251] offset:2048
s_waitcnt lgkmcnt(5)
v_mfma_f32_32x32x16_bf16 v[32:47], v[16:19], v[212:215], v[32:47]
ds_read_b64_tr_b16 v[8:9], v1 offset:30720
ds_read_b64_tr_b16 v[10:11], v1 offset:31232
v_mul_f32 v244, s68, v120
v_mul_f32 v245, s68, v121
v_exp_f32_e64 v244, v244 clamp
v_mfma_f32_32x32x16_bf16 v[48:63], v[20:23], v[212:215], v[48:63]
ds_read_b64_tr_b16 v[12:13], v6 offset:30720
ds_read_b64_tr_b16 v[14:15], v6 offset:31232
v_exp_f32_e64 v245, v245 clamp
s_waitcnt lgkmcnt(5)
v_mfma_f32_32x32x16_bf16 v[32:47], v[24:27], v[216:219], v[32:47]
ds_read_b64_tr_b16 v[16:17], v1 offset:32768
ds_read_b64_tr_b16 v[18:19], v1 offset:33280
v_max_f32 v120, 0x358637bd, v120
v_max_f32 v121, 0x358637bd, v121
v_add_f32 v120, v120, v244
v_add_f32 v121, v121, v245
v_mul_f32 v246, s68, v122
v_mfma_f32_32x32x16_bf16 v[48:63], v[28:31], v[216:219], v[48:63]
ds_read_b64_tr_b16 v[20:21], v6 offset:32768
ds_read_b64_tr_b16 v[22:23], v6 offset:33280
v_mul_f32 v247, s68, v123
v_exp_f32_e64 v246, v246 clamp
s_waitcnt lgkmcnt(4)
v_mfma_f32_32x32x16_bf16 v[32:47], v[8:11], v[220:223], v[32:47]
ds_read_b64_tr_b16 v[24:25], v1 offset:34816
ds_read_b64_tr_b16 v[26:27], v1 offset:35328
v_exp_f32_e64 v247, v247 clamp
v_max_f32 v122, 0x358637bd, v122
v_max_f32 v123, 0x358637bd, v123
v_mfma_f32_32x32x16_bf16 v[48:63], v[12:15], v[220:223], v[48:63]
ds_read_b64_tr_b16 v[28:29], v6 offset:34816
ds_read_b64_tr_b16 v[30:31], v6 offset:35328
v_add_f32 v122, v122, v246
v_add_f32 v123, v123, v247
v_mul_f32 v244, s68, v124
s_waitcnt lgkmcnt(4)
v_mfma_f32_32x32x16_bf16 v[32:47], v[16:19], v[224:227], v[32:47]
ds_read_b64_tr_b16 v[8:9], v1 offset:36864
ds_read_b64_tr_b16 v[10:11], v1 offset:37376
v_mul_f32 v245, s68, v125
v_exp_f32_e64 v244, v244 clamp
v_exp_f32_e64 v245, v245 clamp
v_mfma_f32_32x32x16_bf16 v[48:63], v[20:23], v[224:227], v[48:63]
ds_read_b64_tr_b16 v[12:13], v6 offset:36864
ds_read_b64_tr_b16 v[14:15], v6 offset:37376
v_max_f32 v124, 0x358637bd, v124
v_max_f32 v125, 0x358637bd, v125
s_waitcnt lgkmcnt(4)
v_mfma_f32_32x32x16_bf16 v[32:47], v[24:27], v[228:231], v[32:47]
ds_read_b64_tr_b16 v[16:17], v1 offset:38912
ds_read_b64_tr_b16 v[18:19], v1 offset:39424
v_add_f32 v124, v124, v244
v_add_f32 v125, v125, v245
v_mul_f32 v246, s68, v126
v_mul_f32 v247, s68, v127
v_mfma_f32_32x32x16_bf16 v[48:63], v[28:31], v[228:231], v[48:63]
ds_read_b64_tr_b16 v[20:21], v6 offset:38912
ds_read_b64_tr_b16 v[22:23], v6 offset:39424
v_exp_f32_e64 v246, v246 clamp
v_exp_f32_e64 v247, v247 clamp
s_waitcnt lgkmcnt(4)
v_mfma_f32_32x32x16_bf16 v[32:47], v[8:11], v[232:235], v[32:47]
v_max_f32 v126, 0x358637bd, v126
v_max_f32 v127, 0x358637bd, v127
v_add_f32 v126, v126, v246
v_add_f32 v127, v127, v247
v_mfma_f32_32x32x16_bf16 v[48:63], v[12:15], v[232:235], v[48:63]
v_cvt_pk_bf16_f32 v252, v120, v121
v_cvt_pk_bf16_f32 v253, v122, v123
v_cvt_pk_bf16_f32 v254, v124, v125
s_waitcnt lgkmcnt(0)
v_mfma_f32_32x32x16_bf16 v[32:47], v[16:19], v[236:239], v[32:47]
v_cvt_pk_bf16_f32 v255, v126, v127
v_cndmask_b32 v254, v254, 0, s[64:65]
v_cndmask_b32 v255, v255, 0, s[64:65]
v_mfma_f32_32x32x16_bf16 v[48:63], v[20:23], v[236:239], v[48:63]
ds_write_b128 v5, v[252:255] offset:3072
s_nop 6
v_mul_f32 v244, s68, v32
v_mul_f32 v245, s68, v33
v_exp_f32_e64 v244, v244 clamp
v_exp_f32_e64 v245, v245 clamp
v_max_f32 v32, 0x358637bd, v32
v_max_f32 v33, 0x358637bd, v33
v_add_f32 v32, v32, v244
v_add_f32 v33, v33, v245
v_mul_f32 v246, s68, v34
v_mul_f32 v247, s68, v35
v_exp_f32_e64 v246, v246 clamp
v_exp_f32_e64 v247, v247 clamp
v_max_f32 v34, 0x358637bd, v34
v_max_f32 v35, 0x358637bd, v35
v_add_f32 v34, v34, v246
v_add_f32 v35, v35, v247
v_mul_f32 v244, s68, v36
v_mul_f32 v245, s68, v37
v_exp_f32_e64 v244, v244 clamp
v_exp_f32_e64 v245, v245 clamp
v_max_f32 v36, 0x358637bd, v36
v_max_f32 v37, 0x358637bd, v37
v_add_f32 v36, v36, v244
v_add_f32 v37, v37, v245
v_mul_f32 v246, s68, v38
v_mul_f32 v247, s68, v39
v_exp_f32_e64 v246, v246 clamp
v_exp_f32_e64 v247, v247 clamp
v_max_f32 v38, 0x358637bd, v38
v_max_f32 v39, 0x358637bd, v39
v_add_f32 v38, v38, v246
v_add_f32 v39, v39, v247
v_cvt_pk_bf16_f32 v248, v32, v33
v_cvt_pk_bf16_f32 v249, v34, v35
v_cvt_pk_bf16_f32 v250, v36, v37
v_cvt_pk_bf16_f32 v251, v38, v39
ds_write_b128 v5, v[248:251] offset:4096
v_mul_f32 v244, s68, v40
v_mul_f32 v245, s68, v41
v_exp_f32_e64 v244, v244 clamp
v_exp_f32_e64 v245, v245 clamp
v_max_f32 v40, 0x358637bd, v40
v_max_f32 v41, 0x358637bd, v41
v_add_f32 v40, v40, v244
v_add_f32 v41, v41, v245
v_mul_f32 v246, s68, v42
v_mul_f32 v247, s68, v43
v_exp_f32_e64 v246, v246 clamp
v_exp_f32_e64 v247, v247 clamp
v_max_f32 v42, 0x358637bd, v42
v_max_f32 v43, 0x358637bd, v43
v_add_f32 v42, v42, v246
v_add_f32 v43, v43, v247
v_mul_f32 v244, s68, v44
v_mul_f32 v245, s68, v45
v_exp_f32_e64 v244, v244 clamp
v_exp_f32_e64 v245, v245 clamp
v_max_f32 v44, 0x358637bd, v44
v_max_f32 v45, 0x358637bd, v45
v_add_f32 v44, v44, v244
v_add_f32 v45, v45, v245
v_mul_f32 v246, s68, v46
v_mul_f32 v247, s68, v47
v_exp_f32_e64 v246, v246 clamp
v_exp_f32_e64 v247, v247 clamp
v_max_f32 v46, 0x358637bd, v46
v_max_f32 v47, 0x358637bd, v47
v_add_f32 v46, v46, v246
v_add_f32 v47, v47, v247
v_cvt_pk_bf16_f32 v252, v40, v41
v_cvt_pk_bf16_f32 v253, v42, v43
v_cvt_pk_bf16_f32 v254, v44, v45
v_cvt_pk_bf16_f32 v255, v46, v47
v_cndmask_b32 v254, v254, 0, s[64:65]
v_cndmask_b32 v255, v255, 0, s[64:65]
ds_write_b128 v5, v[252:255] offset:5120
v_mul_f32 v244, s68, v48
v_mul_f32 v245, s68, v49
v_exp_f32_e64 v244, v244 clamp
v_exp_f32_e64 v245, v245 clamp
v_max_f32 v48, 0x358637bd, v48
v_max_f32 v49, 0x358637bd, v49
v_add_f32 v48, v48, v244
v_add_f32 v49, v49, v245
v_mul_f32 v246, s68, v50
v_mul_f32 v247, s68, v51
v_exp_f32_e64 v246, v246 clamp
v_exp_f32_e64 v247, v247 clamp
v_max_f32 v50, 0x358637bd, v50
v_max_f32 v51, 0x358637bd, v51
v_add_f32 v50, v50, v246
v_add_f32 v51, v51, v247
v_mul_f32 v244, s68, v52
v_mul_f32 v245, s68, v53
v_exp_f32_e64 v244, v244 clamp
v_exp_f32_e64 v245, v245 clamp
v_max_f32 v52, 0x358637bd, v52
v_max_f32 v53, 0x358637bd, v53
v_add_f32 v52, v52, v244
v_add_f32 v53, v53, v245
v_mul_f32 v246, s68, v54
v_mul_f32 v247, s68, v55
v_exp_f32_e64 v246, v246 clamp
v_exp_f32_e64 v247, v247 clamp
v_max_f32 v54, 0x358637bd, v54
v_max_f32 v55, 0x358637bd, v55
v_add_f32 v54, v54, v246
v_add_f32 v55, v55, v247
v_cvt_pk_bf16_f32 v248, v48, v49
v_cvt_pk_bf16_f32 v249, v50, v51
v_cvt_pk_bf16_f32 v250, v52, v53
v_cvt_pk_bf16_f32 v251, v54, v55
ds_write_b128 v5, v[248:251] offset:6144
v_mul_f32 v244, s68, v56
v_mul_f32 v245, s68, v57
v_exp_f32_e64 v244, v244 clamp
v_exp_f32_e64 v245, v245 clamp
v_max_f32 v56, 0x358637bd, v56
v_max_f32 v57, 0x358637bd, v57
v_add_f32 v56, v56, v244
v_add_f32 v57, v57, v245
v_mul_f32 v246, s68, v58
v_mul_f32 v247, s68, v59
v_exp_f32_e64 v246, v246 clamp
v_exp_f32_e64 v247, v247 clamp
v_max_f32 v58, 0x358637bd, v58
v_max_f32 v59, 0x358637bd, v59
v_add_f32 v58, v58, v246
v_add_f32 v59, v59, v247
v_mul_f32 v244, s68, v60
v_mul_f32 v245, s68, v61
v_exp_f32_e64 v244, v244 clamp
v_exp_f32_e64 v245, v245 clamp
v_max_f32 v60, 0x358637bd, v60
v_max_f32 v61, 0x358637bd, v61
v_add_f32 v60, v60, v244
v_add_f32 v61, v61, v245
v_mul_f32 v246, s68, v62
v_mul_f32 v247, s68, v63
v_exp_f32_e64 v246, v246 clamp
v_exp_f32_e64 v247, v247 clamp
v_max_f32 v62, 0x358637bd, v62
v_max_f32 v63, 0x358637bd, v63
v_add_f32 v62, v62, v246
v_add_f32 v63, v63, v247
v_cvt_pk_bf16_f32 v252, v56, v57
v_cvt_pk_bf16_f32 v253, v58, v59
v_cvt_pk_bf16_f32 v254, v60, v61
v_cvt_pk_bf16_f32 v255, v62, v63
v_cndmask_b32 v254, v254, 0, s[64:65]
v_cndmask_b32 v255, v255, 0, s[64:65]
ds_write_b128 v5, v[252:255] offset:7168
s_waitcnt lgkmcnt(0)
s_and_b32 s54, s44, 3
s_lshr_b32 s55, s44, 2
s_xor_b32 s55, s55, 0
v_lshlrev_b32 v3, 4, v0
s_lshl_b32 s56, s54, 13
s_mul_i32 s57, s55, 0
s_add_u32 s56, s56, s57
v_add_u32 v1, s56, v3
s_lshl_b32 s57, s55, 13
s_add_u32 s56, s57, 32768
v_add_u32 v2, s56, v3
s_lshl_b32 s56, s45, 2
s_add_u32 s56, s56, s54
s_mul_i32 s56, s56, 144
s_lshl_b32 s57, s47, 4
s_add_u32 s56, s56, s57
s_lshl_b32 s57, s55, 3
s_add_u32 s56, s56, s57
s_add_u32 s56, s56, 112
s_lshl_b32 s64, s56, 10
s_add_u32 s65, s64, 4096
s_lshl_b32 s56, s45, 15
s_lshl_b32 s57, s54, 12
s_add_u32 s56, s56, s57
s_lshl_b32 s57, s47, 8
s_add_u32 s56, s56, s57
s_lshl_b32 s57, s55, 7
s_add_u32 s56, s56, s57
s_add_u32 s66, s56, 10569728
v_cmp_eq_u32 vcc, 0, v0
v_mov_b32 v5, 0x40000000
s_nop 0
v_cndmask_b32 v4, v5, v0, vcc
v_cmp_lt_u32 s[68:69], 31, v0
v_mov_b32 v6, v7
s_barrier
ds_read_b128 v[16:19], v2 offset:0
ds_read_b128 v[20:23], v2 offset:1024
ds_read_b128 v[24:27], v2 offset:2048
ds_read_b128 v[28:31], v2 offset:3072
ds_read_b128 v[32:35], v2 offset:4096
ds_read_b128 v[36:39], v2 offset:5120
ds_read_b128 v[40:43], v2 offset:6144
ds_read_b128 v[44:47], v2 offset:7168
s_waitcnt lgkmcnt(6)
v_mfma_f32_32x32x16_bf16 v[128:143], v[16:19], v[64:67], 0
v_mfma_f32_32x32x16_bf16 v[128:143], v[20:23], v[68:71], v[128:143]
s_waitcnt lgkmcnt(4)
v_mfma_f32_32x32x16_bf16 v[144:159], v[24:27], v[72:75], 0
v_mfma_f32_32x32x16_bf16 v[144:159], v[28:31], v[76:79], v[144:159]
s_waitcnt lgkmcnt(2)
v_mfma_f32_32x32x16_bf16 v[160:175], v[32:35], v[80:83], 0
v_mfma_f32_32x32x16_bf16 v[160:175], v[36:39], v[84:87], v[160:175]
s_waitcnt lgkmcnt(0)
v_mfma_f32_32x32x16_bf16 v[176:191], v[40:43], v[88:91], 0
v_mfma_f32_32x32x16_bf16 v[176:191], v[44:47], v[92:95], v[176:191]
s_nop 2
v_mov_b32 v8, v140
s_nop 1
v_permlane32_swap_b32 v140, v8
v_add_f32 v8, 0x358637bd, v8
v_rcp_f32 v8, v8
s_nop 0
v_cndmask_b32 v9, v8, 0, s[68:69]
v_mul_f32 v128, v128, v8
v_mul_f32 v129, v129, v8
v_mul_f32 v130, v130, v8
v_mul_f32 v131, v131, v8
v_mul_f32 v132, v132, v8
v_mul_f32 v133, v133, v8
v_mul_f32 v134, v134, v8
v_mul_f32 v135, v135, v8
v_mul_f32 v136, v136, v8
v_mul_f32 v137, v137, v8
v_mul_f32 v138, v138, v8
v_mul_f32 v139, v139, v8
v_mul_f32 v140, v140, v9
v_mul_f32 v141, v141, v9
v_mul_f32 v142, v142, v9
v_mul_f32 v143, v143, v9
v_cvt_pk_bf16_f32 v16, v128, v129
v_cvt_pk_bf16_f32 v17, v130, v131
v_cvt_pk_bf16_f32 v18, v132, v133
v_cvt_pk_bf16_f32 v19, v134, v135
v_cvt_pk_bf16_f32 v20, v136, v137
v_cvt_pk_bf16_f32 v21, v138, v139
v_cvt_pk_bf16_f32 v22, v140, v141
v_cvt_pk_bf16_f32 v23, v142, v143
buffer_store_dwordx4 v[16:19], v3, s[36:39], s64 offen offset:0 sc1
buffer_store_dwordx4 v[20:23], v3, s[36:39], s64 offen offset:1024 sc1
v_mov_b32 v8, v156
s_nop 1
v_permlane32_swap_b32 v156, v8
v_add_f32 v8, 0x358637bd, v8
v_rcp_f32 v8, v8
s_nop 0
v_cndmask_b32 v9, v8, 0, s[68:69]
v_mul_f32 v144, v144, v8
v_mul_f32 v145, v145, v8
v_mul_f32 v146, v146, v8
v_mul_f32 v147, v147, v8
v_mul_f32 v148, v148, v8
v_mul_f32 v149, v149, v8
v_mul_f32 v150, v150, v8
v_mul_f32 v151, v151, v8
v_mul_f32 v152, v152, v8
v_mul_f32 v153, v153, v8
v_mul_f32 v154, v154, v8
v_mul_f32 v155, v155, v8
v_mul_f32 v156, v156, v9
v_mul_f32 v157, v157, v9
v_mul_f32 v158, v158, v9
v_mul_f32 v159, v159, v9
v_cvt_pk_bf16_f32 v24, v144, v145
v_cvt_pk_bf16_f32 v25, v146, v147
v_cvt_pk_bf16_f32 v26, v148, v149
v_cvt_pk_bf16_f32 v27, v150, v151
v_cvt_pk_bf16_f32 v28, v152, v153
v_cvt_pk_bf16_f32 v29, v154, v155
v_cvt_pk_bf16_f32 v30, v156, v157
v_cvt_pk_bf16_f32 v31, v158, v159
buffer_store_dwordx4 v[24:27], v3, s[36:39], s64 offen offset:2048 sc1
buffer_store_dwordx4 v[28:31], v3, s[36:39], s64 offen offset:3072 sc1
v_mov_b32 v8, v172
s_nop 1
v_permlane32_swap_b32 v172, v8
v_add_f32 v8, 0x358637bd, v8
v_rcp_f32 v8, v8
s_nop 0
v_cndmask_b32 v9, v8, 0, s[68:69]
v_mul_f32 v160, v160, v8
v_mul_f32 v161, v161, v8
v_mul_f32 v162, v162, v8
v_mul_f32 v163, v163, v8
v_mul_f32 v164, v164, v8
v_mul_f32 v165, v165, v8
v_mul_f32 v166, v166, v8
v_mul_f32 v167, v167, v8
v_mul_f32 v168, v168, v8
v_mul_f32 v169, v169, v8
v_mul_f32 v170, v170, v8
v_mul_f32 v171, v171, v8
v_mul_f32 v172, v172, v9
v_mul_f32 v173, v173, v9
v_mul_f32 v174, v174, v9
v_mul_f32 v175, v175, v9
v_cvt_pk_bf16_f32 v32, v160, v161
v_cvt_pk_bf16_f32 v33, v162, v163
v_cvt_pk_bf16_f32 v34, v164, v165
v_cvt_pk_bf16_f32 v35, v166, v167
v_cvt_pk_bf16_f32 v36, v168, v169
v_cvt_pk_bf16_f32 v37, v170, v171
v_cvt_pk_bf16_f32 v38, v172, v173
v_cvt_pk_bf16_f32 v39, v174, v175
buffer_store_dwordx4 v[32:35], v3, s[36:39], s65 offen offset:0 sc1
buffer_store_dwordx4 v[36:39], v3, s[36:39], s65 offen offset:1024 sc1
v_mov_b32 v8, v188
s_nop 1
v_permlane32_swap_b32 v188, v8
v_add_f32 v8, 0x358637bd, v8
v_rcp_f32 v8, v8
s_nop 0
v_cndmask_b32 v9, v8, 0, s[68:69]
v_mul_f32 v176, v176, v8
v_mul_f32 v177, v177, v8
v_mul_f32 v178, v178, v8
v_mul_f32 v179, v179, v8
v_mul_f32 v180, v180, v8
v_mul_f32 v181, v181, v8
v_mul_f32 v182, v182, v8
v_mul_f32 v183, v183, v8
v_mul_f32 v184, v184, v8
v_mul_f32 v185, v185, v8
v_mul_f32 v186, v186, v8
v_mul_f32 v187, v187, v8
v_mul_f32 v188, v188, v9
v_mul_f32 v189, v189, v9
v_mul_f32 v190, v190, v9
v_mul_f32 v191, v191, v9
v_cvt_pk_bf16_f32 v40, v176, v177
v_cvt_pk_bf16_f32 v41, v178, v179
v_cvt_pk_bf16_f32 v42, v180, v181
v_cvt_pk_bf16_f32 v43, v182, v183
v_cvt_pk_bf16_f32 v44, v184, v185
v_cvt_pk_bf16_f32 v45, v186, v187
v_cvt_pk_bf16_f32 v46, v188, v189
v_cvt_pk_bf16_f32 v47, v190, v191
buffer_store_dwordx4 v[40:43], v3, s[36:39], s65 offen offset:2048 sc1
buffer_store_dwordx4 v[44:47], v3, s[36:39], s65 offen offset:3072 sc1
s_waitcnt vmcnt(0)
buffer_store_dword v6, v4, s[36:39], s66 offen sc1
s_endpgm
L_HrA:
s_waitcnt vmcnt(10)
s_barrier
s_add_u32 s94, s49, 2
s_sub_u32 s54, s94, 7
s_cmp_ge_u32 s94, 7
s_cselect_b32 s94, s54, s94
s_mul_i32 s54, s94, 172032
s_add_u32 s54, s54, s40
s_add_u32 m0, s53, 122880
s_nop 0
buffer_load_dwordx4 v1, s[8:11], s54 offen  lds
s_add_u32 m0, s53, 123904
s_add_u32 s54, s54, 21504
buffer_load_dwordx4 v1, s[8:11], s54 offen  lds
s_add_u32 s94, s49, 3
s_sub_u32 s54, s94, 7
s_cmp_ge_u32 s94, 7
s_cselect_b32 s94, s54, s94
s_mul_i32 s54, s94, 172032
s_add_u32 s54, s54, s40
s_add_u32 m0, s53, 131072
s_nop 0
buffer_load_dwordx4 v1, s[8:11], s54 offen  lds
s_add_u32 m0, s53, 132096
s_add_u32 s54, s54, 21504
buffer_load_dwordx4 v1, s[8:11], s54 offen  lds
s_add_u32 s94, s49, 4
s_sub_u32 s54, s94, 7
s_cmp_ge_u32 s94, 7
s_cselect_b32 s94, s54, s94
s_mul_i32 s54, s94, 172032
s_add_u32 s54, s54, s40
s_add_u32 m0, s53, 139264
s_nop 0
buffer_load_dwordx4 v1, s[8:11], s54 offen  lds
s_add_u32 m0, s53, 140288
s_add_u32 s54, s54, 21504
buffer_load_dwordx4 v1, s[8:11], s54 offen  lds
s_waitcnt vmcnt(4)
s_barrier
v_cmp_eq_u32 vcc, 0, v191
s_nop 1
s_cbranch_vccz L_tagA_x
s_mov_b32 s58, 0
v_mov_b32 v12, 0
L_tagA:
buffer_load_dword v191, v12, s[32:35], 0 offen sc1
s_add_u32 s58, s58, 1
s_waitcnt vmcnt(0)
v_cmp_eq_u32 vcc, 0, v191
s_cmp_gt_u32 s58, 0x40000
s_cbranch_scc1 L_tagA_x
s_cbranch_vccnz L_tagA
L_tagA_x:
s_add_u32 s94, s49, 5
s_sub_u32 s54, s94, 7
s_cmp_ge_u32 s94, 7
s_cselect_b32 s94, s54, s94
s_mul_i32 s54, s94, 172032
s_add_u32 s54, s54, s40
s_add_u32 m0, s53, 147456
s_nop 0
buffer_load_dwordx4 v1, s[8:11], s54 offen  lds
s_add_u32 m0, s53, 148480
s_add_u32 s54, s54, 21504
buffer_load_dwordx4 v1, s[8:11], s54 offen  lds
s_add_u32 s94, s49, 6
s_sub_u32 s54, s94, 7
s_cmp_ge_u32 s94, 7
s_cselect_b32 s94, s54, s94
s_mul_i32 s54, s94, 172032
s_add_u32 s54, s54, s40
s_add_u32 m0, s53, 155648
s_nop 0
buffer_load_dwordx4 v1, s[8:11], s54 offen  lds
s_add_u32 m0, s53, 156672
s_add_u32 s54, s54, 21504
buffer_load_dwordx4 v1, s[8:11], s54 offen  lds
s_add_u32 s94, s49, 0
s_sub_u32 s54, s94, 7
s_cmp_ge_u32 s94, 7
s_cselect_b32 s94, s54, s94
s_mul_i32 s54, s94, s93
s_add_u32 s54, s54, s41
s_add_u32 m0, s53, 49152
s_nop 0
buffer_load_dwordx4 v2, s[20:23], s54 offen  lds
s_add_u32 m0, s53, 50176
s_add_u32 s54, s54, s92
buffer_load_dwordx4 v2, s[20:23], s54 offen  lds
s_add_u32 s94, s49, 1
s_sub_u32 s54, s94, 7
s_cmp_ge_u32 s94, 7
s_cselect_b32 s94, s54, s94
s_mul_i32 s54, s94, s93
s_add_u32 s54, s54, s41
s_add_u32 m0, s53, 57344
s_nop 0
buffer_load_dwordx4 v2, s[20:23], s54 offen  lds
s_add_u32 m0, s53, 58368
s_add_u32 s54, s54, s92
buffer_load_dwordx4 v2, s[20:23], s54 offen  lds
s_add_u32 s94, s49, 2
s_sub_u32 s54, s94, 7
s_cmp_ge_u32 s94, 7
s_cselect_b32 s94, s54, s94
s_mul_i32 s54, s94, s93
s_add_u32 s54, s54, s41
s_add_u32 m0, s53, 65536
s_nop 0
buffer_load_dwordx4 v2, s[20:23], s54 offen  lds
s_add_u32 m0, s53, 66560
s_add_u32 s54, s54, s92
buffer_load_dwordx4 v2, s[20:23], s54 offen  lds
s_waitcnt vmcnt(8)
s_barrier
s_add_u32 s94, s49, 3
s_sub_u32 s54, s94, 7
s_cmp_ge_u32 s94, 7
s_cselect_b32 s94, s54, s94
s_mul_i32 s54, s94, s93
s_add_u32 s54, s54, s41
s_add_u32 m0, s53, 73728
s_nop 0
buffer_load_dwordx4 v2, s[20:23], s54 offen  lds
s_add_u32 m0, s53, 74752
s_add_u32 s54, s54, s92
buffer_load_dwordx4 v2, s[20:23], s54 offen  lds
s_add_u32 s94, s49, 4
s_sub_u32 s54, s94, 7
s_cmp_ge_u32 s94, 7
s_cselect_b32 s94, s54, s94
s_mul_i32 s54, s94, s93
s_add_u32 s54, s54, s41
s_add_u32 m0, s53, 81920
s_nop 0
buffer_load_dwordx4 v2, s[20:23], s54 offen  lds
s_add_u32 m0, s53, 82944
s_add_u32 s54, s54, s92
buffer_load_dwordx4 v2, s[20:23], s54 offen  lds
s_add_u32 s94, s49, 5
s_sub_u32 s54, s94, 7
s_cmp_ge_u32 s94, 7
s_cselect_b32 s94, s54, s94
s_mul_i32 s54, s94, s93
s_add_u32 s54, s54, s41
s_add_u32 m0, s53, 90112
s_nop 0
buffer_load_dwordx4 v2, s[20:23], s54 offen  lds
s_add_u32 m0, s53, 91136
s_add_u32 s54, s54, s92
buffer_load_dwordx4 v2, s[20:23], s54 offen  lds
s_add_u32 s94, s49, 6
s_sub_u32 s54, s94, 7
s_cmp_ge_u32 s94, 7
s_cselect_b32 s94, s54, s94
s_mul_i32 s54, s94, s93
s_add_u32 s54, s54, s41
s_add_u32 m0, s53, 98304
s_nop 0
buffer_load_dwordx4 v2, s[20:23], s54 offen  lds
s_add_u32 m0, s53, 99328
s_add_u32 s54, s54, s92
buffer_load_dwordx4 v2, s[20:23], s54 offen  lds
s_waitcnt vmcnt(8)
s_barrier
s_add_u32 s94, s49, 0
s_sub_u32 s54, s94, 7
s_cmp_ge_u32 s94, 7
s_cselect_b32 s94, s54, s94
s_mul_i32 s54, s94, s93
s_add_u32 s54, s54, s42
s_add_u32 m0, s53, 106496
s_nop 0
buffer_load_dwordx4 v2, s[16:19], s54 offen  lds
s_add_u32 m0, s53, 107520
s_add_u32 s54, s54, s92
buffer_load_dwordx4 v2, s[16:19], s54 offen  lds
s_add_u32 s94, s49, 1
s_sub_u32 s54, s94, 7
s_cmp_ge_u32 s94, 7
s_cselect_b32 s94, s54, s94
s_mul_i32 s54, s94, s93
s_add_u32 s54, s54, s42
s_add_u32 m0, s53, 114688
s_nop 0
buffer_load_dwordx4 v2, s[16:19], s54 offen  lds
s_add_u32 m0, s53, 115712
s_add_u32 s54, s54, s92
buffer_load_dwordx4 v2, s[16:19], s54 offen  lds
s_add_u32 s94, s49, 2
s_sub_u32 s54, s94, 7
s_cmp_ge_u32 s94, 7
s_cselect_b32 s94, s54, s94
s_mul_i32 s54, s94, s93
s_add_u32 s54, s54, s42
s_add_u32 m0, s53, 122880
s_nop 0
buffer_load_dwordx4 v2, s[16:19], s54 offen  lds
s_add_u32 m0, s53, 123904
s_add_u32 s54, s54, s92
buffer_load_dwordx4 v2, s[16:19], s54 offen  lds
s_add_u32 s94, s49, 3
s_sub_u32 s54, s94, 7
s_cmp_ge_u32 s94, 7
s_cselect_b32 s94, s54, s94
s_mul_i32 s54, s94, s93
s_add_u32 s54, s54, s42
s_add_u32 m0, s53, 131072
s_nop 0
buffer_load_dwordx4 v2, s[16:19], s54 offen  lds
s_add_u32 m0, s53, 132096
s_add_u32 s54, s54, s92
buffer_load_dwordx4 v2, s[16:19], s54 offen  lds
s_waitcnt vmcnt(10)
s_barrier
s_add_u32 s94, s49, 4
s_sub_u32 s54, s94, 7
s_cmp_ge_u32 s94, 7
s_cselect_b32 s94, s54, s94
s_mul_i32 s54, s94, s93
s_add_u32 s54, s54, s42
s_add_u32 m0, s53, 139264
s_nop 0
buffer_load_dwordx4 v2, s[16:19], s54 offen  lds
s_add_u32 m0, s53, 140288
s_add_u32 s54, s54, s92
buffer_load_dwordx4 v2, s[16:19], s54 offen  lds
s_add_u32 s94, s49, 5
s_sub_u32 s54, s94, 7
s_cmp_ge_u32 s94, 7
s_cselect_b32 s94, s54, s94
s_mul_i32 s54, s94, s93
s_add_u32 s54, s54, s42
s_add_u32 m0, s53, 147456
s_nop 0
buffer_load_dwordx4 v2, s[16:19], s54 offen  lds
s_add_u32 m0, s53, 148480
s_add_u32 s54, s54, s92
buffer_load_dwordx4 v2, s[16:19], s54 offen  lds
s_add_u32 s94, s49, 6
s_sub_u32 s54, s94, 7
s_cmp_ge_u32 s94, 7
s_cselect_b32 s94, s54, s94
s_mul_i32 s54, s94, s93
s_add_u32 s54, s54, s42
s_add_u32 m0, s53, 155648
s_nop 0
buffer_load_dwordx4 v2, s[16:19], s54 offen  lds
s_add_u32 m0, s53, 156672
s_add_u32 s54, s54, s92
buffer_load_dwordx4 v2, s[16:19], s54 offen  lds
s_add_u32 s94, s49, 0
s_sub_u32 s54, s94, 7
s_cmp_ge_u32 s94, 7
s_cselect_b32 s94, s54, s94
s_mul_i32 s54, s94, s93
s_add_u32 s54, s54, s43
s_add_u32 m0, s53, 49152
s_nop 0
buffer_load_dwordx4 v2, s[20:23], s54 offen  lds
s_add_u32 m0, s53, 50176
s_add_u32 s54, s54, s92
buffer_load_dwordx4 v2, s[20:23], s54 offen  lds
s_add_u32 s94, s49, 1
s_sub_u32 s54, s94, 7
s_cmp_ge_u32 s94, 7
s_cselect_b32 s94, s54, s94
s_mul_i32 s54, s94, s93
s_add_u32 s54, s54, s43
s_add_u32 m0, s53, 57344
s_nop 0
buffer_load_dwordx4 v2, s[20:23], s54 offen  lds
s_add_u32 m0, s53, 58368
s_add_u32 s54, s54, s92
buffer_load_dwordx4 v2, s[20:23], s54 offen  lds
s_waitcnt vmcnt(12)
s_barrier
s_lshl_b32 s54, s100, 12
s_add_u32 s55, s54, 32768
v_add_u32 v11, s55, v4
ds_read_b128 v[16:19], v11 offset:0
ds_read_b128 v[20:23], v11 offset:1024
ds_read_b128 v[24:27], v11 offset:2048
ds_read_b128 v[28:31], v11 offset:3072
s_lshl_b32 s54, s101, 11
s_add_u32 s54, s54, 11534336
s_waitcnt lgkmcnt(2)
v_add_f32 v16, v16, v20
v_add_f32 v17, v17, v21
v_add_f32 v18, v18, v22
v_add_f32 v19, v19, v23
s_waitcnt lgkmcnt(0)
v_add_f32 v24, v24, v28
v_add_f32 v25, v25, v29
v_add_f32 v26, v26, v30
v_add_f32 v27, v27, v31
v_add_f32 v32, v16, v24
v_mov_b32 v33, v191
v_add_f32 v34, v17, v25
v_mov_b32 v35, v191
v_add_f32 v36, v18, v26
v_mov_b32 v37, v191
v_add_f32 v38, v19, v27
v_mov_b32 v39, v191
buffer_store_dwordx4 v[32:35], v4, s[36:39], s54 offen offset:0 sc1
buffer_store_dwordx4 v[36:39], v4, s[36:39], s54 offen offset:1024 sc1
s_add_u32 s94, s49, 2
s_sub_u32 s54, s94, 7
s_cmp_ge_u32 s94, 7
s_cselect_b32 s94, s54, s94
s_mul_i32 s54, s94, s93
s_add_u32 s54, s54, s43
s_add_u32 m0, s53, 65536
s_nop 0
buffer_load_dwordx4 v2, s[20:23], s54 offen  lds
s_add_u32 m0, s53, 66560
s_add_u32 s54, s54, s92
buffer_load_dwordx4 v2, s[20:23], s54 offen  lds
s_add_u32 s94, s49, 3
s_sub_u32 s54, s94, 7
s_cmp_ge_u32 s94, 7
s_cselect_b32 s94, s54, s94
s_mul_i32 s54, s94, s93
s_add_u32 s54, s54, s43
s_add_u32 m0, s53, 73728
s_nop 0
buffer_load_dwordx4 v2, s[20:23], s54 offen  lds
s_add_u32 m0, s53, 74752
s_add_u32 s54, s54, s92
buffer_load_dwordx4 v2, s[20:23], s54 offen  lds
s_add_u32 s94, s49, 4
s_sub_u32 s54, s94, 7
s_cmp_ge_u32 s94, 7
s_cselect_b32 s94, s54, s94
s_mul_i32 s54, s94, s93
s_add_u32 s54, s54, s43
s_add_u32 m0, s53, 81920
s_nop 0
buffer_load_dwordx4 v2, s[20:23], s54 offen  lds
s_add_u32 m0, s53, 82944
s_add_u32 s54, s54, s92
buffer_load_dwordx4 v2, s[20:23], s54 offen  lds
s_waitcnt vmcnt(0)
s_barrier
s_add_u32 s94, s49, 5
s_sub_u32 s54, s94, 7
s_cmp_ge_u32 s94, 7
s_cselect_b32 s94, s54, s94
s_mul_i32 s54, s94, s93
s_add_u32 s54, s54, s43
s_add_u32 m0, s53, 90112
s_nop 0
buffer_load_dwordx4 v2, s[20:23], s54 offen  lds
s_add_u32 m0, s53, 91136
s_add_u32 s54, s54, s92
buffer_load_dwordx4 v2, s[20:23], s54 offen  lds
s_add_u32 s94, s49, 6
s_sub_u32 s54, s94, 7
s_cmp_ge_u32 s94, 7
s_cselect_b32 s94, s54, s94
s_mul_i32 s54, s94, s93
s_add_u32 s54, s54, s43
s_add_u32 m0, s53, 98304
s_nop 0
buffer_load_dwordx4 v2, s[20:23], s54 offen  lds
s_add_u32 m0, s53, 99328
s_add_u32 s54, s54, s92
buffer_load_dwordx4 v2, s[20:23], s54 offen  lds
v_lshrrev_b32 v8, 1, v0
v_and_b32 v9, 1, v0
v_lshl_add_u32 v8, v8, 2, v9
v_lshlrev_b32 v8, 11, v8
v_mov_b32 v9, 0x40000000
v_cmp_gt_u32 vcc, 32, v0
s_lshl_b32 s60, s45, 17
s_lshl_b32 s54, s47, 12
v_cndmask_b32 v8, v9, v8, vcc
s_add_u32 s60, s60, s54
s_add_u32 s60, s60, 11536380
s_mov_b32 s58, 0
s_mov_b32 s54, 0xffffffff
s_mov_b32 s55, 0x00000000
L_can:
buffer_load_dword v10, v8, s[36:39], s60 offen sc1
s_add_u32 s58, s58, 1
s_waitcnt vmcnt(0)
v_cmp_ne_u32 vcc, v191, v10
s_cmp_gt_u32 s58, 0x40000
s_cbranch_scc1 L_can_x
s_and_b64 s[56:57], vcc, s[54:55]
s_cbranch_scc1 L_can
L_can_x:
v_lshrrev_b32 v8, 4, v0
v_lshlrev_b32 v8, 15, v8
v_and_b32 v9, 15, v0
v_lshl_add_u32 v8, v9, 4, v8
s_lshl_b32 s60, s45, 17
s_lshl_b32 s55, s47, 12
s_add_u32 s60, s60, s55
s_lshl_b32 s55, s100, 8
s_add_u32 s60, s60, s55
s_add_u32 s60, s60, 11534336
s_add_u32 s61, s60, 8192
s_add_u32 s62, s60, 16384
s_add_u32 s63, s60, 24576
buffer_load_dwordx4 v[40:43], v8, s[36:39], s60 offen offset:0 sc1
buffer_load_dwordx4 v[44:47], v8, s[36:39], s60 offen offset:1024 sc1
buffer_load_dwordx4 v[48:51], v8, s[36:39], s60 offen offset:2048 sc1
buffer_load_dwordx4 v[52:55], v8, s[36:39], s60 offen offset:3072 sc1
buffer_load_dwordx4 v[56:59], v8, s[36:39], s61 offen offset:0 sc1
buffer_load_dwordx4 v[60:63], v8, s[36:39], s61 offen offset:1024 sc1
buffer_load_dwordx4 v[64:67], v8, s[36:39], s61 offen offset:2048 sc1
buffer_load_dwordx4 v[68:71], v8, s[36:39], s61 offen offset:3072 sc1
buffer_load_dwordx4 v[72:75], v8, s[36:39], s62 offen offset:0 sc1
buffer_load_dwordx4 v[76:79], v8, s[36:39], s62 offen offset:1024 sc1
buffer_load_dwordx4 v[80:83], v8, s[36:39], s62 offen offset:2048 sc1
buffer_load_dwordx4 v[84:87], v8, s[36:39], s62 offen offset:3072 sc1
buffer_load_dwordx4 v[88:91], v8, s[36:39], s63 offen offset:0 sc1
buffer_load_dwordx4 v[92:95], v8, s[36:39], s63 offen offset:1024 sc1
buffer_load_dwordx4 v[96:99], v8, s[36:39], s63 offen offset:2048 sc1
buffer_load_dwordx4 v[100:103], v8, s[36:39], s63 offen offset:3072 sc1
s_mov_b32 s58, 0
s_branch L_k1_c
L_k1:
buffer_load_dwordx4 v[40:43], v8, s[36:39], s60 offen offset:0 sc1
buffer_load_dwordx4 v[44:47], v8, s[36:39], s60 offen offset:1024 sc1
buffer_load_dwordx4 v[48:51], v8, s[36:39], s60 offen offset:2048 sc1
buffer_load_dwordx4 v[52:55], v8, s[36:39], s60 offen offset:3072 sc1
buffer_load_dwordx4 v[56:59], v8, s[36:39], s61 offen offset:0 sc1
buffer_load_dwordx4 v[60:63], v8, s[36:39], s61 offen offset:1024 sc1
buffer_load_dwordx4 v[64:67], v8, s[36:39], s61 offen offset:2048 sc1
buffer_load_dwordx4 v[68:71], v8, s[36:39], s61 offen offset:3072 sc1
buffer_load_dwordx4 v[72:75], v8, s[36:39], s62 offen offset:0 sc1
buffer_load_dwordx4 v[76:79], v8, s[36:39], s62 offen offset:1024 sc1
buffer_load_dwordx4 v[80:83], v8, s[36:39], s62 offen offset:2048 sc1
buffer_load_dwordx4 v[84:87], v8, s[36:39], s62 offen offset:3072 sc1
buffer_load_dwordx4 v[88:91], v8, s[36:39], s63 offen offset:0 sc1
buffer_load_dwordx4 v[92:95], v8, s[36:39], s63 offen offset:1024 sc1
buffer_load_dwordx4 v[96:99], v8, s[36:39], s63 offen offset:2048 sc1
buffer_load_dwordx4 v[100:103], v8, s[36:39], s63 offen offset:3072 sc1
L_k1_c:
s_add_u32 s58, s58, 1
v_mov_b32 v10, v191
v_mov_b32 v11, v191
s_waitcnt vmcnt(0)
v_min3_u32 v10, v10, v41, v43
v_max3_u32 v11, v11, v41, v43
v_min3_u32 v10, v10, v45, v47
v_max3_u32 v11, v11, v45, v47
v_min3_u32 v10, v10, v49, v51
v_max3_u32 v11, v11, v49, v51
v_min3_u32 v10, v10, v53, v55
v_max3_u32 v11, v11, v53, v55
v_min3_u32 v10, v10, v57, v59
v_max3_u32 v11, v11, v57, v59
v_min3_u32 v10, v10, v61, v63
v_max3_u32 v11, v11, v61, v63
v_min3_u32 v10, v10, v65, v67
v_max3_u32 v11, v11, v65, v67
v_min3_u32 v10, v10, v69, v71
v_max3_u32 v11, v11, v69, v71
v_min3_u32 v10, v10, v73, v75
v_max3_u32 v11, v11, v73, v75
v_min3_u32 v10, v10, v77, v79
v_max3_u32 v11, v11, v77, v79
v_min3_u32 v10, v10, v81, v83
v_max3_u32 v11, v11, v81, v83
v_min3_u32 v10, v10, v85, v87
v_max3_u32 v11, v11, v85, v87
v_min3_u32 v10, v10, v89, v91
v_max3_u32 v11, v11, v89, v91
v_min3_u32 v10, v10, v93, v95
v_max3_u32 v11, v11, v93, v95
v_min3_u32 v10, v10, v97, v99
v_max3_u32 v11, v11, v97, v99
v_min3_u32 v10, v10, v101, v103
v_max3_u32 v11, v11, v101, v103
v_cmp_ne_u32 vcc, v10, v11
s_cmp_gt_u32 s58, 0x20000
s_cbranch_scc1 L_k1_x
s_cbranch_vccnz L_k1
L_k1_x:
v_add_f32 v40, v40, v56
v_add_f32 v72, v72, v88
v_add_f32 v42, v42, v58
v_add_f32 v74, v74, v90
v_add_f32 v44, v44, v60
v_add_f32 v76, v76, v92
v_add_f32 v46, v46, v62
v_add_f32 v78, v78, v94
v_add_f32 v48, v48, v64
v_add_f32 v80, v80, v96
v_add_f32 v50, v50, v66
v_add_f32 v82, v82, v98
v_add_f32 v52, v52, v68
v_add_f32 v84, v84, v100
v_add_f32 v54, v54, v70
v_add_f32 v86, v86, v102
v_add_f32 v16, v40, v72
v_add_f32 v17, v42, v74
v_add_f32 v18, v44, v76
v_add_f32 v19, v46, v78
v_add_f32 v20, v48, v80
v_add_f32 v21, v50, v82
v_add_f32 v22, v52, v84
v_add_f32 v23, v54, v86
ds_swizzle_b32 v24, v16 offset:0x401F
ds_swizzle_b32 v25, v17 offset:0x401F
ds_swizzle_b32 v26, v18 offset:0x401F
ds_swizzle_b32 v27, v19 offset:0x401F
ds_swizzle_b32 v28, v20 offset:0x401F
ds_swizzle_b32 v29, v21 offset:0x401F
ds_swizzle_b32 v30, v22 offset:0x401F
ds_swizzle_b32 v31, v23 offset:0x401F
s_waitcnt lgkmcnt(0)
v_add_f32 v16, v16, v24
v_add_f32 v17, v17, v25
v_add_f32 v18, v18, v26
v_add_f32 v19, v19, v27
v_add_f32 v20, v20, v28
v_add_f32 v21, v21, v29
v_add_f32 v22, v22, v30
v_add_f32 v23, v23, v31
v_mov_b32 v24, v16
v_mov_b32 v25, v17
v_mov_b32 v26, v18
v_mov_b32 v27, v19
v_mov_b32 v28, v20
v_mov_b32 v29, v21
v_mov_b32 v30, v22
v_mov_b32 v31, v23
v_permlane32_swap_b32 v16, v24
v_permlane32_swap_b32 v17, v25
v_permlane32_swap_b32 v18, v26
v_permlane32_swap_b32 v19, v27
v_permlane32_swap_b32 v20, v28
v_permlane32_swap_b32 v21, v29
v_permlane32_swap_b32 v22, v30
v_permlane32_swap_b32 v23, v31
v_add_f32 v16, v16, v24
v_add_f32 v17, v17, v25
v_add_f32 v18, v18, v26
v_add_f32 v19, v19, v27
v_add_f32 v20, v20, v28
v_add_f32 v21, v21, v29
v_add_f32 v22, v22, v30
v_add_f32 v23, v23, v31
v_cvt_pk_bf16_f32 v24, v16, v17
v_cvt_pk_bf16_f32 v25, v18, v19
v_cvt_pk_bf16_f32 v26, v20, v21
v_cvt_pk_bf16_f32 v27, v22, v23
v_cmp_gt_u32 vcc, 16, v0
v_mov_b32 v29, v191
v_mov_b32 v31, v191
v_cndmask_b32 v28, v26, v24, vcc
v_cndmask_b32 v30, v27, v25, vcc
v_lshrrev_b32 v8, 4, v0
v_lshlrev_b32 v8, 10, v8
v_and_b32 v9, 15, v0
v_lshl_add_u32 v8, v9, 4, v8
v_mov_b32 v9, 0x40000000
v_cmp_gt_u32 vcc, 32, v0
s_lshl_b32 s54, s45, 1
s_add_u32 s54, s54, s47
v_cndmask_b32 v8, v9, v8, vcc
s_lshl_b32 s54, s54, 11
s_lshl_b32 s55, s100, 8
s_add_u32 s54, s54, s55
s_add_u32 s54, s54, 10485760
buffer_store_dwordx4 v[28:31], v8, s[36:39], s54 offen sc1
s_barrier
s_branch L_HA
L_HA:
s_lshl_b32 s54, s47, 2
s_add_u32 s60, s54, s100
s_lshl_b32 s60, s60, 13
s_add_u32 s60, s60, 10485760
s_add_u32 s61, s60, 4096
buffer_load_dwordx4 v[16:19], v4, s[36:39], s60 offen offset:0 sc1
buffer_load_dwordx4 v[20:23], v4, s[36:39], s60 offen offset:1024 sc1
buffer_load_dwordx4 v[24:27], v4, s[36:39], s60 offen offset:2048 sc1
buffer_load_dwordx4 v[28:31], v4, s[36:39], s60 offen offset:3072 sc1
buffer_load_dwordx4 v[32:35], v4, s[36:39], s61 offen offset:0 sc1
buffer_load_dwordx4 v[36:39], v4, s[36:39], s61 offen offset:1024 sc1
buffer_load_dwordx4 v[40:43], v4, s[36:39], s61 offen offset:2048 sc1
buffer_load_dwordx4 v[44:47], v4, s[36:39], s61 offen offset:3072 sc1
s_lshl_b32 s54, s100, 12
s_add_u32 s54, s54, 32768
v_add_u32 v9, s54, v4
s_mov_b32 s58, 0
s_branch L_k2_c
L_k2:
buffer_load_dwordx4 v[16:19], v4, s[36:39], s60 offen offset:0 sc1
buffer_load_dwordx4 v[20:23], v4, s[36:39], s60 offen offset:1024 sc1
buffer_load_dwordx4 v[24:27], v4, s[36:39], s60 offen offset:2048 sc1
buffer_load_dwordx4 v[28:31], v4, s[36:39], s60 offen offset:3072 sc1
buffer_load_dwordx4 v[32:35], v4, s[36:39], s61 offen offset:0 sc1
buffer_load_dwordx4 v[36:39], v4, s[36:39], s61 offen offset:1024 sc1
buffer_load_dwordx4 v[40:43], v4, s[36:39], s61 offen offset:2048 sc1
buffer_load_dwordx4 v[44:47], v4, s[36:39], s61 offen offset:3072 sc1
L_k2_c:
s_add_u32 s58, s58, 1
v_mov_b32 v10, v191
v_mov_b32 v11, v191
s_waitcnt vmcnt(0)
v_min3_u32 v10, v10, v17, v19
v_max3_u32 v11, v11, v17, v19
v_min3_u32 v10, v10, v21, v23
v_max3_u32 v11, v11, v21, v23
v_min3_u32 v10, v10, v25, v27
v_max3_u32 v11, v11, v25, v27
v_min3_u32 v10, v10, v29, v31
v_max3_u32 v11, v11, v29, v31
v_min3_u32 v10, v10, v33, v35
v_max3_u32 v11, v11, v33, v35
v_min3_u32 v10, v10, v37, v39
v_max3_u32 v11, v11, v37, v39
v_min3_u32 v10, v10, v41, v43
v_max3_u32 v11, v11, v41, v43
v_min3_u32 v10, v10, v45, v47
v_max3_u32 v11, v11, v45, v47
v_cmp_ne_u32 vcc, v10, v11
s_cmp_gt_u32 s58, 0x20000
s_cbranch_scc1 L_k2_x
s_cbranch_vccnz L_k2
L_k2_x:
v_mov_b32 v17, v18
v_mov_b32 v18, v20
v_mov_b32 v19, v22
ds_write_b128 v9, v[16:19] offset:0
v_mov_b32 v25, v26
v_mov_b32 v26, v28
v_mov_b32 v27, v30
ds_write_b128 v9, v[24:27] offset:1024
v_mov_b32 v33, v34
v_mov_b32 v34, v36
v_mov_b32 v35, v38
ds_write_b128 v9, v[32:35] offset:2048
v_mov_b32 v41, v42
v_mov_b32 v42, v44
v_mov_b32 v43, v46
ds_write_b128 v9, v[40:43] offset:3072
s_waitcnt lgkmcnt(0)
s_and_b32 s54, s44, 3
s_lshr_b32 s55, s44, 2
s_xor_b32 s55, s55, 0
v_lshlrev_b32 v3, 4, v0
s_lshl_b32 s56, s54, 13
s_mul_i32 s57, s55, 0
s_add_u32 s56, s56, s57
v_add_u32 v1, s56, v3
s_lshl_b32 s57, s55, 13
s_add_u32 s56, s57, 32768
v_add_u32 v2, s56, v3
s_lshl_b32 s56, s45, 2
s_add_u32 s56, s56, s54
s_mul_i32 s56, s56, 144
s_lshl_b32 s57, s47, 4
s_add_u32 s56, s56, s57
s_lshl_b32 s57, s55, 3
s_add_u32 s56, s56, s57
s_add_u32 s56, s56, 112
s_lshl_b32 s64, s56, 10
s_add_u32 s65, s64, 4096
s_lshl_b32 s56, s45, 15
s_lshl_b32 s57, s54, 12
s_add_u32 s56, s56, s57
s_lshl_b32 s57, s47, 8
s_add_u32 s56, s56, s57
s_lshl_b32 s57, s55, 7
s_add_u32 s56, s56, s57
s_add_u32 s66, s56, 10569728
v_cmp_eq_u32 vcc, 0, v0
v_mov_b32 v5, 0x40000000
s_nop 0
v_cndmask_b32 v4, v5, v0, vcc
v_cmp_lt_u32 s[68:69], 31, v0
v_mov_b32 v6, v191
s_barrier
ds_read_b128 v[16:19], v1 offset:0
ds_read_b128 v[20:23], v1 offset:1024
ds_read_b128 v[24:27], v2 offset:0
ds_read_b128 v[28:31], v2 offset:1024
ds_read_b128 v[32:35], v1 offset:2048
ds_read_b128 v[36:39], v1 offset:3072
ds_read_b128 v[40:43], v2 offset:2048
ds_read_b128 v[44:47], v2 offset:3072
ds_read_b128 v[48:51], v1 offset:4096
ds_read_b128 v[52:55], v1 offset:5120
ds_read_b128 v[56:59], v2 offset:4096
ds_read_b128 v[60:63], v2 offset:5120
ds_read_b128 v[64:67], v1 offset:6144
ds_read_b128 v[68:71], v1 offset:7168
ds_read_b128 v[72:75], v2 offset:6144
ds_read_b128 v[76:79], v2 offset:7168
s_waitcnt lgkmcnt(12)
v_mfma_f32_32x32x16_bf16 v[128:143], v[24:27], v[16:19], 0
v_mfma_f32_32x32x16_bf16 v[128:143], v[28:31], v[20:23], v[128:143]
s_waitcnt lgkmcnt(8)
v_mfma_f32_32x32x16_bf16 v[144:159], v[40:43], v[32:35], 0
v_mfma_f32_32x32x16_bf16 v[144:159], v[44:47], v[36:39], v[144:159]
s_waitcnt lgkmcnt(4)
v_mfma_f32_32x32x16_bf16 v[160:175], v[56:59], v[48:51], 0
v_mfma_f32_32x32x16_bf16 v[160:175], v[60:63], v[52:55], v[160:175]
s_waitcnt lgkmcnt(0)
v_mfma_f32_32x32x16_bf16 v[176:191], v[72:75], v[64:67], 0
v_mfma_f32_32x32x16_bf16 v[176:191], v[76:79], v[68:71], v[176:191]
s_nop 2
v_mov_b32 v8, v140
s_nop 1
v_permlane32_swap_b32 v140, v8
v_add_f32 v8, 0x358637bd, v8
v_rcp_f32 v8, v8
s_nop 0
v_cndmask_b32 v9, v8, 0, s[68:69]
v_mul_f32 v128, v128, v8
v_mul_f32 v129, v129, v8
v_mul_f32 v130, v130, v8
v_mul_f32 v131, v131, v8
v_mul_f32 v132, v132, v8
v_mul_f32 v133, v133, v8
v_mul_f32 v134, v134, v8
v_mul_f32 v135, v135, v8
v_mul_f32 v136, v136, v8
v_mul_f32 v137, v137, v8
v_mul_f32 v138, v138, v8
v_mul_f32 v139, v139, v8
v_mul_f32 v140, v140, v9
v_mul_f32 v141, v141, v9
v_mul_f32 v142, v142, v9
v_mul_f32 v143, v143, v9
v_cvt_pk_bf16_f32 v16, v128, v129
v_cvt_pk_bf16_f32 v17, v130, v131
v_cvt_pk_bf16_f32 v18, v132, v133
v_cvt_pk_bf16_f32 v19, v134, v135
v_cvt_pk_bf16_f32 v20, v136, v137
v_cvt_pk_bf16_f32 v21, v138, v139
v_cvt_pk_bf16_f32 v22, v140, v141
v_cvt_pk_bf16_f32 v23, v142, v143
buffer_store_dwordx4 v[16:19], v3, s[36:39], s64 offen offset:0 sc1
buffer_store_dwordx4 v[20:23], v3, s[36:39], s64 offen offset:1024 sc1
v_mov_b32 v8, v156
s_nop 1
v_permlane32_swap_b32 v156, v8
v_add_f32 v8, 0x358637bd, v8
v_rcp_f32 v8, v8
s_nop 0
v_cndmask_b32 v9, v8, 0, s[68:69]
v_mul_f32 v144, v144, v8
v_mul_f32 v145, v145, v8
v_mul_f32 v146, v146, v8
v_mul_f32 v147, v147, v8
v_mul_f32 v148, v148, v8
v_mul_f32 v149, v149, v8
v_mul_f32 v150, v150, v8
v_mul_f32 v151, v151, v8
v_mul_f32 v152, v152, v8
v_mul_f32 v153, v153, v8
v_mul_f32 v154, v154, v8
v_mul_f32 v155, v155, v8
v_mul_f32 v156, v156, v9
v_mul_f32 v157, v157, v9
v_mul_f32 v158, v158, v9
v_mul_f32 v159, v159, v9
v_cvt_pk_bf16_f32 v24, v144, v145
v_cvt_pk_bf16_f32 v25, v146, v147
v_cvt_pk_bf16_f32 v26, v148, v149
v_cvt_pk_bf16_f32 v27, v150, v151
v_cvt_pk_bf16_f32 v28, v152, v153
v_cvt_pk_bf16_f32 v29, v154, v155
v_cvt_pk_bf16_f32 v30, v156, v157
v_cvt_pk_bf16_f32 v31, v158, v159
buffer_store_dwordx4 v[24:27], v3, s[36:39], s64 offen offset:2048 sc1
buffer_store_dwordx4 v[28:31], v3, s[36:39], s64 offen offset:3072 sc1
v_mov_b32 v8, v172
s_nop 1
v_permlane32_swap_b32 v172, v8
v_add_f32 v8, 0x358637bd, v8
v_rcp_f32 v8, v8
s_nop 0
v_cndmask_b32 v9, v8, 0, s[68:69]
v_mul_f32 v160, v160, v8
v_mul_f32 v161, v161, v8
v_mul_f32 v162, v162, v8
v_mul_f32 v163, v163, v8
v_mul_f32 v164, v164, v8
v_mul_f32 v165, v165, v8
v_mul_f32 v166, v166, v8
v_mul_f32 v167, v167, v8
v_mul_f32 v168, v168, v8
v_mul_f32 v169, v169, v8
v_mul_f32 v170, v170, v8
v_mul_f32 v171, v171, v8
v_mul_f32 v172, v172, v9
v_mul_f32 v173, v173, v9
v_mul_f32 v174, v174, v9
v_mul_f32 v175, v175, v9
v_cvt_pk_bf16_f32 v32, v160, v161
v_cvt_pk_bf16_f32 v33, v162, v163
v_cvt_pk_bf16_f32 v34, v164, v165
v_cvt_pk_bf16_f32 v35, v166, v167
v_cvt_pk_bf16_f32 v36, v168, v169
v_cvt_pk_bf16_f32 v37, v170, v171
v_cvt_pk_bf16_f32 v38, v172, v173
v_cvt_pk_bf16_f32 v39, v174, v175
buffer_store_dwordx4 v[32:35], v3, s[36:39], s65 offen offset:0 sc1
buffer_store_dwordx4 v[36:39], v3, s[36:39], s65 offen offset:1024 sc1
v_mov_b32 v8, v188
s_nop 1
v_permlane32_swap_b32 v188, v8
v_add_f32 v8, 0x358637bd, v8
v_rcp_f32 v8, v8
s_nop 0
v_cndmask_b32 v9, v8, 0, s[68:69]
v_mul_f32 v176, v176, v8
v_mul_f32 v177, v177, v8
v_mul_f32 v178, v178, v8
v_mul_f32 v179, v179, v8
v_mul_f32 v180, v180, v8
v_mul_f32 v181, v181, v8
v_mul_f32 v182, v182, v8
v_mul_f32 v183, v183, v8
v_mul_f32 v184, v184, v8
v_mul_f32 v185, v185, v8
v_mul_f32 v186, v186, v8
v_mul_f32 v187, v187, v8
v_mul_f32 v188, v188, v9
v_mul_f32 v189, v189, v9
v_mul_f32 v190, v190, v9
v_mul_f32 v191, v191, v9
v_cvt_pk_bf16_f32 v40, v176, v177
v_cvt_pk_bf16_f32 v41, v178, v179
v_cvt_pk_bf16_f32 v42, v180, v181
v_cvt_pk_bf16_f32 v43, v182, v183
v_cvt_pk_bf16_f32 v44, v184, v185
v_cvt_pk_bf16_f32 v45, v186, v187
v_cvt_pk_bf16_f32 v46, v188, v189
v_cvt_pk_bf16_f32 v47, v190, v191
buffer_store_dwordx4 v[40:43], v3, s[36:39], s65 offen offset:2048 sc1
buffer_store_dwordx4 v[44:47], v3, s[36:39], s65 offen offset:3072 sc1
s_waitcnt vmcnt(0)
buffer_store_dword v6, v4, s[36:39], s66 offen sc1
s_endpgm
L_end:
s_endpgm
.section .rodata,"a"
.p2align 6
.amdhsa_kernel parallel_sum__linear_attn_block__geglu_ffn__prompt_kernel
  .amdhsa_next_free_vgpr 256
  .amdhsa_next_free_sgpr 102
  .amdhsa_accum_offset 256
  .amdhsa_group_segment_fixed_size 0
  .amdhsa_kernarg_size 80
  .amdhsa_user_sgpr_count 2
  .amdhsa_user_sgpr_kernarg_segment_ptr 1
  .amdhsa_system_sgpr_workgroup_id_x 1
.end_amdhsa_kernel
```
